```python
import torch

def _softmax(x, axis=-1):
    return torch.softmax(x, dim=axis)
def _gelu(x):
    return torch.nn.functional.gelu(x, approximate="tanh")
def _silu(x):
    return torch.nn.functional.silu(x)
def _sigmoid(x):
    return torch.sigmoid(x)
def _layernorm(x, axis=-1, eps=1e-5):
    m = x.mean(dim=axis, keepdim=True)
    v = x.var(dim=axis, keepdim=True, unbiased=False)
    return (x - m) / torch.sqrt(v + eps)
def _scatter_add(tgt, idx, src, axis=0):
    return tgt.clone().index_add_(axis, idx, src)
def _segment_sum(src, seg, n):
    out = torch.zeros((n,) + src.shape[1:], dtype=src.dtype)
    return out.index_add_(0, seg, src)
def _pad(x, pw):
    flat = tuple(v for pair in reversed(pw) for v in pair)
    return torch.nn.functional.pad(x, flat)

kernel_name = 'recurrent_scan__spectral_gfnet__glu_gated_geglu__prompt'

def setup_inputs():

    _w = (lambda a: (lambda t: t.to(torch.bfloat16) if t.is_floating_point() else t)(torch.as_tensor(a)))
    def _A_setup():
        B, S, D = 1, 2048, 640
        Df = D // 2 + 1
        return {
            "x": _w((lambda *s: torch.randn(*s, dtype=torch.bfloat16) * 0.1)(B, S, D)),
            "w_r": _w((lambda *s: torch.randn(*s, dtype=torch.bfloat16) * 3.2)(S, Df) * 0.02),
            "w_i": _w((lambda *s: torch.randn(*s, dtype=torch.bfloat16) * 3.2)(S, Df) * 0.02),
        }
    _A_in = _A_setup()

    def _B_setup():
        B, S, Dm, Df = 1, 2048, 640, 1536
        return {
            "x": _w((lambda *s: torch.randn(*s, dtype=torch.bfloat16) * 0.1)(B, S, Dm)),
            "w_gate": _w((lambda *s: torch.randn(*s, dtype=torch.bfloat16) * 0.8)(Dm, Df) * (Dm ** -0.5)),
            "w_up": _w((lambda *s: torch.randn(*s, dtype=torch.bfloat16) * 0.8)(Dm, Df) * (Dm ** -0.5)),
            "w_down": _w((lambda *s: torch.randn(*s, dtype=torch.bfloat16) * 0.8)(Df, Dm) * (Df ** -0.5)),
        }
    _B_in = _B_setup()

    return {
        "A_x": _A_in["x"],
        "A_w_r": _A_in["w_r"],
        "A_w_i": _A_in["w_i"],
        "B_x": _B_in["x"],
        "B_w_gate": _B_in["w_gate"],
        "B_w_up": _B_in["w_up"],
        "B_w_down": _B_in["w_down"],
    }

def reference(A_x, A_w_r, A_w_i, B_x, B_w_gate, B_w_up, B_w_down):
    def _A_ref(x, w_r, w_i):
        B, S, D = x.shape
        X = (lambda x, axes=(-2,-1): torch.fft.rfft2(x.float(), dim=axes))(x, axes=(-2, -1))
        W = w_r + 1j * w_i
        X = X * W
        y = (lambda x, s, axes=(-2,-1): torch.fft.irfft2(x, s=s, dim=axes).to(torch.bfloat16))(X, (S, D), axes=(-2, -1))
        return y

    def _B_ref(x, w_gate, w_up, w_down):
        g = torch.einsum("bsd,df->bsf", x, w_gate)
        u = torch.einsum("bsd,df->bsf", x, w_up)
        h = _gelu(g) * u
        return torch.einsum("bsf,fd->bsd", h, w_down)

    x = A_x
    xn = _layernorm(x, axis=-1)
    s = _A_ref(xn, A_w_r, A_w_i)
    g = _silu(_B_ref(xn, B_w_gate, B_w_up, B_w_down))
    return x + s * g
```

```asm
; @launch grid=(256,1,1) block=(512,1,1) lds=163840
.amdgcn_target "amdgcn-amd-amdhsa--gfx950"
.text
.globl recurrent_scan__spectral_gfnet__glu_gated_geglu__prompt_kernel
.p2align 8
.type recurrent_scan__spectral_gfnet__glu_gated_geglu__prompt_kernel,@function
recurrent_scan__spectral_gfnet__glu_gated_geglu__prompt_kernel:
  s_cmp_ge_u32 s2, 256
  s_cbranch_scc1 L_end
  s_load_dwordx16 s[4:19], s[0:1], 0
  s_load_dwordx4 s[20:23], s[0:1], 64
  v_lshrrev_b32 v1, 6, v0
  v_and_b32 v0, 63, v0
  v_readfirstlane_b32 s3, v1
  s_getpc_b64 s[62:63]
  s_lshr_b32 s64, s2, 3
  s_mul_i32 s64, s64, 1536
  v_lshl_add_u32 v4, v0, 7, s64
  v_min_u32 v4, PFMAX, v4
  v_mov_b32 v5, s63
  v_add_co_u32 v4, vcc, s62, v4
  s_nop 1
  v_addc_co_u32 v5, vcc, 0, v5, vcc
  s_cmp_lg_u32 s3, 7
  s_cbranch_scc1 L_nopf
  s_mov_b64 exec, 4095
  global_load_dword v6, v[4:5], off
  s_mov_b64 exec, -1
L_nopf:
  s_and_b32 s52, s2, 7
  s_lshr_b32 s53, s2, 3
  s_and_b32 s62, s52, 1
  s_lshl_b32 s62, s62, 3
  s_and_b32 s63, s53, 7
  s_add_u32 s54, s62, s63
  s_lshr_b32 s62, s52, 1
  s_lshl_b32 s62, s62, 2
  s_lshr_b32 s63, s53, 3
  s_add_u32 s55, s62, s63
  s_mul_i32 s62, s54, 1
  s_mul_i32 s63, s55, 1
  s_add_u32 s62, s62, s63
  s_mul_i32 s63, s62, 6554
  s_lshr_b32 s63, s63, 16
  s_mul_i32 s63, s63, 10
  s_sub_u32 s56, s62, s63
  s_and_b32 s62, s52, 1
  s_xor_b32 s62, s62, 1
  s_lshr_b32 s63, s52, 1
  s_lshl2_add_u32 s63, s62, s63
  s_and_b32 s62, s53, 3
  s_lshl2_add_u32 s57, s63, s62
  s_lshr_b32 s58, s53, 2
  s_mul_i32 s62, s62, 3
  s_mul_i32 s63, s58, 3
  s_lshr_b32 s63, s63, 1
  s_add_u32 s62, s62, s63
  s_mul_i32 s63, s62, 5462
  s_lshr_b32 s63, s63, 16
  s_mul_i32 s63, s63, 12
  s_sub_u32 s71, s62, s63
  s_and_b32 s62, s53, 3
  s_add_u32 s62, s62, s58
  s_and_b32 s71, s62, 3
  s_mul_i32 s63, s53, 3277
  s_lshr_b32 s63, s63, 16
  s_mul_i32 s63, s63, 20
  s_sub_u32 s62, s53, s63
  s_mul_i32 s59, s52, 20
  s_add_u32 s59, s59, s62
  s_cmp_lt_u32 s53, 20
  s_cselect_b32 s70, 0, 2147418112
  s_cmp_eq_u32 s2, 160
  s_cselect_b32 s59, 160, s59
  s_cselect_b32 s70, 0, s70
  s_and_b32 s61, s3, 3
  s_cmp_eq_u32 s70, 0
  s_cselect_b32 s100, 1, 0
  s_waitcnt lgkmcnt(0)
  s_mov_b32 s24, s4
  s_mov_b32 s25, s5
  s_mov_b32 s26, 2621440
  s_mov_b32 s27, 0x20000
  s_mov_b32 s28, s22
  s_mov_b32 s29, s23
  s_mov_b32 s30, 17887616
  s_mov_b32 s31, 0x20000
  s_mov_b32 s36, s6
  s_mov_b32 s37, s7
  s_mov_b32 s38, 1314816
  s_mov_b32 s39, 0x20000
  s_mov_b32 s40, s8
  s_mov_b32 s41, s9
  s_mov_b32 s42, 1314816
  s_mov_b32 s43, 0x20000
  s_mov_b32 s44, s16
  s_mov_b32 s45, s17
  s_mov_b32 s46, 1966080
  s_mov_b32 s47, 0x20000
  s_mov_b32 s48, s18
  s_mov_b32 s49, s19
  s_mov_b32 s50, 2621440
  s_mov_b32 s51, 0x20000
  s_bitcmp1_b32 s3, 0
  s_cselect_b32 s32, s14, s12
  s_cselect_b32 s33, s15, s13
  s_mov_b32 s34, 1966080
  s_mov_b32 s35, 0x20000
  v_mov_b32 v2, 0
  buffer_load_dword v1, v2, s[28:31], 0 offen sc1
  s_cmp_ge_u32 s3, 4
  s_cselect_b32 s78, 1, 0
  s_cmp_eq_u32 s78, 1
  s_cbranch_scc1 L_ld0
  s_setprio 1
  s_lshr_b32 s62, s2, 7
  s_lshl_b32 s62, s62, 5
  s_lshr_b32 s63, s3, 1
  s_lshl4_add_u32 s62, s63, s62
  s_bfe_u32 s63, s2, 131077
  s_lshl2_add_u32 s62, s63, s62
  s_and_b32 s63, s3, 1
  s_lshl1_add_u32 s62, s63, s62
  s_lshl_b32 s62, s62, 5
  s_and_b32 s63, s2, 31
  s_add_u32 s68, s62, s63
  s_mul_i32 s62, s68, 1280
  s_mul_i32 s69, s3, 3072
  s_add_u32 s69, s69, 123072
  s_mov_b32 m0, s69
  v_lshlrev_b32 v2, 4, v0
  v_add_u32 v3, 39680, v2
  v_cmp_gt_u32 vcc, 16, v0
  s_nop 1
  v_cndmask_b32 v4, v3, v2, vcc
  v_mov_b32 v5, 2147418112
  v_cmp_gt_u32 vcc, 32, v0
  s_nop 1
  v_cndmask_b32 v5, v5, v3, vcc
  buffer_load_dwordx4 v2, s[24:27], s62 offen lds
  buffer_load_dwordx4 v4, s[24:27], s62 offen offset:1024 lds
  buffer_load_dwordx4 v5, s[24:27], s62 offen offset:2048 lds
  s_mov_b32 s77, 81920
  v_and_b32 v60, 31, v0
  v_lshrrev_b32 v61, 5, v0
  v_cvt_f32_u32 v62, v60
  v_cvt_f32_u32 v63, v61
  v_mul_f32 v66, 0x3d000000, v62
  v_mul_f32 v67, 0x41000000, v63
  v_mul_f32 v67, v67, v66
  v_fmamk_f32 v71, v66, 0x3f800000, v67
  v_fmamk_f32 v72, v66, 0x40000000, v67
  v_fmamk_f32 v73, v66, 0x40400000, v67
  v_fmamk_f32 v74, v66, 0x40800000, v67
  v_fmamk_f32 v75, v66, 0x40a00000, v67
  v_fmamk_f32 v76, v66, 0x40c00000, v67
  v_fmamk_f32 v77, v66, 0x40e00000, v67
  v_cos_f32 v78, v67
  v_cos_f32 v79, v71
  v_cos_f32 v80, v72
  v_cos_f32 v81, v73
  v_cos_f32 v82, v74
  v_cos_f32 v83, v75
  v_cos_f32 v84, v76
  v_cos_f32 v85, v77
  v_sin_f32 v86, v67
  v_sin_f32 v87, v71
  v_sin_f32 v88, v72
  v_sin_f32 v89, v73
  v_sin_f32 v90, v74
  v_sin_f32 v91, v75
  v_sin_f32 v92, v76
  v_sin_f32 v93, v77
  v_cvt_pk_bf16_f32 v8, v78, v79
  v_cvt_pk_bf16_f32 v9, v80, v81
  v_cvt_pk_bf16_f32 v10, v82, v83
  v_cvt_pk_bf16_f32 v11, v84, v85
  v_cvt_pk_bf16_f32 v16, -v86, -v87
  v_cvt_pk_bf16_f32 v17, -v88, -v89
  v_cvt_pk_bf16_f32 v18, -v90, -v91
  v_cvt_pk_bf16_f32 v19, -v92, -v93
  v_fmamk_f32 v70, v66, 0x41800000, v67
  v_fmamk_f32 v71, v66, 0x41880000, v67
  v_fmamk_f32 v72, v66, 0x41900000, v67
  v_fmamk_f32 v73, v66, 0x41980000, v67
  v_fmamk_f32 v74, v66, 0x41a00000, v67
  v_fmamk_f32 v75, v66, 0x41a80000, v67
  v_fmamk_f32 v76, v66, 0x41b00000, v67
  v_fmamk_f32 v77, v66, 0x41b80000, v67
  v_cos_f32 v78, v70
  v_cos_f32 v79, v71
  v_cos_f32 v80, v72
  v_cos_f32 v81, v73
  v_cos_f32 v82, v74
  v_cos_f32 v83, v75
  v_cos_f32 v84, v76
  v_cos_f32 v85, v77
  v_sin_f32 v86, v70
  v_sin_f32 v87, v71
  v_sin_f32 v88, v72
  v_sin_f32 v89, v73
  v_sin_f32 v90, v74
  v_sin_f32 v91, v75
  v_sin_f32 v92, v76
  v_sin_f32 v93, v77
  v_cvt_pk_bf16_f32 v12, v78, v79
  v_cvt_pk_bf16_f32 v13, v80, v81
  v_cvt_pk_bf16_f32 v14, v82, v83
  v_cvt_pk_bf16_f32 v15, v84, v85
  v_cvt_pk_bf16_f32 v20, -v86, -v87
  v_cvt_pk_bf16_f32 v21, -v88, -v89
  v_cvt_pk_bf16_f32 v22, -v90, -v91
  v_cvt_pk_bf16_f32 v23, -v92, -v93
  v_mul_f32 v63, 4.0, v63
  v_mul_f32 v66, 0x3acccccd, v62
  v_mul_f32 v67, v63, v66
  v_fmamk_f32 v71, v66, 0x3f800000, v67
  v_fmamk_f32 v72, v66, 0x40000000, v67
  v_fmamk_f32 v73, v66, 0x40400000, v67
  v_fmamk_f32 v74, v66, 0x41000000, v67
  v_fmamk_f32 v75, v66, 0x41100000, v67
  v_fmamk_f32 v76, v66, 0x41200000, v67
  v_fmamk_f32 v77, v66, 0x41300000, v67
  v_fmamk_f32 v78, v66, 0x41800000, v67
  v_fmamk_f32 v79, v66, 0x41880000, v67
  v_fmamk_f32 v80, v66, 0x41900000, v67
  v_fmamk_f32 v81, v66, 0x41980000, v67
  v_cos_f32 v82, v67
  v_cos_f32 v83, v71
  v_cos_f32 v84, v72
  v_cos_f32 v85, v73
  v_cos_f32 v86, v74
  v_cos_f32 v87, v75
  v_cos_f32 v88, v76
  v_cos_f32 v89, v77
  v_cos_f32 v90, v78
  v_cos_f32 v91, v79
  v_cos_f32 v92, v80
  v_cos_f32 v93, v81
  v_sin_f32 v94, v67
  v_sin_f32 v95, v71
  v_sin_f32 v96, v72
  v_sin_f32 v97, v73
  v_sin_f32 v98, v74
  v_sin_f32 v99, v75
  v_sin_f32 v100, v76
  v_sin_f32 v101, v77
  v_sin_f32 v102, v78
  v_sin_f32 v103, v79
  v_sin_f32 v104, v80
  v_sin_f32 v105, v81
  v_cvt_pk_f16_f32 v24, v82, v94
  v_cvt_pk_f16_f32 v25, v83, v95
  v_cvt_pk_f16_f32 v26, v84, v96
  v_cvt_pk_f16_f32 v27, v85, v97
  v_cvt_pk_f16_f32 v28, v86, v98
  v_cvt_pk_f16_f32 v29, v87, v99
  v_cvt_pk_f16_f32 v30, v88, v100
  v_cvt_pk_f16_f32 v31, v89, v101
  v_cvt_pk_f16_f32 v32, v90, v102
  v_cvt_pk_f16_f32 v33, v91, v103
  v_cvt_pk_f16_f32 v34, v92, v104
  v_cvt_pk_f16_f32 v35, v93, v105
  v_cmp_gt_u32 vcc, 32, v0
  s_nop 1
  v_cndmask_b32 v32, 0, v32, vcc
  v_cndmask_b32 v33, 0, v33, vcc
  v_cndmask_b32 v34, 0, v34, vcc
  v_cndmask_b32 v35, 0, v35, vcc
  v_lshrrev_b32 v64, 1, v60
  v_cvt_f32_u32 v64, v64
  v_and_b32 v65, 1, v60
  v_cvt_f32_u32 v65, v65
  v_mul_f32 v66, 0x3d4ccccd, v64
  v_mul_f32 v67, v63, v66
  v_fmac_f32 v67, 0x3e800000, v65
  v_fmamk_f32 v71, v66, 0x3f800000, v67
  v_fmamk_f32 v72, v66, 0x40000000, v67
  v_fmamk_f32 v73, v66, 0x40400000, v67
  v_fmamk_f32 v74, v66, 0x41000000, v67
  v_fmamk_f32 v75, v66, 0x41100000, v67
  v_fmamk_f32 v76, v66, 0x41200000, v67
  v_fmamk_f32 v77, v66, 0x41300000, v67
  v_fmamk_f32 v78, v66, 0x41800000, v67
  v_fmamk_f32 v79, v66, 0x41880000, v67
  v_fmamk_f32 v80, v66, 0x41900000, v67
  v_fmamk_f32 v81, v66, 0x41980000, v67
  v_cos_f32 v82, v67
  v_cos_f32 v83, v71
  v_cos_f32 v84, v72
  v_cos_f32 v85, v73
  v_cos_f32 v86, v74
  v_cos_f32 v87, v75
  v_cos_f32 v88, v76
  v_cos_f32 v89, v77
  v_cos_f32 v90, v78
  v_cos_f32 v91, v79
  v_cos_f32 v92, v80
  v_cos_f32 v93, v81
  v_sin_f32 v94, v67
  v_sin_f32 v95, v71
  v_sin_f32 v96, v72
  v_sin_f32 v97, v73
  v_sin_f32 v98, v74
  v_sin_f32 v99, v75
  v_sin_f32 v100, v76
  v_sin_f32 v101, v77
  v_sin_f32 v102, v78
  v_sin_f32 v103, v79
  v_sin_f32 v104, v80
  v_sin_f32 v105, v81
  v_cvt_pk_bf16_f32 v36, v82, v83
  v_cvt_pk_bf16_f32 v37, v84, v85
  v_cvt_pk_bf16_f32 v38, v86, v87
  v_cvt_pk_bf16_f32 v39, v88, v89
  v_cvt_pk_bf16_f32 v40, v94, v95
  v_cvt_pk_bf16_f32 v41, v96, v97
  v_cvt_pk_bf16_f32 v42, v98, v99
  v_cvt_pk_bf16_f32 v43, v100, v101
  v_cvt_pk_bf16_f32 v44, v90, v91
  v_cvt_pk_bf16_f32 v45, v92, v93
  v_cvt_pk_bf16_f32 v46, v102, v103
  v_cvt_pk_bf16_f32 v47, v104, v105
  v_and_b32 v64, 15, v0
  v_lshrrev_b32 v65, 2, v64
  v_lshl_add_u32 v65, v61, 3, v65
  v_mul_u32_u24 v65, 40, v65
  v_and_b32 v64, 3, v64
  v_lshl_add_u32 v65, v64, 3, v65
  v_and_b32 v64, 16, v0
  v_lshl_add_u32 v65, v64, 1, v65
  v_add_u32 v48, s69, v65
  v_mul_u32_u24 v64, 1280, v61
  v_mad_u32_u24 v64, v60, 40, v64
  v_add_u32 v49, s69, v64
  s_lshl_b32 s62, s3, 2
  s_add_u32 s62, s62, 135360
  v_lshlrev_b32 v64, 5, v60
  v_lshl_add_u32 v64, v61, 11, v64
  v_add_u32 v50, s62, v64
  v_cmp_eq_u32 vcc, 0, v0
  s_nop 1
  v_cndmask_b32 v51, 1.0, 0.5, vcc
  v_cmp_eq_u32 vcc, 0, v60
  s_nop 1
  v_cndmask_b32 v53, 0, 1.0, vcc
  v_cmp_eq_u32 vcc, 32, v0
  s_nop 1
  v_cndmask_b32 v52, 1.0, 0.5, vcc
  v_lshl_add_u32 v54, v61, 5, s68
  v_lshlrev_b32 v54, 3, v54
  s_and_b32 s66, s3, 1
  s_lshr_b32 s67, s3, 1
  v_and_b32 v2, 15, v0
  v_lshrrev_b32 v3, 4, v0
  v_lshrrev_b32 v4, 1, v2
  s_lshl_b32 s62, s66, 13
  v_lshl_add_u32 v5, v2, 7, s62
  s_xor_b32 s63, s66, 0
  s_lshl_b32 s63, s63, 2
  v_add_u32 v6, s63, v3
  v_xor_b32 v6, v6, v4
  v_lshl_add_u32 v208, v6, 4, v5
  s_xor_b32 s63, s66, 1
  s_lshl_b32 s63, s63, 2
  v_add_u32 v6, s63, v3
  v_xor_b32 v6, v6, v4
  v_lshl_add_u32 v209, v6, 4, v5
  v_lshrrev_b32 v7, 2, v2
  v_lshl_add_u32 v7, v3, 3, v7
  v_mul_u32_u24 v7, 192, v7
  v_and_b32 v6, 3, v2
  v_lshl_add_u32 v7, v6, 3, v7
  v_and_b32 v6, 1, v3
  v_lshl_add_u32 v7, v6, 5, v7
  s_mul_i32 s62, s67, 96
  s_add_u32 s62, s62, 16384
  s_mul_i32 s63, s66, 6144
  s_add_u32 s64, s62, s63
  s_sub_u32 s65, s62, s63
  v_add_u32 v210, s64, v7
  v_add_u32 v211, s65, v7
  s_mul_i32 s62, s67, 192
  v_mul_u32_u24 v6, s62, v6
  v_sub_u32 v212, v210, v6
  v_sub_u32 v213, v211, v6
  s_mul_i32 s62, s3, 768
  s_add_u32 s62, s62, 160512
  v_lshl_add_u32 v214, v0, 2, s62
  s_mul_i32 s62, s67, 768
  s_add_u32 s62, s62, 160512
  v_lshl_add_u32 v215, v3, 4, s62
  s_lshl_b32 s62, s66, 8
  s_add_u32 s62, s62, 162048
  v_lshl_add_u32 v216, v2, 2, s62
  v_mov_b32 v6, 0x3f803f80
  v_cmp_eq_u32 vcc, 0, v2
  s_nop 1
  v_cndmask_b32 v220, 0, v6, vcc
  v_cndmask_b32 v221, 0, v6, vcc
  v_cndmask_b32 v222, 0, v6, vcc
  v_cndmask_b32 v223, 0, v6, vcc
  v_cmp_eq_u32 vcc, 4, v2
  s_nop 1
  v_cndmask_b32 v224, 0, v6, vcc
  v_cndmask_b32 v225, 0, v6, vcc
  v_cndmask_b32 v226, 0, v6, vcc
  v_cndmask_b32 v227, 0, v6, vcc
  v_lshlrev_b32 v228, 4, v0
  v_and_b32 v6, 1, v3
  v_mul_u32_u24 v6, 50304, v6
  v_lshrrev_b32 v7, 1, v3
  v_lshl_add_u32 v6, v7, 8, v6
  v_lshl_add_u32 v229, v2, 4, v6
  s_waitcnt vmcnt(3)
  v_readfirstlane_b32 s60, v1
  s_nop 0
  s_mul_i32 s60, s60, 0x9e3779b1
  s_add_u32 s60, s60, 0x7f4a7c15
  s_waitcnt vmcnt(0)
  ds_read_b64 v[60:61], v49 offset:0
  ds_read_b64 v[62:63], v49 offset:8
  ds_read_b64 v[64:65], v49 offset:16
  ds_read_b64 v[66:67], v49 offset:24
  ds_read_b64 v[68:69], v49 offset:32
  ds_read_b64_tr_b16 v[72:73], v48 offset:0
  ds_read_b64_tr_b16 v[74:75], v48 offset:160
  ds_read_b64_tr_b16 v[76:77], v48 offset:640
  ds_read_b64_tr_b16 v[78:79], v48 offset:800
  ds_read_b64_tr_b16 v[80:81], v48 offset:1280
  ds_read_b64_tr_b16 v[82:83], v48 offset:1440
  ds_read_b64_tr_b16 v[84:85], v48 offset:1920
  ds_read_b64_tr_b16 v[86:87], v48 offset:2080
  s_waitcnt lgkmcnt(4)
  v_mfma_f32_32x32x16_bf16 v[112:127], v[72:75], v[8:11], 0
  v_mfma_f32_32x32x16_bf16 v[112:127], v[76:79], v[12:15], v[112:127]
  v_mfma_f32_32x32x16_bf16 v[128:143], v[72:75], v[16:19], 0
  v_mfma_f32_32x32x16_bf16 v[128:143], v[76:79], v[20:23], v[128:143]
  s_waitcnt lgkmcnt(0)
  v_mfma_f32_32x32x16_bf16 v[144:159], v[80:83], v[8:11], 0
  v_mfma_f32_32x32x16_bf16 v[144:159], v[84:87], v[12:15], v[144:159]
  v_mfma_f32_32x32x16_bf16 v[160:175], v[80:83], v[16:19], 0
  v_mfma_f32_32x32x16_bf16 v[160:175], v[84:87], v[20:23], v[160:175]
  v_lshlrev_b32 v92, 16, v60
  v_and_b32 v93, 0xffff0000, v60
  v_mov_b32 v88, v92
  v_mov_b32 v89, v93
  v_mul_f32 v90, v92, v92
  v_mul_f32 v91, v93, v93
  v_lshlrev_b32 v92, 16, v61
  v_and_b32 v93, 0xffff0000, v61
  v_add_f32 v88, v88, v92
  v_add_f32 v89, v89, v93
  v_fmac_f32 v90, v92, v92
  v_fmac_f32 v91, v93, v93
  v_lshlrev_b32 v92, 16, v62
  v_and_b32 v93, 0xffff0000, v62
  v_add_f32 v88, v88, v92
  v_add_f32 v89, v89, v93
  v_fmac_f32 v90, v92, v92
  v_fmac_f32 v91, v93, v93
  v_lshlrev_b32 v92, 16, v63
  v_and_b32 v93, 0xffff0000, v63
  v_add_f32 v88, v88, v92
  v_add_f32 v89, v89, v93
  v_fmac_f32 v90, v92, v92
  v_fmac_f32 v91, v93, v93
  v_lshlrev_b32 v92, 16, v64
  v_and_b32 v93, 0xffff0000, v64
  v_add_f32 v88, v88, v92
  v_add_f32 v89, v89, v93
  v_fmac_f32 v90, v92, v92
  v_fmac_f32 v91, v93, v93
  v_lshlrev_b32 v92, 16, v65
  v_and_b32 v93, 0xffff0000, v65
  v_add_f32 v88, v88, v92
  v_add_f32 v89, v89, v93
  v_fmac_f32 v90, v92, v92
  v_fmac_f32 v91, v93, v93
  v_lshlrev_b32 v92, 16, v66
  v_and_b32 v93, 0xffff0000, v66
  v_add_f32 v88, v88, v92
  v_add_f32 v89, v89, v93
  v_fmac_f32 v90, v92, v92
  v_fmac_f32 v91, v93, v93
  v_lshlrev_b32 v92, 16, v67
  v_and_b32 v93, 0xffff0000, v67
  v_add_f32 v88, v88, v92
  v_add_f32 v89, v89, v93
  v_fmac_f32 v90, v92, v92
  v_fmac_f32 v91, v93, v93
  v_lshlrev_b32 v92, 16, v68
  v_and_b32 v93, 0xffff0000, v68
  v_add_f32 v88, v88, v92
  v_add_f32 v89, v89, v93
  v_fmac_f32 v90, v92, v92
  v_fmac_f32 v91, v93, v93
  v_lshlrev_b32 v92, 16, v69
  v_and_b32 v93, 0xffff0000, v69
  v_add_f32 v88, v88, v92
  v_add_f32 v89, v89, v93
  v_fmac_f32 v90, v92, v92
  v_fmac_f32 v91, v93, v93
  v_add_f32 v88, v88, v89
  v_add_f32 v90, v90, v91
  s_nop 0
  v_add_f32_dpp v88, v88, v88 row_shr:1 row_mask:0xf bank_mask:0xf bound_ctrl:1
  v_add_f32_dpp v90, v90, v90 row_shr:1 row_mask:0xf bank_mask:0xf bound_ctrl:1
  s_nop 0
  v_add_f32_dpp v88, v88, v88 row_shr:2 row_mask:0xf bank_mask:0xf bound_ctrl:1
  v_add_f32_dpp v90, v90, v90 row_shr:2 row_mask:0xf bank_mask:0xf bound_ctrl:1
  s_nop 0
  v_add_f32_dpp v88, v88, v88 row_shr:4 row_mask:0xf bank_mask:0xf bound_ctrl:1
  v_add_f32_dpp v90, v90, v90 row_shr:4 row_mask:0xf bank_mask:0xf bound_ctrl:1
  s_nop 0
  v_add_f32_dpp v88, v88, v88 row_shr:8 row_mask:0xf bank_mask:0xf bound_ctrl:1
  v_add_f32_dpp v90, v90, v90 row_shr:8 row_mask:0xf bank_mask:0xf bound_ctrl:1
  s_nop 0
  v_add_f32_dpp v88, v88, v88 row_bcast:15 row_mask:0xa bank_mask:0xf
  v_add_f32_dpp v90, v90, v90 row_bcast:15 row_mask:0xa bank_mask:0xf
  v_mul_f32 v88, 0x3acccccd, v88
  v_mul_f32 v90, 0x3acccccd, v90
  v_fma_f32 v90, -v88, v88, v90
  v_max_f32 v90, 0, v90
  v_cvt_pk_bf16_f32 v92, v88, v90
  v_and_b32 v93, 0xffff0000, v92
  v_add_f32 v93, 0x3727c5ac, v93
  v_cvt_pk_bf16_f32 v93, v93, v93
  v_and_b32 v93, 0xffff0000, v93
  v_sqrt_f32 v93, v93
  s_nop 0
  v_cvt_pk_bf16_f32 v93, v93, v93
  v_and_b32 v93, 0xffff0000, v93
  v_rcp_f32 v91, v93
  v_and_b32 v94, 0xffff, v92
  v_or_b32 v94, v94, v93
  v_mov_b32 v95, s60
  v_mul_f32 v91, 0x35cccccd, v91
  v_lshlrev_b32 v89, 16, v92
  v_mul_f32 v89, 0xc2000000, v89
  s_mov_b32 exec_lo, 0x80000000
  s_mov_b32 exec_hi, 0x80000000
  buffer_store_dwordx2 v[94:95], v54, s[28:31], s77 offen sc1
  s_mov_b64 exec, -1
  v_readlane_b32 s62, v91, 31
  v_readlane_b32 s63, v91, 63
  v_readlane_b32 s64, v89, 31
  v_readlane_b32 s65, v89, 63
  s_nop 0
  v_fma_f32 v112, v53, s64, v112
  v_fma_f32 v113, v53, s64, v113
  v_fma_f32 v114, v53, s64, v114
  v_fma_f32 v115, v53, s64, v115
  v_fma_f32 v116, v53, s64, v116
  v_fma_f32 v117, v53, s64, v117
  v_fma_f32 v118, v53, s64, v118
  v_fma_f32 v119, v53, s64, v119
  v_fma_f32 v120, v53, s64, v120
  v_fma_f32 v121, v53, s64, v121
  v_fma_f32 v122, v53, s64, v122
  v_fma_f32 v123, v53, s64, v123
  v_fma_mix_f32 v88, v112, v24, 0 op_sel_hi:[0,1,0]
  v_fma_mix_f32 v100, v128, v24, 0 op_sel_hi:[0,1,0]
  v_fma_mix_f32 v88, v128, v24, v88 op_sel:[0,1,0] op_sel_hi:[0,1,0]
  v_fma_mix_f32 v100, -v112, v24, v100 op_sel:[0,1,0] op_sel_hi:[0,1,0]
  v_fma_mix_f32 v89, v113, v25, 0 op_sel_hi:[0,1,0]
  v_fma_mix_f32 v101, v129, v25, 0 op_sel_hi:[0,1,0]
  v_fma_mix_f32 v89, v129, v25, v89 op_sel:[0,1,0] op_sel_hi:[0,1,0]
  v_fma_mix_f32 v101, -v113, v25, v101 op_sel:[0,1,0] op_sel_hi:[0,1,0]
  v_fma_mix_f32 v90, v114, v26, 0 op_sel_hi:[0,1,0]
  v_fma_mix_f32 v102, v130, v26, 0 op_sel_hi:[0,1,0]
  v_fma_mix_f32 v90, v130, v26, v90 op_sel:[0,1,0] op_sel_hi:[0,1,0]
  v_fma_mix_f32 v102, -v114, v26, v102 op_sel:[0,1,0] op_sel_hi:[0,1,0]
  v_fma_mix_f32 v91, v115, v27, 0 op_sel_hi:[0,1,0]
  v_fma_mix_f32 v103, v131, v27, 0 op_sel_hi:[0,1,0]
  v_fma_mix_f32 v91, v131, v27, v91 op_sel:[0,1,0] op_sel_hi:[0,1,0]
  v_fma_mix_f32 v103, -v115, v27, v103 op_sel:[0,1,0] op_sel_hi:[0,1,0]
  v_fma_mix_f32 v92, v116, v28, 0 op_sel_hi:[0,1,0]
  v_fma_mix_f32 v104, v132, v28, 0 op_sel_hi:[0,1,0]
  v_fma_mix_f32 v92, v132, v28, v92 op_sel:[0,1,0] op_sel_hi:[0,1,0]
  v_fma_mix_f32 v104, -v116, v28, v104 op_sel:[0,1,0] op_sel_hi:[0,1,0]
  v_fma_mix_f32 v93, v117, v29, 0 op_sel_hi:[0,1,0]
  v_fma_mix_f32 v105, v133, v29, 0 op_sel_hi:[0,1,0]
  v_fma_mix_f32 v93, v133, v29, v93 op_sel:[0,1,0] op_sel_hi:[0,1,0]
  v_fma_mix_f32 v105, -v117, v29, v105 op_sel:[0,1,0] op_sel_hi:[0,1,0]
  v_fma_mix_f32 v94, v118, v30, 0 op_sel_hi:[0,1,0]
  v_fma_mix_f32 v106, v134, v30, 0 op_sel_hi:[0,1,0]
  v_fma_mix_f32 v94, v134, v30, v94 op_sel:[0,1,0] op_sel_hi:[0,1,0]
  v_fma_mix_f32 v106, -v118, v30, v106 op_sel:[0,1,0] op_sel_hi:[0,1,0]
  v_fma_mix_f32 v95, v119, v31, 0 op_sel_hi:[0,1,0]
  v_fma_mix_f32 v107, v135, v31, 0 op_sel_hi:[0,1,0]
  v_fma_mix_f32 v95, v135, v31, v95 op_sel:[0,1,0] op_sel_hi:[0,1,0]
  v_fma_mix_f32 v107, -v119, v31, v107 op_sel:[0,1,0] op_sel_hi:[0,1,0]
  v_fma_mix_f32 v96, v120, v32, 0 op_sel_hi:[0,1,0]
  v_fma_mix_f32 v108, v136, v32, 0 op_sel_hi:[0,1,0]
  v_fma_mix_f32 v96, v136, v32, v96 op_sel:[0,1,0] op_sel_hi:[0,1,0]
  v_fma_mix_f32 v108, -v120, v32, v108 op_sel:[0,1,0] op_sel_hi:[0,1,0]
  v_fma_mix_f32 v97, v121, v33, 0 op_sel_hi:[0,1,0]
  v_fma_mix_f32 v109, v137, v33, 0 op_sel_hi:[0,1,0]
  v_fma_mix_f32 v97, v137, v33, v97 op_sel:[0,1,0] op_sel_hi:[0,1,0]
  v_fma_mix_f32 v109, -v121, v33, v109 op_sel:[0,1,0] op_sel_hi:[0,1,0]
  v_fma_mix_f32 v98, v122, v34, 0 op_sel_hi:[0,1,0]
  v_fma_mix_f32 v110, v138, v34, 0 op_sel_hi:[0,1,0]
  v_fma_mix_f32 v98, v138, v34, v98 op_sel:[0,1,0] op_sel_hi:[0,1,0]
  v_fma_mix_f32 v110, -v122, v34, v110 op_sel:[0,1,0] op_sel_hi:[0,1,0]
  v_fma_mix_f32 v99, v123, v35, 0 op_sel_hi:[0,1,0]
  v_fma_mix_f32 v111, v139, v35, 0 op_sel_hi:[0,1,0]
  v_fma_mix_f32 v99, v139, v35, v99 op_sel:[0,1,0] op_sel_hi:[0,1,0]
  v_fma_mix_f32 v111, -v123, v35, v111 op_sel:[0,1,0] op_sel_hi:[0,1,0]
  v_cvt_pk_bf16_f32 v60, v88, v89
  v_cvt_pk_bf16_f32 v61, v90, v91
  v_cvt_pk_bf16_f32 v62, v92, v93
  v_cvt_pk_bf16_f32 v63, v94, v95
  v_cvt_pk_bf16_f32 v64, v100, v101
  v_cvt_pk_bf16_f32 v65, v102, v103
  v_cvt_pk_bf16_f32 v66, v104, v105
  v_cvt_pk_bf16_f32 v67, v106, v107
  v_cvt_pk_bf16_f32 v68, v96, v97
  v_cvt_pk_bf16_f32 v69, v98, v99
  v_cvt_pk_bf16_f32 v70, v108, v109
  v_cvt_pk_bf16_f32 v71, v110, v111
  v_mfma_f32_32x32x16_bf16 v[176:191], v[36:39], v[60:63], 0
  v_mfma_f32_32x32x16_bf16 v[176:191], v[40:43], v[64:67], v[176:191]
  v_mfma_f32_32x32x16_bf16 v[176:191], v[44:47], v[68:71], v[176:191]
  v_fma_f32 v144, v53, s65, v144
  v_fma_f32 v145, v53, s65, v145
  v_fma_f32 v146, v53, s65, v146
  v_fma_f32 v147, v53, s65, v147
  v_fma_f32 v148, v53, s65, v148
  v_fma_f32 v149, v53, s65, v149
  v_fma_f32 v150, v53, s65, v150
  v_fma_f32 v151, v53, s65, v151
  v_fma_f32 v152, v53, s65, v152
  v_fma_f32 v153, v53, s65, v153
  v_fma_f32 v154, v53, s65, v154
  v_fma_f32 v155, v53, s65, v155
  v_fma_mix_f32 v88, v144, v24, 0 op_sel_hi:[0,1,0]
  v_fma_mix_f32 v100, v160, v24, 0 op_sel_hi:[0,1,0]
  v_fma_mix_f32 v88, v160, v24, v88 op_sel:[0,1,0] op_sel_hi:[0,1,0]
  v_fma_mix_f32 v100, -v144, v24, v100 op_sel:[0,1,0] op_sel_hi:[0,1,0]
  v_fma_mix_f32 v89, v145, v25, 0 op_sel_hi:[0,1,0]
  v_fma_mix_f32 v101, v161, v25, 0 op_sel_hi:[0,1,0]
  v_fma_mix_f32 v89, v161, v25, v89 op_sel:[0,1,0] op_sel_hi:[0,1,0]
  v_fma_mix_f32 v101, -v145, v25, v101 op_sel:[0,1,0] op_sel_hi:[0,1,0]
  v_fma_mix_f32 v90, v146, v26, 0 op_sel_hi:[0,1,0]
  v_fma_mix_f32 v102, v162, v26, 0 op_sel_hi:[0,1,0]
  v_fma_mix_f32 v90, v162, v26, v90 op_sel:[0,1,0] op_sel_hi:[0,1,0]
  v_fma_mix_f32 v102, -v146, v26, v102 op_sel:[0,1,0] op_sel_hi:[0,1,0]
  v_fma_mix_f32 v91, v147, v27, 0 op_sel_hi:[0,1,0]
  v_fma_mix_f32 v103, v163, v27, 0 op_sel_hi:[0,1,0]
  v_fma_mix_f32 v91, v163, v27, v91 op_sel:[0,1,0] op_sel_hi:[0,1,0]
  v_fma_mix_f32 v103, -v147, v27, v103 op_sel:[0,1,0] op_sel_hi:[0,1,0]
  v_fma_mix_f32 v92, v148, v28, 0 op_sel_hi:[0,1,0]
  v_fma_mix_f32 v104, v164, v28, 0 op_sel_hi:[0,1,0]
  v_fma_mix_f32 v92, v164, v28, v92 op_sel:[0,1,0] op_sel_hi:[0,1,0]
  v_fma_mix_f32 v104, -v148, v28, v104 op_sel:[0,1,0] op_sel_hi:[0,1,0]
  v_fma_mix_f32 v93, v149, v29, 0 op_sel_hi:[0,1,0]
  v_fma_mix_f32 v105, v165, v29, 0 op_sel_hi:[0,1,0]
  v_fma_mix_f32 v93, v165, v29, v93 op_sel:[0,1,0] op_sel_hi:[0,1,0]
  v_fma_mix_f32 v105, -v149, v29, v105 op_sel:[0,1,0] op_sel_hi:[0,1,0]
  v_fma_mix_f32 v94, v150, v30, 0 op_sel_hi:[0,1,0]
  v_fma_mix_f32 v106, v166, v30, 0 op_sel_hi:[0,1,0]
  v_fma_mix_f32 v94, v166, v30, v94 op_sel:[0,1,0] op_sel_hi:[0,1,0]
  v_fma_mix_f32 v106, -v150, v30, v106 op_sel:[0,1,0] op_sel_hi:[0,1,0]
  v_fma_mix_f32 v95, v151, v31, 0 op_sel_hi:[0,1,0]
  v_fma_mix_f32 v107, v167, v31, 0 op_sel_hi:[0,1,0]
  v_fma_mix_f32 v95, v167, v31, v95 op_sel:[0,1,0] op_sel_hi:[0,1,0]
  v_fma_mix_f32 v107, -v151, v31, v107 op_sel:[0,1,0] op_sel_hi:[0,1,0]
  v_fma_mix_f32 v96, v152, v32, 0 op_sel_hi:[0,1,0]
  v_fma_mix_f32 v108, v168, v32, 0 op_sel_hi:[0,1,0]
  v_fma_mix_f32 v96, v168, v32, v96 op_sel:[0,1,0] op_sel_hi:[0,1,0]
  v_fma_mix_f32 v108, -v152, v32, v108 op_sel:[0,1,0] op_sel_hi:[0,1,0]
  v_fma_mix_f32 v97, v153, v33, 0 op_sel_hi:[0,1,0]
  v_fma_mix_f32 v109, v169, v33, 0 op_sel_hi:[0,1,0]
  v_fma_mix_f32 v97, v169, v33, v97 op_sel:[0,1,0] op_sel_hi:[0,1,0]
  v_fma_mix_f32 v109, -v153, v33, v109 op_sel:[0,1,0] op_sel_hi:[0,1,0]
  v_fma_mix_f32 v98, v154, v34, 0 op_sel_hi:[0,1,0]
  v_fma_mix_f32 v110, v170, v34, 0 op_sel_hi:[0,1,0]
  v_fma_mix_f32 v98, v170, v34, v98 op_sel:[0,1,0] op_sel_hi:[0,1,0]
  v_fma_mix_f32 v110, -v154, v34, v110 op_sel:[0,1,0] op_sel_hi:[0,1,0]
  v_fma_mix_f32 v99, v155, v35, 0 op_sel_hi:[0,1,0]
  v_fma_mix_f32 v111, v171, v35, 0 op_sel_hi:[0,1,0]
  v_fma_mix_f32 v99, v171, v35, v99 op_sel:[0,1,0] op_sel_hi:[0,1,0]
  v_fma_mix_f32 v111, -v155, v35, v111 op_sel:[0,1,0] op_sel_hi:[0,1,0]
  v_cvt_pk_bf16_f32 v72, v88, v89
  v_cvt_pk_bf16_f32 v73, v90, v91
  v_cvt_pk_bf16_f32 v74, v92, v93
  v_cvt_pk_bf16_f32 v75, v94, v95
  v_cvt_pk_bf16_f32 v76, v100, v101
  v_cvt_pk_bf16_f32 v77, v102, v103
  v_cvt_pk_bf16_f32 v78, v104, v105
  v_cvt_pk_bf16_f32 v79, v106, v107
  v_cvt_pk_bf16_f32 v80, v96, v97
  v_cvt_pk_bf16_f32 v81, v98, v99
  v_cvt_pk_bf16_f32 v82, v108, v109
  v_cvt_pk_bf16_f32 v83, v110, v111
  v_mfma_f32_32x32x16_bf16 v[192:207], v[36:39], v[72:75], 0
  v_mfma_f32_32x32x16_bf16 v[192:207], v[40:43], v[76:79], v[192:207]
  v_mfma_f32_32x32x16_bf16 v[192:207], v[44:47], v[80:83], v[192:207]
  v_mul_f32 v176, v176, v51
  v_mul_f32 v184, v184, v52
  v_mul_f32 v176, s62, v176
  v_mul_f32 v177, s62, v177
  v_mul_f32 v178, s62, v178
  v_mul_f32 v179, s62, v179
  v_mul_f32 v180, s62, v180
  v_mul_f32 v181, s62, v181
  v_mul_f32 v182, s62, v182
  v_mul_f32 v183, s62, v183
  v_mul_f32 v184, s62, v184
  v_mul_f32 v185, s62, v185
  v_mul_f32 v186, s62, v186
  v_mul_f32 v187, s62, v187
  v_mul_f32 v192, v192, v51
  v_mul_f32 v200, v200, v52
  v_mul_f32 v192, s63, v192
  v_mul_f32 v193, s63, v193
  v_mul_f32 v194, s63, v194
  v_mul_f32 v195, s63, v195
  v_mul_f32 v196, s63, v196
  v_mul_f32 v197, s63, v197
  v_mul_f32 v198, s63, v198
  v_mul_f32 v199, s63, v199
  v_mul_f32 v200, s63, v200
  v_mul_f32 v201, s63, v201
  v_mul_f32 v202, s63, v202
  v_mul_f32 v203, s63, v203
  v_cvt_pk_bf16_f32 v88, v176, v192
  v_cvt_pk_bf16_f32 v89, v177, v193
  v_cvt_pk_bf16_f32 v90, v178, v194
  v_cvt_pk_bf16_f32 v91, v179, v195
  v_cvt_pk_bf16_f32 v92, v180, v196
  v_cvt_pk_bf16_f32 v93, v181, v197
  v_cvt_pk_bf16_f32 v94, v182, v198
  v_cvt_pk_bf16_f32 v95, v183, v199
  v_cvt_pk_bf16_f32 v96, v184, v200
  v_cvt_pk_bf16_f32 v97, v185, v201
  v_cvt_pk_bf16_f32 v98, v186, v202
  v_cvt_pk_bf16_f32 v99, v187, v203
  ds_write_b32 v50, v88 offset:0
  ds_write_b32 v50, v89 offset:16
  ds_write_b32 v50, v90 offset:1024
  ds_write_b32 v50, v91 offset:1040
  ds_write_b32 v50, v92 offset:4096
  ds_write_b32 v50, v93 offset:4112
  ds_write_b32 v50, v94 offset:5120
  ds_write_b32 v50, v95 offset:5136
  ds_write_b32 v50, v96 offset:8192
  ds_write_b32 v50, v97 offset:8208
  ds_write_b32 v50, v98 offset:9216
  ds_write_b32 v50, v99 offset:9232
  s_waitcnt lgkmcnt(0)
  s_barrier
  ds_read_b128 v[56:59], v208 offset:0
  ds_read_b128 v[60:63], v208 offset:2048
  ds_read_b128 v[64:67], v208 offset:4096
  ds_read_b128 v[68:71], v208 offset:6144
  ds_read_b64_tr_b16 v[88:89], v210 offset:0
  ds_read_b64_tr_b16 v[90:91], v210 offset:768
  ds_read_b64_tr_b16 v[92:93], v210 offset:12320
  ds_read_b64_tr_b16 v[94:95], v210 offset:13088
  ds_read_b64_tr_b16 v[96:97], v210 offset:32
  ds_read_b64_tr_b16 v[98:99], v210 offset:800
  s_waitcnt lgkmcnt(0)
  v_mfma_f32_16x16x32_bf16 v[112:115], v[88:91], v[56:59], 0
  ds_read_b64_tr_b16 v[100:101], v210 offset:12352
  v_mfma_f32_16x16x32_bf16 v[116:119], v[88:91], v[60:63], 0
  ds_read_b64_tr_b16 v[102:103], v210 offset:13120
  v_mfma_f32_16x16x32_bf16 v[120:123], v[88:91], v[64:67], 0
  ds_read_b64_tr_b16 v[104:105], v212 offset:64
  v_mfma_f32_16x16x32_bf16 v[124:127], v[88:91], v[68:71], 0
  ds_read_b64_tr_b16 v[106:107], v212 offset:832
  v_mfma_f32_16x16x32_bf16 v[8:11], v[220:223], v[88:91], 0
  v_mfma_f32_16x16x32_bf16 v[128:131], v[92:95], v[56:59], 0
  ds_read_b64_tr_b16 v[108:109], v212 offset:12384
  v_mfma_f32_16x16x32_bf16 v[132:135], v[92:95], v[60:63], 0
  ds_read_b64_tr_b16 v[110:111], v212 offset:13152
  v_mfma_f32_16x16x32_bf16 v[136:139], v[92:95], v[64:67], 0
  ds_read_b128 v[72:75], v209 offset:0
  v_mfma_f32_16x16x32_bf16 v[140:143], v[92:95], v[68:71], 0
  ds_read_b128 v[76:79], v209 offset:2048
  v_mfma_f32_16x16x32_bf16 v[8:11], v[224:227], v[92:95], v[8:11]
  v_mfma_f32_16x16x32_bf16 v[144:147], v[96:99], v[56:59], 0
  v_mfma_f32_16x16x32_bf16 v[148:151], v[96:99], v[60:63], 0
  v_mfma_f32_16x16x32_bf16 v[152:155], v[96:99], v[64:67], 0
  v_mfma_f32_16x16x32_bf16 v[156:159], v[96:99], v[68:71], 0
  v_mfma_f32_16x16x32_bf16 v[12:15], v[220:223], v[96:99], 0
  s_waitcnt lgkmcnt(0)
  v_mfma_f32_16x16x32_bf16 v[160:163], v[100:103], v[56:59], 0
  ds_read_b64_tr_b16 v[88:89], v211 offset:6144
  v_mfma_f32_16x16x32_bf16 v[164:167], v[100:103], v[60:63], 0
  ds_read_b64_tr_b16 v[90:91], v211 offset:6912
  v_mfma_f32_16x16x32_bf16 v[168:171], v[100:103], v[64:67], 0
  ds_read_b64_tr_b16 v[92:93], v211 offset:18464
  v_mfma_f32_16x16x32_bf16 v[172:175], v[100:103], v[68:71], 0
  ds_read_b64_tr_b16 v[94:95], v211 offset:19232
  v_mfma_f32_16x16x32_bf16 v[12:15], v[224:227], v[100:103], v[12:15]
  v_mfma_f32_16x16x32_bf16 v[176:179], v[104:107], v[56:59], 0
  ds_read_b64_tr_b16 v[96:97], v211 offset:6176
  v_mfma_f32_16x16x32_bf16 v[180:183], v[104:107], v[60:63], 0
  ds_read_b64_tr_b16 v[98:99], v211 offset:6944
  v_mfma_f32_16x16x32_bf16 v[184:187], v[104:107], v[64:67], 0
  ds_read_b128 v[80:83], v209 offset:4096
  v_mfma_f32_16x16x32_bf16 v[188:191], v[104:107], v[68:71], 0
  ds_read_b128 v[84:87], v209 offset:6144
  v_mfma_f32_16x16x32_bf16 v[16:19], v[220:223], v[104:107], 0
  v_mfma_f32_16x16x32_bf16 v[192:195], v[108:111], v[56:59], 0
  v_mfma_f32_16x16x32_bf16 v[196:199], v[108:111], v[60:63], 0
  v_mfma_f32_16x16x32_bf16 v[200:203], v[108:111], v[64:67], 0
  v_mfma_f32_16x16x32_bf16 v[204:207], v[108:111], v[68:71], 0
  v_mfma_f32_16x16x32_bf16 v[16:19], v[224:227], v[108:111], v[16:19]
  s_waitcnt lgkmcnt(0)
  v_mfma_f32_16x16x32_bf16 v[112:115], v[88:91], v[72:75], v[112:115]
  ds_read_b64_tr_b16 v[100:101], v211 offset:18496
  v_mfma_f32_16x16x32_bf16 v[116:119], v[88:91], v[76:79], v[116:119]
  ds_read_b64_tr_b16 v[102:103], v211 offset:19264
  v_mfma_f32_16x16x32_bf16 v[120:123], v[88:91], v[80:83], v[120:123]
  ds_read_b64_tr_b16 v[104:105], v213 offset:6208
  v_mfma_f32_16x16x32_bf16 v[124:127], v[88:91], v[84:87], v[124:127]
  ds_read_b64_tr_b16 v[106:107], v213 offset:6976
  v_mfma_f32_16x16x32_bf16 v[128:131], v[92:95], v[72:75], v[128:131]
  ds_read_b64_tr_b16 v[108:109], v213 offset:18528
  v_mfma_f32_16x16x32_bf16 v[132:135], v[92:95], v[76:79], v[132:135]
  ds_read_b64_tr_b16 v[110:111], v213 offset:19296
  v_mfma_f32_16x16x32_bf16 v[136:139], v[92:95], v[80:83], v[136:139]
  ds_write_b32 v214, v8 offset:0
  ds_write_b32 v214, v12 offset:256
  ds_write_b32 v214, v16 offset:512
  v_mfma_f32_16x16x32_bf16 v[140:143], v[92:95], v[84:87], v[140:143]
  v_add_u32 v230, 41024, v208
  v_add_u32 v231, 41024, v209
  v_mfma_f32_16x16x32_bf16 v[144:147], v[96:99], v[72:75], v[144:147]
  v_add_u32 v232, 41024, v210
  v_add_u32 v233, 41024, v211
  v_mfma_f32_16x16x32_bf16 v[148:151], v[96:99], v[76:79], v[148:151]
  v_add_u32 v234, 41024, v212
  v_add_u32 v235, 41024, v213
  v_mfma_f32_16x16x32_bf16 v[152:155], v[96:99], v[80:83], v[152:155]
  v_mfma_f32_16x16x32_bf16 v[156:159], v[96:99], v[84:87], v[156:159]
  s_waitcnt lgkmcnt(0)
  s_barrier
  v_mfma_f32_16x16x32_bf16 v[160:163], v[100:103], v[72:75], v[160:163]
  ds_read_b128 v[56:59], v230 offset:0
  v_mfma_f32_16x16x32_bf16 v[164:167], v[100:103], v[76:79], v[164:167]
  ds_read_b128 v[60:63], v230 offset:2048
  v_mfma_f32_16x16x32_bf16 v[168:171], v[100:103], v[80:83], v[168:171]
  ds_read_b128 v[64:67], v230 offset:4096
  v_mfma_f32_16x16x32_bf16 v[172:175], v[100:103], v[84:87], v[172:175]
  ds_read_b128 v[68:71], v230 offset:6144
  v_mfma_f32_16x16x32_bf16 v[176:179], v[104:107], v[72:75], v[176:179]
  ds_read_b64_tr_b16 v[88:89], v232 offset:0
  v_mfma_f32_16x16x32_bf16 v[180:183], v[104:107], v[76:79], v[180:183]
  ds_read_b64_tr_b16 v[90:91], v232 offset:768
  v_mfma_f32_16x16x32_bf16 v[184:187], v[104:107], v[80:83], v[184:187]
  ds_read_b64_tr_b16 v[92:93], v232 offset:12320
  v_mfma_f32_16x16x32_bf16 v[188:191], v[104:107], v[84:87], v[188:191]
  ds_read_b64_tr_b16 v[94:95], v232 offset:13088
  v_mfma_f32_16x16x32_bf16 v[192:195], v[108:111], v[72:75], v[192:195]
  ds_read_b64_tr_b16 v[96:97], v232 offset:32
  v_mfma_f32_16x16x32_bf16 v[196:199], v[108:111], v[76:79], v[196:199]
  ds_read_b64_tr_b16 v[98:99], v232 offset:800
  v_mfma_f32_16x16x32_bf16 v[200:203], v[108:111], v[80:83], v[200:203]
  v_mfma_f32_16x16x32_bf16 v[204:207], v[108:111], v[84:87], v[204:207]
  s_waitcnt lgkmcnt(0)
  v_mfma_f32_16x16x32_bf16 v[112:115], v[88:91], v[56:59], v[112:115]
  ds_read_b64_tr_b16 v[100:101], v232 offset:12352
  v_mfma_f32_16x16x32_bf16 v[116:119], v[88:91], v[60:63], v[116:119]
  ds_read_b64_tr_b16 v[102:103], v232 offset:13120
  v_mfma_f32_16x16x32_bf16 v[120:123], v[88:91], v[64:67], v[120:123]
  ds_read_b64_tr_b16 v[104:105], v234 offset:64
  v_mfma_f32_16x16x32_bf16 v[124:127], v[88:91], v[68:71], v[124:127]
  ds_read_b64_tr_b16 v[106:107], v234 offset:832
  v_mfma_f32_16x16x32_bf16 v[128:131], v[92:95], v[56:59], v[128:131]
  ds_read_b64_tr_b16 v[108:109], v234 offset:12384
  v_mfma_f32_16x16x32_bf16 v[132:135], v[92:95], v[60:63], v[132:135]
  ds_read_b64_tr_b16 v[110:111], v234 offset:13152
  v_mfma_f32_16x16x32_bf16 v[136:139], v[92:95], v[64:67], v[136:139]
  ds_read_b128 v[72:75], v231 offset:0
  v_mfma_f32_16x16x32_bf16 v[140:143], v[92:95], v[68:71], v[140:143]
  ds_read_b128 v[76:79], v231 offset:2048
  v_mfma_f32_16x16x32_bf16 v[144:147], v[96:99], v[56:59], v[144:147]
  v_mfma_f32_16x16x32_bf16 v[148:151], v[96:99], v[60:63], v[148:151]
  v_mfma_f32_16x16x32_bf16 v[152:155], v[96:99], v[64:67], v[152:155]
  v_mfma_f32_16x16x32_bf16 v[156:159], v[96:99], v[68:71], v[156:159]
  s_waitcnt lgkmcnt(0)
  v_mfma_f32_16x16x32_bf16 v[160:163], v[100:103], v[56:59], v[160:163]
  ds_read_b64_tr_b16 v[88:89], v233 offset:6144
  v_mfma_f32_16x16x32_bf16 v[164:167], v[100:103], v[60:63], v[164:167]
  ds_read_b64_tr_b16 v[90:91], v233 offset:6912
  v_mfma_f32_16x16x32_bf16 v[168:171], v[100:103], v[64:67], v[168:171]
  ds_read_b64_tr_b16 v[92:93], v233 offset:18464
  v_mfma_f32_16x16x32_bf16 v[172:175], v[100:103], v[68:71], v[172:175]
  ds_read_b64_tr_b16 v[94:95], v233 offset:19232
  v_mfma_f32_16x16x32_bf16 v[176:179], v[104:107], v[56:59], v[176:179]
  ds_read_b64_tr_b16 v[96:97], v233 offset:6176
  v_mfma_f32_16x16x32_bf16 v[180:183], v[104:107], v[60:63], v[180:183]
  ds_read_b64_tr_b16 v[98:99], v233 offset:6944
  v_mfma_f32_16x16x32_bf16 v[184:187], v[104:107], v[64:67], v[184:187]
  ds_read_b128 v[80:83], v231 offset:4096
  v_mfma_f32_16x16x32_bf16 v[188:191], v[104:107], v[68:71], v[188:191]
  ds_read_b128 v[84:87], v231 offset:6144
  v_mfma_f32_16x16x32_bf16 v[192:195], v[108:111], v[56:59], v[192:195]
  v_mfma_f32_16x16x32_bf16 v[196:199], v[108:111], v[60:63], v[196:199]
  v_mfma_f32_16x16x32_bf16 v[200:203], v[108:111], v[64:67], v[200:203]
  v_mfma_f32_16x16x32_bf16 v[204:207], v[108:111], v[68:71], v[204:207]
  s_waitcnt lgkmcnt(0)
  v_mfma_f32_16x16x32_bf16 v[112:115], v[88:91], v[72:75], v[112:115]
  ds_read_b64_tr_b16 v[100:101], v233 offset:18496
  v_mfma_f32_16x16x32_bf16 v[116:119], v[88:91], v[76:79], v[116:119]
  ds_read_b64_tr_b16 v[102:103], v233 offset:19264
  v_mfma_f32_16x16x32_bf16 v[120:123], v[88:91], v[80:83], v[120:123]
  ds_read_b64_tr_b16 v[104:105], v235 offset:6208
  v_mfma_f32_16x16x32_bf16 v[124:127], v[88:91], v[84:87], v[124:127]
  ds_read_b64_tr_b16 v[106:107], v235 offset:6976
  v_mfma_f32_16x16x32_bf16 v[128:131], v[92:95], v[72:75], v[128:131]
  ds_read_b64_tr_b16 v[108:109], v235 offset:18528
  v_mfma_f32_16x16x32_bf16 v[132:135], v[92:95], v[76:79], v[132:135]
  ds_read_b64_tr_b16 v[110:111], v235 offset:19296
  v_mfma_f32_16x16x32_bf16 v[136:139], v[92:95], v[80:83], v[136:139]
  v_mfma_f32_16x16x32_bf16 v[140:143], v[92:95], v[84:87], v[140:143]
  v_add_u32 v230, 82048, v208
  v_add_u32 v231, 82048, v209
  v_mfma_f32_16x16x32_bf16 v[144:147], v[96:99], v[72:75], v[144:147]
  v_add_u32 v232, 82048, v210
  v_add_u32 v233, 82048, v211
  v_mfma_f32_16x16x32_bf16 v[148:151], v[96:99], v[76:79], v[148:151]
  v_add_u32 v234, 82048, v212
  v_add_u32 v235, 82048, v213
  v_mfma_f32_16x16x32_bf16 v[152:155], v[96:99], v[80:83], v[152:155]
  v_mfma_f32_16x16x32_bf16 v[156:159], v[96:99], v[84:87], v[156:159]
  s_waitcnt lgkmcnt(0)
  s_barrier
  v_mfma_f32_16x16x32_bf16 v[160:163], v[100:103], v[72:75], v[160:163]
  ds_read_b128 v[56:59], v230 offset:0
  v_mfma_f32_16x16x32_bf16 v[164:167], v[100:103], v[76:79], v[164:167]
  ds_read_b128 v[60:63], v230 offset:2048
  v_mfma_f32_16x16x32_bf16 v[168:171], v[100:103], v[80:83], v[168:171]
  ds_read_b128 v[64:67], v230 offset:4096
  v_mfma_f32_16x16x32_bf16 v[172:175], v[100:103], v[84:87], v[172:175]
  ds_read_b128 v[68:71], v230 offset:6144
  v_mfma_f32_16x16x32_bf16 v[176:179], v[104:107], v[72:75], v[176:179]
  ds_read_b64_tr_b16 v[88:89], v232 offset:0
  v_mfma_f32_16x16x32_bf16 v[180:183], v[104:107], v[76:79], v[180:183]
  ds_read_b64_tr_b16 v[90:91], v232 offset:768
  v_mfma_f32_16x16x32_bf16 v[184:187], v[104:107], v[80:83], v[184:187]
  ds_read_b64_tr_b16 v[92:93], v232 offset:12320
  v_mfma_f32_16x16x32_bf16 v[188:191], v[104:107], v[84:87], v[188:191]
  ds_read_b64_tr_b16 v[94:95], v232 offset:13088
  v_mfma_f32_16x16x32_bf16 v[192:195], v[108:111], v[72:75], v[192:195]
  ds_read_b64_tr_b16 v[96:97], v232 offset:32
  v_mfma_f32_16x16x32_bf16 v[196:199], v[108:111], v[76:79], v[196:199]
  ds_read_b64_tr_b16 v[98:99], v232 offset:800
  v_mfma_f32_16x16x32_bf16 v[200:203], v[108:111], v[80:83], v[200:203]
  v_mfma_f32_16x16x32_bf16 v[204:207], v[108:111], v[84:87], v[204:207]
  s_lshl1_add_u32 s62, s54, s66
  s_mul_i32 s64, s62, 201216
  s_lshl_b32 s65, s55, 10
  s_add_u32 s64, s64, s65
  s_add_u32 s64, s64, 8794496
  s_lshl_b32 s65, s67, 9
  s_add_u32 s65, s65, s64
  s_add_u32 s65, s65, 32768
  s_lshl_b32 s63, s67, 14
  s_add_u32 s64, s64, s63
  s_waitcnt lgkmcnt(0)
  v_mfma_f32_16x16x32_bf16 v[112:115], v[88:91], v[56:59], v[112:115]
  ds_read_b64_tr_b16 v[100:101], v232 offset:12352
  v_mfma_f32_16x16x32_bf16 v[116:119], v[88:91], v[60:63], v[116:119]
  ds_read_b64_tr_b16 v[102:103], v232 offset:13120
  v_mfma_f32_16x16x32_bf16 v[120:123], v[88:91], v[64:67], v[120:123]
  ds_read_b64_tr_b16 v[104:105], v234 offset:64
  v_mfma_f32_16x16x32_bf16 v[124:127], v[88:91], v[68:71], v[124:127]
  ds_read_b64_tr_b16 v[106:107], v234 offset:832
  v_mfma_f32_16x16x32_bf16 v[128:131], v[92:95], v[56:59], v[128:131]
  ds_read_b64_tr_b16 v[108:109], v234 offset:12384
  v_mfma_f32_16x16x32_bf16 v[132:135], v[92:95], v[60:63], v[132:135]
  ds_read_b64_tr_b16 v[110:111], v234 offset:13152
  v_mfma_f32_16x16x32_bf16 v[136:139], v[92:95], v[64:67], v[136:139]
  ds_read_b128 v[72:75], v231 offset:0
  v_mfma_f32_16x16x32_bf16 v[140:143], v[92:95], v[68:71], v[140:143]
  ds_read_b128 v[76:79], v231 offset:2048
  v_mfma_f32_16x16x32_bf16 v[144:147], v[96:99], v[56:59], v[144:147]
  v_mfma_f32_16x16x32_bf16 v[148:151], v[96:99], v[60:63], v[148:151]
  v_mfma_f32_16x16x32_bf16 v[152:155], v[96:99], v[64:67], v[152:155]
  v_mfma_f32_16x16x32_bf16 v[156:159], v[96:99], v[68:71], v[156:159]
  s_waitcnt lgkmcnt(0)
  v_mfma_f32_16x16x32_bf16 v[160:163], v[100:103], v[56:59], v[160:163]
  ds_read_b64_tr_b16 v[88:89], v233 offset:6144
  v_mfma_f32_16x16x32_bf16 v[164:167], v[100:103], v[60:63], v[164:167]
  ds_read_b64_tr_b16 v[90:91], v233 offset:6912
  v_mfma_f32_16x16x32_bf16 v[168:171], v[100:103], v[64:67], v[168:171]
  ds_read_b64_tr_b16 v[92:93], v233 offset:18464
  v_mfma_f32_16x16x32_bf16 v[172:175], v[100:103], v[68:71], v[172:175]
  ds_read_b64_tr_b16 v[94:95], v233 offset:19232
  v_mfma_f32_16x16x32_bf16 v[176:179], v[104:107], v[56:59], v[176:179]
  ds_read_b64_tr_b16 v[96:97], v233 offset:6176
  v_mfma_f32_16x16x32_bf16 v[180:183], v[104:107], v[60:63], v[180:183]
  ds_read_b64_tr_b16 v[98:99], v233 offset:6944
  v_mfma_f32_16x16x32_bf16 v[184:187], v[104:107], v[64:67], v[184:187]
  ds_read_b128 v[80:83], v231 offset:4096
  v_mfma_f32_16x16x32_bf16 v[188:191], v[104:107], v[68:71], v[188:191]
  ds_read_b128 v[84:87], v231 offset:6144
  v_mfma_f32_16x16x32_bf16 v[192:195], v[108:111], v[56:59], v[192:195]
  v_mfma_f32_16x16x32_bf16 v[196:199], v[108:111], v[60:63], v[196:199]
  v_mfma_f32_16x16x32_bf16 v[200:203], v[108:111], v[64:67], v[200:203]
  v_mfma_f32_16x16x32_bf16 v[204:207], v[108:111], v[68:71], v[204:207]
  s_waitcnt lgkmcnt(0)
  v_mfma_f32_16x16x32_bf16 v[112:115], v[88:91], v[72:75], v[112:115]
  ds_read_b64_tr_b16 v[100:101], v233 offset:18496
  v_mfma_f32_16x16x32_bf16 v[116:119], v[88:91], v[76:79], v[116:119]
  ds_read_b64_tr_b16 v[102:103], v233 offset:19264
  v_mfma_f32_16x16x32_bf16 v[120:123], v[88:91], v[80:83], v[120:123]
  ds_read_b64_tr_b16 v[104:105], v235 offset:6208
  v_mfma_f32_16x16x32_bf16 v[124:127], v[88:91], v[84:87], v[124:127]
  ds_read_b64_tr_b16 v[106:107], v235 offset:6976
  v_mfma_f32_16x16x32_bf16 v[128:131], v[92:95], v[72:75], v[128:131]
  ds_read_b64_tr_b16 v[108:109], v235 offset:18528
  v_mfma_f32_16x16x32_bf16 v[132:135], v[92:95], v[76:79], v[132:135]
  ds_read_b64_tr_b16 v[110:111], v235 offset:19296
  v_mfma_f32_16x16x32_bf16 v[136:139], v[92:95], v[80:83], v[136:139]
  v_mfma_f32_16x16x32_bf16 v[140:143], v[92:95], v[84:87], v[140:143]
  v_add_u32 v230, 0, v208
  v_add_u32 v231, 0, v209
  v_mfma_f32_16x16x32_bf16 v[144:147], v[96:99], v[72:75], v[144:147]
  v_add_u32 v232, 0, v210
  v_add_u32 v233, 0, v211
  v_mfma_f32_16x16x32_bf16 v[148:151], v[96:99], v[76:79], v[148:151]
  v_add_u32 v234, 0, v212
  v_add_u32 v235, 0, v213
  v_mfma_f32_16x16x32_bf16 v[152:155], v[96:99], v[80:83], v[152:155]
  v_mfma_f32_16x16x32_bf16 v[156:159], v[96:99], v[84:87], v[156:159]
  s_waitcnt lgkmcnt(0)
  s_barrier
  v_mfma_f32_16x16x32_bf16 v[160:163], v[100:103], v[72:75], v[160:163]
  ds_read_b128 v[56:59], v230 offset:0
  v_mfma_f32_16x16x32_bf16 v[164:167], v[100:103], v[76:79], v[164:167]
  ds_read_b128 v[60:63], v230 offset:2048
  v_mfma_f32_16x16x32_bf16 v[168:171], v[100:103], v[80:83], v[168:171]
  ds_read_b128 v[64:67], v230 offset:4096
  v_mfma_f32_16x16x32_bf16 v[172:175], v[100:103], v[84:87], v[172:175]
  ds_read_b128 v[68:71], v230 offset:6144
  v_mfma_f32_16x16x32_bf16 v[176:179], v[104:107], v[72:75], v[176:179]
  ds_read_b64_tr_b16 v[88:89], v232 offset:0
  v_mfma_f32_16x16x32_bf16 v[180:183], v[104:107], v[76:79], v[180:183]
  ds_read_b64_tr_b16 v[90:91], v232 offset:768
  v_mfma_f32_16x16x32_bf16 v[184:187], v[104:107], v[80:83], v[184:187]
  ds_read_b64_tr_b16 v[92:93], v232 offset:12320
  v_mfma_f32_16x16x32_bf16 v[188:191], v[104:107], v[84:87], v[188:191]
  ds_read_b64_tr_b16 v[94:95], v232 offset:13088
  v_mfma_f32_16x16x32_bf16 v[192:195], v[108:111], v[72:75], v[192:195]
  ds_read_b64_tr_b16 v[96:97], v232 offset:32
  v_mfma_f32_16x16x32_bf16 v[196:199], v[108:111], v[76:79], v[196:199]
  ds_read_b64_tr_b16 v[98:99], v232 offset:800
  v_mfma_f32_16x16x32_bf16 v[200:203], v[108:111], v[80:83], v[200:203]
  v_mfma_f32_16x16x32_bf16 v[204:207], v[108:111], v[84:87], v[204:207]
  s_lshl1_add_u32 s62, s54, s66
  s_lshl1_add_u32 s63, s55, s67
  s_lshl_b32 s62, s62, 5
  s_add_u32 s62, s62, s63
  s_lshl_b32 s62, s62, 7
  s_add_u32 s69, s62, 131072
  s_waitcnt lgkmcnt(0)
  v_mfma_f32_16x16x32_bf16 v[112:115], v[88:91], v[56:59], v[112:115]
  ds_read_b64_tr_b16 v[100:101], v232 offset:12352
  v_mfma_f32_16x16x32_bf16 v[116:119], v[88:91], v[60:63], v[116:119]
  ds_read_b64_tr_b16 v[102:103], v232 offset:13120
  v_mfma_f32_16x16x32_bf16 v[120:123], v[88:91], v[64:67], v[120:123]
  ds_read_b64_tr_b16 v[104:105], v234 offset:64
  v_mfma_f32_16x16x32_bf16 v[124:127], v[88:91], v[68:71], v[124:127]
  ds_read_b64_tr_b16 v[106:107], v234 offset:832
  v_mfma_f32_16x16x32_bf16 v[128:131], v[92:95], v[56:59], v[128:131]
  ds_read_b64_tr_b16 v[108:109], v234 offset:12384
  v_mfma_f32_16x16x32_bf16 v[132:135], v[92:95], v[60:63], v[132:135]
  ds_read_b64_tr_b16 v[110:111], v234 offset:13152
  v_mfma_f32_16x16x32_bf16 v[136:139], v[92:95], v[64:67], v[136:139]
  ds_read_b128 v[72:75], v231 offset:0
  v_mfma_f32_16x16x32_bf16 v[140:143], v[92:95], v[68:71], v[140:143]
  ds_read_b128 v[76:79], v231 offset:2048
  v_mfma_f32_16x16x32_bf16 v[144:147], v[96:99], v[56:59], v[144:147]
  v_mfma_f32_16x16x32_bf16 v[148:151], v[96:99], v[60:63], v[148:151]
  v_mfma_f32_16x16x32_bf16 v[152:155], v[96:99], v[64:67], v[152:155]
  v_mfma_f32_16x16x32_bf16 v[156:159], v[96:99], v[68:71], v[156:159]
  s_waitcnt lgkmcnt(0)
  v_mfma_f32_16x16x32_bf16 v[160:163], v[100:103], v[56:59], v[160:163]
  ds_read_b64_tr_b16 v[88:89], v233 offset:6144
  v_mfma_f32_16x16x32_bf16 v[164:167], v[100:103], v[60:63], v[164:167]
  ds_read_b64_tr_b16 v[90:91], v233 offset:6912
  v_mfma_f32_16x16x32_bf16 v[168:171], v[100:103], v[64:67], v[168:171]
  ds_read_b64_tr_b16 v[92:93], v233 offset:18464
  v_mfma_f32_16x16x32_bf16 v[172:175], v[100:103], v[68:71], v[172:175]
  ds_read_b64_tr_b16 v[94:95], v233 offset:19232
  v_mfma_f32_16x16x32_bf16 v[176:179], v[104:107], v[56:59], v[176:179]
  ds_read_b64_tr_b16 v[96:97], v233 offset:6176
  v_mfma_f32_16x16x32_bf16 v[180:183], v[104:107], v[60:63], v[180:183]
  ds_read_b64_tr_b16 v[98:99], v233 offset:6944
  v_mfma_f32_16x16x32_bf16 v[184:187], v[104:107], v[64:67], v[184:187]
  ds_read_b128 v[80:83], v231 offset:4096
  v_mfma_f32_16x16x32_bf16 v[188:191], v[104:107], v[68:71], v[188:191]
  ds_read_b128 v[84:87], v231 offset:6144
  v_mfma_f32_16x16x32_bf16 v[192:195], v[108:111], v[56:59], v[192:195]
  v_mfma_f32_16x16x32_bf16 v[196:199], v[108:111], v[60:63], v[196:199]
  v_mfma_f32_16x16x32_bf16 v[200:203], v[108:111], v[64:67], v[200:203]
  v_mfma_f32_16x16x32_bf16 v[204:207], v[108:111], v[68:71], v[204:207]
  s_waitcnt lgkmcnt(0)
  v_mfma_f32_16x16x32_bf16 v[112:115], v[88:91], v[72:75], v[112:115]
  ds_read_b64_tr_b16 v[100:101], v233 offset:18496
  v_mfma_f32_16x16x32_bf16 v[116:119], v[88:91], v[76:79], v[116:119]
  ds_read_b64_tr_b16 v[102:103], v233 offset:19264
  v_mfma_f32_16x16x32_bf16 v[120:123], v[88:91], v[80:83], v[120:123]
  ds_read_b64_tr_b16 v[104:105], v235 offset:6208
  v_mfma_f32_16x16x32_bf16 v[124:127], v[88:91], v[84:87], v[124:127]
  ds_read_b64_tr_b16 v[106:107], v235 offset:6976
  v_mfma_f32_16x16x32_bf16 v[128:131], v[92:95], v[72:75], v[128:131]
  ds_read_b64_tr_b16 v[108:109], v235 offset:18528
  v_mfma_f32_16x16x32_bf16 v[132:135], v[92:95], v[76:79], v[132:135]
  ds_read_b64_tr_b16 v[110:111], v235 offset:19296
  v_mfma_f32_16x16x32_bf16 v[136:139], v[92:95], v[80:83], v[136:139]
  v_mfma_f32_16x16x32_bf16 v[140:143], v[92:95], v[84:87], v[140:143]
  v_add_u32 v230, 41024, v208
  v_add_u32 v231, 41024, v209
  v_mfma_f32_16x16x32_bf16 v[144:147], v[96:99], v[72:75], v[144:147]
  v_add_u32 v232, 41024, v210
  v_add_u32 v233, 41024, v211
  v_mfma_f32_16x16x32_bf16 v[148:151], v[96:99], v[76:79], v[148:151]
  v_add_u32 v234, 41024, v212
  v_add_u32 v235, 41024, v213
  v_mfma_f32_16x16x32_bf16 v[152:155], v[96:99], v[80:83], v[152:155]
  v_mfma_f32_16x16x32_bf16 v[156:159], v[96:99], v[84:87], v[156:159]
  s_waitcnt lgkmcnt(0)
  s_barrier
  v_mfma_f32_16x16x32_bf16 v[160:163], v[100:103], v[72:75], v[160:163]
  ds_read_b128 v[56:59], v230 offset:0
  v_mfma_f32_16x16x32_bf16 v[164:167], v[100:103], v[76:79], v[164:167]
  ds_read_b128 v[60:63], v230 offset:2048
  v_mfma_f32_16x16x32_bf16 v[168:171], v[100:103], v[80:83], v[168:171]
  ds_read_b128 v[64:67], v230 offset:4096
  v_mfma_f32_16x16x32_bf16 v[172:175], v[100:103], v[84:87], v[172:175]
  ds_read_b128 v[68:71], v230 offset:6144
  v_mfma_f32_16x16x32_bf16 v[176:179], v[104:107], v[72:75], v[176:179]
  ds_read_b64_tr_b16 v[88:89], v232 offset:0
  v_mfma_f32_16x16x32_bf16 v[180:183], v[104:107], v[76:79], v[180:183]
  ds_read_b64_tr_b16 v[90:91], v232 offset:768
  v_mfma_f32_16x16x32_bf16 v[184:187], v[104:107], v[80:83], v[184:187]
  ds_read_b64_tr_b16 v[92:93], v232 offset:12320
  v_mfma_f32_16x16x32_bf16 v[188:191], v[104:107], v[84:87], v[188:191]
  ds_read_b64_tr_b16 v[94:95], v232 offset:13088
  v_mfma_f32_16x16x32_bf16 v[192:195], v[108:111], v[72:75], v[192:195]
  ds_read_b64_tr_b16 v[96:97], v232 offset:32
  v_mfma_f32_16x16x32_bf16 v[196:199], v[108:111], v[76:79], v[196:199]
  ds_read_b64_tr_b16 v[98:99], v232 offset:800
  v_mfma_f32_16x16x32_bf16 v[200:203], v[108:111], v[80:83], v[200:203]
  v_mfma_f32_16x16x32_bf16 v[204:207], v[108:111], v[84:87], v[204:207]
  s_waitcnt lgkmcnt(0)
  v_mfma_f32_16x16x32_bf16 v[112:115], v[88:91], v[56:59], v[112:115]
  ds_read_b64_tr_b16 v[100:101], v232 offset:12352
  v_mfma_f32_16x16x32_bf16 v[116:119], v[88:91], v[60:63], v[116:119]
  ds_read_b64_tr_b16 v[102:103], v232 offset:13120
  v_mfma_f32_16x16x32_bf16 v[120:123], v[88:91], v[64:67], v[120:123]
  ds_read_b64_tr_b16 v[104:105], v234 offset:64
  v_mfma_f32_16x16x32_bf16 v[124:127], v[88:91], v[68:71], v[124:127]
  ds_read_b64_tr_b16 v[106:107], v234 offset:832
  v_mfma_f32_16x16x32_bf16 v[128:131], v[92:95], v[56:59], v[128:131]
  ds_read_b64_tr_b16 v[108:109], v234 offset:12384
  v_mfma_f32_16x16x32_bf16 v[132:135], v[92:95], v[60:63], v[132:135]
  ds_read_b64_tr_b16 v[110:111], v234 offset:13152
  v_mfma_f32_16x16x32_bf16 v[136:139], v[92:95], v[64:67], v[136:139]
  ds_read_b128 v[72:75], v231 offset:0
  v_mfma_f32_16x16x32_bf16 v[140:143], v[92:95], v[68:71], v[140:143]
  ds_read_b128 v[76:79], v231 offset:2048
  v_mfma_f32_16x16x32_bf16 v[144:147], v[96:99], v[56:59], v[144:147]
  v_mfma_f32_16x16x32_bf16 v[148:151], v[96:99], v[60:63], v[148:151]
  v_mfma_f32_16x16x32_bf16 v[152:155], v[96:99], v[64:67], v[152:155]
  v_mfma_f32_16x16x32_bf16 v[156:159], v[96:99], v[68:71], v[156:159]
  s_waitcnt lgkmcnt(0)
  v_mfma_f32_16x16x32_bf16 v[160:163], v[100:103], v[56:59], v[160:163]
  ds_read_b64_tr_b16 v[88:89], v233 offset:6144
  v_mfma_f32_16x16x32_bf16 v[164:167], v[100:103], v[60:63], v[164:167]
  ds_read_b64_tr_b16 v[90:91], v233 offset:6912
  v_mfma_f32_16x16x32_bf16 v[168:171], v[100:103], v[64:67], v[168:171]
  ds_read_b64_tr_b16 v[92:93], v233 offset:18464
  v_mfma_f32_16x16x32_bf16 v[172:175], v[100:103], v[68:71], v[172:175]
  ds_read_b64_tr_b16 v[94:95], v233 offset:19232
  v_mfma_f32_16x16x32_bf16 v[176:179], v[104:107], v[56:59], v[176:179]
  ds_read_b64_tr_b16 v[96:97], v233 offset:6176
  v_mfma_f32_16x16x32_bf16 v[180:183], v[104:107], v[60:63], v[180:183]
  ds_read_b64_tr_b16 v[98:99], v233 offset:6944
  v_mfma_f32_16x16x32_bf16 v[184:187], v[104:107], v[64:67], v[184:187]
  ds_read_b128 v[80:83], v231 offset:4096
  v_mfma_f32_16x16x32_bf16 v[188:191], v[104:107], v[68:71], v[188:191]
  ds_read_b128 v[84:87], v231 offset:6144
  v_mfma_f32_16x16x32_bf16 v[192:195], v[108:111], v[56:59], v[192:195]
  v_mfma_f32_16x16x32_bf16 v[196:199], v[108:111], v[60:63], v[196:199]
  v_mfma_f32_16x16x32_bf16 v[200:203], v[108:111], v[64:67], v[200:203]
  v_mfma_f32_16x16x32_bf16 v[204:207], v[108:111], v[68:71], v[204:207]
  s_waitcnt lgkmcnt(0)
  v_mfma_f32_16x16x32_bf16 v[112:115], v[88:91], v[72:75], v[112:115]
  ds_read_b64_tr_b16 v[100:101], v233 offset:18496
  v_mfma_f32_16x16x32_bf16 v[116:119], v[88:91], v[76:79], v[116:119]
  ds_read_b64_tr_b16 v[102:103], v233 offset:19264
  v_mfma_f32_16x16x32_bf16 v[120:123], v[88:91], v[80:83], v[120:123]
  ds_read_b64_tr_b16 v[104:105], v235 offset:6208
  v_mfma_f32_16x16x32_bf16 v[124:127], v[88:91], v[84:87], v[124:127]
  ds_read_b64_tr_b16 v[106:107], v235 offset:6976
  v_mfma_f32_16x16x32_bf16 v[128:131], v[92:95], v[72:75], v[128:131]
  ds_read_b64_tr_b16 v[108:109], v235 offset:18528
  v_mfma_f32_16x16x32_bf16 v[132:135], v[92:95], v[76:79], v[132:135]
  ds_read_b64_tr_b16 v[110:111], v235 offset:19296
  v_mfma_f32_16x16x32_bf16 v[136:139], v[92:95], v[80:83], v[136:139]
  v_mfma_f32_16x16x32_bf16 v[140:143], v[92:95], v[84:87], v[140:143]
  v_add_u32 v230, 82048, v208
  v_add_u32 v231, 82048, v209
  v_mfma_f32_16x16x32_bf16 v[144:147], v[96:99], v[72:75], v[144:147]
  v_add_u32 v232, 82048, v210
  v_add_u32 v233, 82048, v211
  v_mfma_f32_16x16x32_bf16 v[148:151], v[96:99], v[76:79], v[148:151]
  v_add_u32 v234, 82048, v212
  v_add_u32 v235, 82048, v213
  v_mfma_f32_16x16x32_bf16 v[152:155], v[96:99], v[80:83], v[152:155]
  v_mfma_f32_16x16x32_bf16 v[156:159], v[96:99], v[84:87], v[156:159]
  s_waitcnt lgkmcnt(0)
  s_barrier
  v_mfma_f32_16x16x32_bf16 v[160:163], v[100:103], v[72:75], v[160:163]
  ds_read_b128 v[56:59], v230 offset:0
  v_mfma_f32_16x16x32_bf16 v[164:167], v[100:103], v[76:79], v[164:167]
  ds_read_b128 v[60:63], v230 offset:2048
  v_mfma_f32_16x16x32_bf16 v[168:171], v[100:103], v[80:83], v[168:171]
  ds_read_b128 v[64:67], v230 offset:4096
  v_mfma_f32_16x16x32_bf16 v[172:175], v[100:103], v[84:87], v[172:175]
  ds_read_b128 v[68:71], v230 offset:6144
  v_mfma_f32_16x16x32_bf16 v[176:179], v[104:107], v[72:75], v[176:179]
  ds_read_b64_tr_b16 v[88:89], v232 offset:0
  v_mfma_f32_16x16x32_bf16 v[180:183], v[104:107], v[76:79], v[180:183]
  ds_read_b64_tr_b16 v[90:91], v232 offset:768
  v_mfma_f32_16x16x32_bf16 v[184:187], v[104:107], v[80:83], v[184:187]
  ds_read_b64_tr_b16 v[92:93], v232 offset:12320
  v_mfma_f32_16x16x32_bf16 v[188:191], v[104:107], v[84:87], v[188:191]
  ds_read_b64_tr_b16 v[94:95], v232 offset:13088
  v_mfma_f32_16x16x32_bf16 v[192:195], v[108:111], v[72:75], v[192:195]
  ds_read_b64_tr_b16 v[96:97], v232 offset:32
  v_mfma_f32_16x16x32_bf16 v[196:199], v[108:111], v[76:79], v[196:199]
  ds_read_b64_tr_b16 v[98:99], v232 offset:800
  v_mfma_f32_16x16x32_bf16 v[200:203], v[108:111], v[80:83], v[200:203]
  v_mfma_f32_16x16x32_bf16 v[204:207], v[108:111], v[84:87], v[204:207]
  s_waitcnt lgkmcnt(0)
  v_mfma_f32_16x16x32_bf16 v[112:115], v[88:91], v[56:59], v[112:115]
  ds_read_b64_tr_b16 v[100:101], v232 offset:12352
  v_mfma_f32_16x16x32_bf16 v[116:119], v[88:91], v[60:63], v[116:119]
  ds_read_b64_tr_b16 v[102:103], v232 offset:13120
  v_mfma_f32_16x16x32_bf16 v[120:123], v[88:91], v[64:67], v[120:123]
  ds_read_b64_tr_b16 v[104:105], v234 offset:64
  v_mfma_f32_16x16x32_bf16 v[124:127], v[88:91], v[68:71], v[124:127]
  ds_read_b64_tr_b16 v[106:107], v234 offset:832
  v_mfma_f32_16x16x32_bf16 v[128:131], v[92:95], v[56:59], v[128:131]
  ds_read_b64_tr_b16 v[108:109], v234 offset:12384
  v_mfma_f32_16x16x32_bf16 v[132:135], v[92:95], v[60:63], v[132:135]
  ds_read_b64_tr_b16 v[110:111], v234 offset:13152
  v_mfma_f32_16x16x32_bf16 v[136:139], v[92:95], v[64:67], v[136:139]
  ds_read_b128 v[72:75], v231 offset:0
  v_mfma_f32_16x16x32_bf16 v[140:143], v[92:95], v[68:71], v[140:143]
  ds_read_b128 v[76:79], v231 offset:2048
  v_mfma_f32_16x16x32_bf16 v[144:147], v[96:99], v[56:59], v[144:147]
  v_mfma_f32_16x16x32_bf16 v[148:151], v[96:99], v[60:63], v[148:151]
  v_mfma_f32_16x16x32_bf16 v[152:155], v[96:99], v[64:67], v[152:155]
  v_mfma_f32_16x16x32_bf16 v[156:159], v[96:99], v[68:71], v[156:159]
  s_waitcnt lgkmcnt(0)
  v_mfma_f32_16x16x32_bf16 v[160:163], v[100:103], v[56:59], v[160:163]
  ds_read_b64_tr_b16 v[88:89], v233 offset:6144
  v_mfma_f32_16x16x32_bf16 v[164:167], v[100:103], v[60:63], v[164:167]
  ds_read_b64_tr_b16 v[90:91], v233 offset:6912
  v_mfma_f32_16x16x32_bf16 v[168:171], v[100:103], v[64:67], v[168:171]
  ds_read_b64_tr_b16 v[92:93], v233 offset:18464
  v_mfma_f32_16x16x32_bf16 v[172:175], v[100:103], v[68:71], v[172:175]
  ds_read_b64_tr_b16 v[94:95], v233 offset:19232
  v_mfma_f32_16x16x32_bf16 v[176:179], v[104:107], v[56:59], v[176:179]
  ds_read_b64_tr_b16 v[96:97], v233 offset:6176
  v_mfma_f32_16x16x32_bf16 v[180:183], v[104:107], v[60:63], v[180:183]
  ds_read_b64_tr_b16 v[98:99], v233 offset:6944
  v_mfma_f32_16x16x32_bf16 v[184:187], v[104:107], v[64:67], v[184:187]
  ds_read_b128 v[80:83], v231 offset:4096
  v_mfma_f32_16x16x32_bf16 v[188:191], v[104:107], v[68:71], v[188:191]
  ds_read_b128 v[84:87], v231 offset:6144
  v_mfma_f32_16x16x32_bf16 v[192:195], v[108:111], v[56:59], v[192:195]
  v_mfma_f32_16x16x32_bf16 v[196:199], v[108:111], v[60:63], v[196:199]
  v_mfma_f32_16x16x32_bf16 v[200:203], v[108:111], v[64:67], v[200:203]
  v_mfma_f32_16x16x32_bf16 v[204:207], v[108:111], v[68:71], v[204:207]
  s_waitcnt lgkmcnt(0)
  v_mfma_f32_16x16x32_bf16 v[112:115], v[88:91], v[72:75], v[112:115]
  ds_read_b64_tr_b16 v[100:101], v233 offset:18496
  v_mfma_f32_16x16x32_bf16 v[116:119], v[88:91], v[76:79], v[116:119]
  ds_read_b64_tr_b16 v[102:103], v233 offset:19264
  v_mfma_f32_16x16x32_bf16 v[120:123], v[88:91], v[80:83], v[120:123]
  ds_read_b64_tr_b16 v[104:105], v235 offset:6208
  v_mfma_f32_16x16x32_bf16 v[124:127], v[88:91], v[84:87], v[124:127]
  ds_read_b64_tr_b16 v[106:107], v235 offset:6976
  v_mfma_f32_16x16x32_bf16 v[128:131], v[92:95], v[72:75], v[128:131]
  ds_read_b64_tr_b16 v[108:109], v235 offset:18528
  v_mfma_f32_16x16x32_bf16 v[132:135], v[92:95], v[76:79], v[132:135]
  ds_read_b64_tr_b16 v[110:111], v235 offset:19296
  v_mfma_f32_16x16x32_bf16 v[136:139], v[92:95], v[80:83], v[136:139]
  v_mfma_f32_16x16x32_bf16 v[140:143], v[92:95], v[84:87], v[140:143]
  v_add_u32 v230, 0, v208
  v_add_u32 v231, 0, v209
  v_mfma_f32_16x16x32_bf16 v[144:147], v[96:99], v[72:75], v[144:147]
  v_add_u32 v232, 0, v210
  v_add_u32 v233, 0, v211
  v_mfma_f32_16x16x32_bf16 v[148:151], v[96:99], v[76:79], v[148:151]
  v_add_u32 v234, 0, v212
  v_add_u32 v235, 0, v213
  v_mfma_f32_16x16x32_bf16 v[152:155], v[96:99], v[80:83], v[152:155]
  v_mfma_f32_16x16x32_bf16 v[156:159], v[96:99], v[84:87], v[156:159]
  s_waitcnt lgkmcnt(0)
  s_barrier
  v_mfma_f32_16x16x32_bf16 v[160:163], v[100:103], v[72:75], v[160:163]
  ds_read_b128 v[56:59], v230 offset:0
  v_mfma_f32_16x16x32_bf16 v[164:167], v[100:103], v[76:79], v[164:167]
  ds_read_b128 v[60:63], v230 offset:2048
  v_mfma_f32_16x16x32_bf16 v[168:171], v[100:103], v[80:83], v[168:171]
  ds_read_b128 v[64:67], v230 offset:4096
  v_mfma_f32_16x16x32_bf16 v[172:175], v[100:103], v[84:87], v[172:175]
  ds_read_b128 v[68:71], v230 offset:6144
  v_mfma_f32_16x16x32_bf16 v[176:179], v[104:107], v[72:75], v[176:179]
  ds_read_b64_tr_b16 v[88:89], v232 offset:0
  v_mfma_f32_16x16x32_bf16 v[180:183], v[104:107], v[76:79], v[180:183]
  ds_read_b64_tr_b16 v[90:91], v232 offset:768
  v_mfma_f32_16x16x32_bf16 v[184:187], v[104:107], v[80:83], v[184:187]
  ds_read_b64_tr_b16 v[92:93], v232 offset:12320
  v_mfma_f32_16x16x32_bf16 v[188:191], v[104:107], v[84:87], v[188:191]
  ds_read_b64_tr_b16 v[94:95], v232 offset:13088
  v_mfma_f32_16x16x32_bf16 v[192:195], v[108:111], v[72:75], v[192:195]
  ds_read_b64_tr_b16 v[96:97], v232 offset:32
  v_mfma_f32_16x16x32_bf16 v[196:199], v[108:111], v[76:79], v[196:199]
  ds_read_b64_tr_b16 v[98:99], v232 offset:800
  v_mfma_f32_16x16x32_bf16 v[200:203], v[108:111], v[80:83], v[200:203]
  v_mfma_f32_16x16x32_bf16 v[204:207], v[108:111], v[84:87], v[204:207]
  s_waitcnt lgkmcnt(0)
  v_mfma_f32_16x16x32_bf16 v[112:115], v[88:91], v[56:59], v[112:115]
  ds_read_b64_tr_b16 v[100:101], v232 offset:12352
  v_mfma_f32_16x16x32_bf16 v[116:119], v[88:91], v[60:63], v[116:119]
  ds_read_b64_tr_b16 v[102:103], v232 offset:13120
  v_mfma_f32_16x16x32_bf16 v[120:123], v[88:91], v[64:67], v[120:123]
  ds_read_b64_tr_b16 v[104:105], v234 offset:64
  v_mfma_f32_16x16x32_bf16 v[124:127], v[88:91], v[68:71], v[124:127]
  ds_read_b64_tr_b16 v[106:107], v234 offset:832
  v_mfma_f32_16x16x32_bf16 v[128:131], v[92:95], v[56:59], v[128:131]
  ds_read_b64_tr_b16 v[108:109], v234 offset:12384
  v_mfma_f32_16x16x32_bf16 v[132:135], v[92:95], v[60:63], v[132:135]
  ds_read_b64_tr_b16 v[110:111], v234 offset:13152
  v_mfma_f32_16x16x32_bf16 v[136:139], v[92:95], v[64:67], v[136:139]
  ds_read_b128 v[72:75], v231 offset:0
  v_mfma_f32_16x16x32_bf16 v[140:143], v[92:95], v[68:71], v[140:143]
  ds_read_b128 v[76:79], v231 offset:2048
  v_mfma_f32_16x16x32_bf16 v[144:147], v[96:99], v[56:59], v[144:147]
  v_mfma_f32_16x16x32_bf16 v[148:151], v[96:99], v[60:63], v[148:151]
  v_mfma_f32_16x16x32_bf16 v[152:155], v[96:99], v[64:67], v[152:155]
  v_mfma_f32_16x16x32_bf16 v[156:159], v[96:99], v[68:71], v[156:159]
  s_waitcnt lgkmcnt(0)
  v_mfma_f32_16x16x32_bf16 v[160:163], v[100:103], v[56:59], v[160:163]
  ds_read_b64_tr_b16 v[88:89], v233 offset:6144
  v_mfma_f32_16x16x32_bf16 v[164:167], v[100:103], v[60:63], v[164:167]
  ds_read_b64_tr_b16 v[90:91], v233 offset:6912
  v_mfma_f32_16x16x32_bf16 v[168:171], v[100:103], v[64:67], v[168:171]
  ds_read_b64_tr_b16 v[92:93], v233 offset:18464
  v_mfma_f32_16x16x32_bf16 v[172:175], v[100:103], v[68:71], v[172:175]
  ds_read_b64_tr_b16 v[94:95], v233 offset:19232
  v_mfma_f32_16x16x32_bf16 v[176:179], v[104:107], v[56:59], v[176:179]
  ds_read_b64_tr_b16 v[96:97], v233 offset:6176
  v_mfma_f32_16x16x32_bf16 v[180:183], v[104:107], v[60:63], v[180:183]
  ds_read_b64_tr_b16 v[98:99], v233 offset:6944
  v_mfma_f32_16x16x32_bf16 v[184:187], v[104:107], v[64:67], v[184:187]
  ds_read_b128 v[80:83], v231 offset:4096
  v_mfma_f32_16x16x32_bf16 v[188:191], v[104:107], v[68:71], v[188:191]
  ds_read_b128 v[84:87], v231 offset:6144
  v_mfma_f32_16x16x32_bf16 v[192:195], v[108:111], v[56:59], v[192:195]
  v_mfma_f32_16x16x32_bf16 v[196:199], v[108:111], v[60:63], v[196:199]
  v_mfma_f32_16x16x32_bf16 v[200:203], v[108:111], v[64:67], v[200:203]
  v_mfma_f32_16x16x32_bf16 v[204:207], v[108:111], v[68:71], v[204:207]
  s_waitcnt lgkmcnt(0)
  v_mfma_f32_16x16x32_bf16 v[112:115], v[88:91], v[72:75], v[112:115]
  ds_read_b64_tr_b16 v[100:101], v233 offset:18496
  v_mfma_f32_16x16x32_bf16 v[116:119], v[88:91], v[76:79], v[116:119]
  ds_read_b64_tr_b16 v[102:103], v233 offset:19264
  v_mfma_f32_16x16x32_bf16 v[120:123], v[88:91], v[80:83], v[120:123]
  ds_read_b64_tr_b16 v[104:105], v235 offset:6208
  v_mfma_f32_16x16x32_bf16 v[124:127], v[88:91], v[84:87], v[124:127]
  ds_read_b64_tr_b16 v[106:107], v235 offset:6976
  v_mfma_f32_16x16x32_bf16 v[128:131], v[92:95], v[72:75], v[128:131]
  ds_read_b64_tr_b16 v[108:109], v235 offset:18528
  v_mfma_f32_16x16x32_bf16 v[132:135], v[92:95], v[76:79], v[132:135]
  ds_read_b64_tr_b16 v[110:111], v235 offset:19296
  v_mfma_f32_16x16x32_bf16 v[136:139], v[92:95], v[80:83], v[136:139]
  v_mfma_f32_16x16x32_bf16 v[140:143], v[92:95], v[84:87], v[140:143]
  v_add_u32 v230, 41024, v208
  v_add_u32 v231, 41024, v209
  v_mfma_f32_16x16x32_bf16 v[144:147], v[96:99], v[72:75], v[144:147]
  v_add_u32 v232, 41024, v210
  v_add_u32 v233, 41024, v211
  v_mfma_f32_16x16x32_bf16 v[148:151], v[96:99], v[76:79], v[148:151]
  v_add_u32 v234, 41024, v212
  v_add_u32 v235, 41024, v213
  v_mfma_f32_16x16x32_bf16 v[152:155], v[96:99], v[80:83], v[152:155]
  v_mfma_f32_16x16x32_bf16 v[156:159], v[96:99], v[84:87], v[156:159]
  s_waitcnt lgkmcnt(0)
  s_barrier
  v_mfma_f32_16x16x32_bf16 v[160:163], v[100:103], v[72:75], v[160:163]
  ds_read_b128 v[56:59], v230 offset:0
  v_mfma_f32_16x16x32_bf16 v[164:167], v[100:103], v[76:79], v[164:167]
  ds_read_b128 v[60:63], v230 offset:2048
  v_mfma_f32_16x16x32_bf16 v[168:171], v[100:103], v[80:83], v[168:171]
  ds_read_b128 v[64:67], v230 offset:4096
  v_mfma_f32_16x16x32_bf16 v[172:175], v[100:103], v[84:87], v[172:175]
  ds_read_b128 v[68:71], v230 offset:6144
  v_mfma_f32_16x16x32_bf16 v[176:179], v[104:107], v[72:75], v[176:179]
  ds_read_b64_tr_b16 v[88:89], v232 offset:0
  v_mfma_f32_16x16x32_bf16 v[180:183], v[104:107], v[76:79], v[180:183]
  ds_read_b64_tr_b16 v[90:91], v232 offset:768
  v_mfma_f32_16x16x32_bf16 v[184:187], v[104:107], v[80:83], v[184:187]
  ds_read_b64_tr_b16 v[92:93], v232 offset:12320
  v_mfma_f32_16x16x32_bf16 v[188:191], v[104:107], v[84:87], v[188:191]
  ds_read_b64_tr_b16 v[94:95], v232 offset:13088
  v_mfma_f32_16x16x32_bf16 v[192:195], v[108:111], v[72:75], v[192:195]
  ds_read_b64_tr_b16 v[96:97], v232 offset:32
  v_mfma_f32_16x16x32_bf16 v[196:199], v[108:111], v[76:79], v[196:199]
  ds_read_b64_tr_b16 v[98:99], v232 offset:800
  v_mfma_f32_16x16x32_bf16 v[200:203], v[108:111], v[80:83], v[200:203]
  ds_read_b128 v[8:11], v215 offset:0
  ds_read_b128 v[12:15], v215 offset:64
  ds_read_b128 v[16:19], v215 offset:256
  ds_read_b128 v[20:23], v215 offset:320
  ds_read_b128 v[24:27], v215 offset:512
  ds_read_b128 v[28:31], v215 offset:576
  v_mfma_f32_16x16x32_bf16 v[204:207], v[108:111], v[84:87], v[204:207]
  ds_read_b32 v48, v216 offset:0
  ds_read_b32 v49, v216 offset:64
  ds_read_b32 v50, v216 offset:128
  ds_read_b32 v51, v216 offset:192
  s_waitcnt lgkmcnt(0)
  v_mfma_f32_16x16x32_bf16 v[112:115], v[88:91], v[56:59], v[112:115]
  ds_read_b64_tr_b16 v[100:101], v232 offset:12352
  v_lshlrev_b32 v32, 16, v48
  v_mfma_f32_16x16x32_bf16 v[116:119], v[88:91], v[60:63], v[116:119]
  ds_read_b64_tr_b16 v[102:103], v232 offset:13120
  v_lshlrev_b32 v33, 16, v49
  v_mfma_f32_16x16x32_bf16 v[120:123], v[88:91], v[64:67], v[120:123]
  ds_read_b64_tr_b16 v[104:105], v234 offset:64
  v_lshlrev_b32 v34, 16, v50
  v_mfma_f32_16x16x32_bf16 v[124:127], v[88:91], v[68:71], v[124:127]
  ds_read_b64_tr_b16 v[106:107], v234 offset:832
  v_lshlrev_b32 v35, 16, v51
  v_mfma_f32_16x16x32_bf16 v[128:131], v[92:95], v[56:59], v[128:131]
  ds_read_b64_tr_b16 v[108:109], v234 offset:12384
  v_fma_f32 v160, -v32, v20, v160
  v_mfma_f32_16x16x32_bf16 v[132:135], v[92:95], v[60:63], v[132:135]
  ds_read_b64_tr_b16 v[110:111], v234 offset:13152
  v_fma_f32 v161, -v32, v21, v161
  v_mfma_f32_16x16x32_bf16 v[136:139], v[92:95], v[64:67], v[136:139]
  ds_read_b128 v[72:75], v231 offset:0
  v_fma_f32 v162, -v32, v22, v162
  v_mfma_f32_16x16x32_bf16 v[140:143], v[92:95], v[68:71], v[140:143]
  ds_read_b128 v[76:79], v231 offset:2048
  v_fma_f32 v163, -v32, v23, v163
  v_mfma_f32_16x16x32_bf16 v[144:147], v[96:99], v[56:59], v[144:147]
  v_fma_f32 v164, -v33, v20, v164
  v_fma_f32 v165, -v33, v21, v165
  v_mfma_f32_16x16x32_bf16 v[148:151], v[96:99], v[60:63], v[148:151]
  v_fma_f32 v166, -v33, v22, v166
  v_fma_f32 v167, -v33, v23, v167
  v_mfma_f32_16x16x32_bf16 v[152:155], v[96:99], v[64:67], v[152:155]
  v_fma_f32 v168, -v34, v20, v168
  v_fma_f32 v169, -v34, v21, v169
  v_mfma_f32_16x16x32_bf16 v[156:159], v[96:99], v[68:71], v[156:159]
  v_fma_f32 v170, -v34, v22, v170
  v_fma_f32 v171, -v34, v23, v171
  s_waitcnt lgkmcnt(0)
  v_mfma_f32_16x16x32_bf16 v[160:163], v[100:103], v[56:59], v[160:163]
  ds_read_b64_tr_b16 v[88:89], v233 offset:6144
  v_fma_f32 v112, -v32, v8, v112
  v_mfma_f32_16x16x32_bf16 v[164:167], v[100:103], v[60:63], v[164:167]
  ds_read_b64_tr_b16 v[90:91], v233 offset:6912
  v_fma_f32 v113, -v32, v9, v113
  v_mfma_f32_16x16x32_bf16 v[168:171], v[100:103], v[64:67], v[168:171]
  ds_read_b64_tr_b16 v[92:93], v233 offset:18464
  v_fma_f32 v114, -v32, v10, v114
  v_mfma_f32_16x16x32_bf16 v[172:175], v[100:103], v[68:71], v[172:175]
  ds_read_b64_tr_b16 v[94:95], v233 offset:19232
  v_fma_f32 v115, -v32, v11, v115
  v_mfma_f32_16x16x32_bf16 v[176:179], v[104:107], v[56:59], v[176:179]
  ds_read_b64_tr_b16 v[96:97], v233 offset:6176
  v_fma_f32 v116, -v33, v8, v116
  v_mfma_f32_16x16x32_bf16 v[180:183], v[104:107], v[60:63], v[180:183]
  ds_read_b64_tr_b16 v[98:99], v233 offset:6944
  v_fma_f32 v117, -v33, v9, v117
  v_mfma_f32_16x16x32_bf16 v[184:187], v[104:107], v[64:67], v[184:187]
  ds_read_b128 v[80:83], v231 offset:4096
  v_fma_f32 v118, -v33, v10, v118
  v_mfma_f32_16x16x32_bf16 v[188:191], v[104:107], v[68:71], v[188:191]
  ds_read_b128 v[84:87], v231 offset:6144
  v_fma_f32 v119, -v33, v11, v119
  v_mfma_f32_16x16x32_bf16 v[192:195], v[108:111], v[56:59], v[192:195]
  v_fma_f32 v120, -v34, v8, v120
  v_fma_f32 v121, -v34, v9, v121
  v_mfma_f32_16x16x32_bf16 v[196:199], v[108:111], v[60:63], v[196:199]
  v_fma_f32 v122, -v34, v10, v122
  v_fma_f32 v123, -v34, v11, v123
  v_mfma_f32_16x16x32_bf16 v[200:203], v[108:111], v[64:67], v[200:203]
  v_fma_f32 v124, -v35, v8, v124
  v_fma_f32 v125, -v35, v9, v125
  v_mfma_f32_16x16x32_bf16 v[204:207], v[108:111], v[68:71], v[204:207]
  v_fma_f32 v126, -v35, v10, v126
  v_fma_f32 v127, -v35, v11, v127
  s_waitcnt lgkmcnt(0)
  v_mfma_f32_16x16x32_bf16 v[112:115], v[88:91], v[72:75], v[112:115]
  ds_read_b64_tr_b16 v[100:101], v233 offset:18496
  v_fma_f32 v172, -v35, v20, v172
  v_mfma_f32_16x16x32_bf16 v[116:119], v[88:91], v[76:79], v[116:119]
  ds_read_b64_tr_b16 v[102:103], v233 offset:19264
  v_fma_f32 v173, -v35, v21, v173
  v_mfma_f32_16x16x32_bf16 v[120:123], v[88:91], v[80:83], v[120:123]
  ds_read_b64_tr_b16 v[104:105], v235 offset:6208
  v_fma_f32 v174, -v35, v22, v174
  v_mfma_f32_16x16x32_bf16 v[124:127], v[88:91], v[84:87], v[124:127]
  ds_read_b64_tr_b16 v[106:107], v235 offset:6976
  v_fma_f32 v175, -v35, v23, v175
  v_mfma_f32_16x16x32_bf16 v[128:131], v[92:95], v[72:75], v[128:131]
  ds_read_b64_tr_b16 v[108:109], v235 offset:18528
  v_fma_f32 v176, -v32, v24, v176
  v_mfma_f32_16x16x32_bf16 v[132:135], v[92:95], v[76:79], v[132:135]
  ds_read_b64_tr_b16 v[110:111], v235 offset:19296
  v_fma_f32 v177, -v32, v25, v177
  v_mfma_f32_16x16x32_bf16 v[136:139], v[92:95], v[80:83], v[136:139]
  v_fma_f32 v178, -v32, v26, v178
  v_fma_f32 v179, -v32, v27, v179
  v_mfma_f32_16x16x32_bf16 v[140:143], v[92:95], v[84:87], v[140:143]
  v_add_u32 v230, 82048, v208
  v_add_u32 v231, 82048, v209
  v_mfma_f32_16x16x32_bf16 v[144:147], v[96:99], v[72:75], v[144:147]
  v_add_u32 v232, 82048, v210
  v_add_u32 v233, 82048, v211
  v_mfma_f32_16x16x32_bf16 v[148:151], v[96:99], v[76:79], v[148:151]
  v_add_u32 v234, 82048, v212
  v_add_u32 v235, 82048, v213
  v_mfma_f32_16x16x32_bf16 v[152:155], v[96:99], v[80:83], v[152:155]
  v_fma_f32 v180, -v33, v24, v180
  v_fma_f32 v181, -v33, v25, v181
  v_mfma_f32_16x16x32_bf16 v[156:159], v[96:99], v[84:87], v[156:159]
  v_fma_f32 v182, -v33, v26, v182
  v_fma_f32 v183, -v33, v27, v183
  s_waitcnt lgkmcnt(0)
  s_barrier
  v_mfma_f32_16x16x32_bf16 v[160:163], v[100:103], v[72:75], v[160:163]
  ds_read_b128 v[56:59], v230 offset:0
  v_fma_f32 v128, -v32, v12, v128
  v_mfma_f32_16x16x32_bf16 v[164:167], v[100:103], v[76:79], v[164:167]
  ds_read_b128 v[60:63], v230 offset:2048
  v_fma_f32 v129, -v32, v13, v129
  v_mfma_f32_16x16x32_bf16 v[168:171], v[100:103], v[80:83], v[168:171]
  ds_read_b128 v[64:67], v230 offset:4096
  v_fma_f32 v130, -v32, v14, v130
  v_mfma_f32_16x16x32_bf16 v[172:175], v[100:103], v[84:87], v[172:175]
  ds_read_b128 v[68:71], v230 offset:6144
  v_fma_f32 v131, -v32, v15, v131
  v_mfma_f32_16x16x32_bf16 v[176:179], v[104:107], v[72:75], v[176:179]
  ds_read_b64_tr_b16 v[88:89], v232 offset:0
  v_fma_f32 v132, -v33, v12, v132
  v_mfma_f32_16x16x32_bf16 v[180:183], v[104:107], v[76:79], v[180:183]
  ds_read_b64_tr_b16 v[90:91], v232 offset:768
  v_fma_f32 v133, -v33, v13, v133
  v_mfma_f32_16x16x32_bf16 v[184:187], v[104:107], v[80:83], v[184:187]
  ds_read_b64_tr_b16 v[92:93], v232 offset:12320
  v_fma_f32 v134, -v33, v14, v134
  v_mfma_f32_16x16x32_bf16 v[188:191], v[104:107], v[84:87], v[188:191]
  ds_read_b64_tr_b16 v[94:95], v232 offset:13088
  v_fma_f32 v135, -v33, v15, v135
  v_mfma_f32_16x16x32_bf16 v[192:195], v[108:111], v[72:75], v[192:195]
  ds_read_b64_tr_b16 v[96:97], v232 offset:32
  v_fma_f32 v136, -v34, v12, v136
  v_mfma_f32_16x16x32_bf16 v[196:199], v[108:111], v[76:79], v[196:199]
  ds_read_b64_tr_b16 v[98:99], v232 offset:800
  v_fma_f32 v137, -v34, v13, v137
  v_mfma_f32_16x16x32_bf16 v[200:203], v[108:111], v[80:83], v[200:203]
  v_fma_f32 v138, -v34, v14, v138
  v_fma_f32 v139, -v34, v15, v139
  v_mfma_f32_16x16x32_bf16 v[204:207], v[108:111], v[84:87], v[204:207]
  v_fma_f32 v140, -v35, v12, v140
  v_fma_f32 v141, -v35, v13, v141
  s_waitcnt lgkmcnt(0)
  v_mfma_f32_16x16x32_bf16 v[112:115], v[88:91], v[56:59], v[112:115]
  ds_read_b64_tr_b16 v[100:101], v232 offset:12352
  v_fma_f32 v184, -v34, v24, v184
  v_mfma_f32_16x16x32_bf16 v[116:119], v[88:91], v[60:63], v[116:119]
  ds_read_b64_tr_b16 v[102:103], v232 offset:13120
  v_fma_f32 v185, -v34, v25, v185
  v_mfma_f32_16x16x32_bf16 v[120:123], v[88:91], v[64:67], v[120:123]
  ds_read_b64_tr_b16 v[104:105], v234 offset:64
  v_fma_f32 v186, -v34, v26, v186
  v_mfma_f32_16x16x32_bf16 v[124:127], v[88:91], v[68:71], v[124:127]
  ds_read_b64_tr_b16 v[106:107], v234 offset:832
  v_fma_f32 v187, -v34, v27, v187
  v_mfma_f32_16x16x32_bf16 v[128:131], v[92:95], v[56:59], v[128:131]
  ds_read_b64_tr_b16 v[108:109], v234 offset:12384
  v_fma_f32 v188, -v35, v24, v188
  v_mfma_f32_16x16x32_bf16 v[132:135], v[92:95], v[60:63], v[132:135]
  ds_read_b64_tr_b16 v[110:111], v234 offset:13152
  v_fma_f32 v189, -v35, v25, v189
  v_mfma_f32_16x16x32_bf16 v[136:139], v[92:95], v[64:67], v[136:139]
  ds_read_b128 v[72:75], v231 offset:0
  v_fma_f32 v190, -v35, v26, v190
  v_mfma_f32_16x16x32_bf16 v[140:143], v[92:95], v[68:71], v[140:143]
  ds_read_b128 v[76:79], v231 offset:2048
  v_fma_f32 v191, -v35, v27, v191
  v_mfma_f32_16x16x32_bf16 v[144:147], v[96:99], v[56:59], v[144:147]
  v_fma_f32 v192, -v32, v28, v192
  v_fma_f32 v193, -v32, v29, v193
  v_mfma_f32_16x16x32_bf16 v[148:151], v[96:99], v[60:63], v[148:151]
  v_fma_f32 v194, -v32, v30, v194
  v_fma_f32 v195, -v32, v31, v195
  v_mfma_f32_16x16x32_bf16 v[152:155], v[96:99], v[64:67], v[152:155]
  v_fma_f32 v196, -v33, v28, v196
  v_fma_f32 v197, -v33, v29, v197
  v_mfma_f32_16x16x32_bf16 v[156:159], v[96:99], v[68:71], v[156:159]
  v_fma_f32 v198, -v33, v30, v198
  v_fma_f32 v199, -v33, v31, v199
  s_waitcnt lgkmcnt(0)
  v_mfma_f32_16x16x32_bf16 v[160:163], v[100:103], v[56:59], v[160:163]
  ds_read_b64_tr_b16 v[88:89], v233 offset:6144
  v_fma_f32 v142, -v35, v14, v142
  v_mfma_f32_16x16x32_bf16 v[164:167], v[100:103], v[60:63], v[164:167]
  ds_read_b64_tr_b16 v[90:91], v233 offset:6912
  v_fma_f32 v143, -v35, v15, v143
  v_mfma_f32_16x16x32_bf16 v[168:171], v[100:103], v[64:67], v[168:171]
  ds_read_b64_tr_b16 v[92:93], v233 offset:18464
  v_fma_f32 v144, -v32, v16, v144
  v_mfma_f32_16x16x32_bf16 v[172:175], v[100:103], v[68:71], v[172:175]
  ds_read_b64_tr_b16 v[94:95], v233 offset:19232
  v_fma_f32 v145, -v32, v17, v145
  v_mfma_f32_16x16x32_bf16 v[176:179], v[104:107], v[56:59], v[176:179]
  ds_read_b64_tr_b16 v[96:97], v233 offset:6176
  v_fma_f32 v146, -v32, v18, v146
  v_mfma_f32_16x16x32_bf16 v[180:183], v[104:107], v[60:63], v[180:183]
  ds_read_b64_tr_b16 v[98:99], v233 offset:6944
  v_fma_f32 v147, -v32, v19, v147
  v_mfma_f32_16x16x32_bf16 v[184:187], v[104:107], v[64:67], v[184:187]
  ds_read_b128 v[80:83], v231 offset:4096
  v_fma_f32 v148, -v33, v16, v148
  v_mfma_f32_16x16x32_bf16 v[188:191], v[104:107], v[68:71], v[188:191]
  ds_read_b128 v[84:87], v231 offset:6144
  v_fma_f32 v149, -v33, v17, v149
  v_mfma_f32_16x16x32_bf16 v[192:195], v[108:111], v[56:59], v[192:195]
  v_fma_f32 v150, -v33, v18, v150
  v_fma_f32 v151, -v33, v19, v151
  v_mfma_f32_16x16x32_bf16 v[196:199], v[108:111], v[60:63], v[196:199]
  v_fma_f32 v152, -v34, v16, v152
  v_fma_f32 v153, -v34, v17, v153
  v_mfma_f32_16x16x32_bf16 v[200:203], v[108:111], v[64:67], v[200:203]
  v_fma_f32 v154, -v34, v18, v154
  v_fma_f32 v155, -v34, v19, v155
  v_mfma_f32_16x16x32_bf16 v[204:207], v[108:111], v[68:71], v[204:207]
  v_fma_f32 v156, -v35, v16, v156
  v_fma_f32 v157, -v35, v17, v157
  s_waitcnt lgkmcnt(0)
  v_mfma_f32_16x16x32_bf16 v[112:115], v[88:91], v[72:75], v[112:115]
  ds_read_b64_tr_b16 v[100:101], v233 offset:18496
  v_fma_f32 v200, -v34, v28, v200
  v_mfma_f32_16x16x32_bf16 v[116:119], v[88:91], v[76:79], v[116:119]
  ds_read_b64_tr_b16 v[102:103], v233 offset:19264
  v_fma_f32 v201, -v34, v29, v201
  v_mfma_f32_16x16x32_bf16 v[120:123], v[88:91], v[80:83], v[120:123]
  ds_read_b64_tr_b16 v[104:105], v235 offset:6208
  v_fma_f32 v202, -v34, v30, v202
  v_mfma_f32_16x16x32_bf16 v[124:127], v[88:91], v[84:87], v[124:127]
  ds_read_b64_tr_b16 v[106:107], v235 offset:6976
  v_fma_f32 v203, -v34, v31, v203
  v_mfma_f32_16x16x32_bf16 v[128:131], v[92:95], v[72:75], v[128:131]
  ds_read_b64_tr_b16 v[108:109], v235 offset:18528
  v_fma_f32 v204, -v35, v28, v204
  v_mfma_f32_16x16x32_bf16 v[132:135], v[92:95], v[76:79], v[132:135]
  ds_read_b64_tr_b16 v[110:111], v235 offset:19296
  v_fma_f32 v205, -v35, v29, v205
  v_mfma_f32_16x16x32_bf16 v[136:139], v[92:95], v[80:83], v[136:139]
  v_fma_f32 v206, -v35, v30, v206
  v_fma_f32 v207, -v35, v31, v207
  v_mfma_f32_16x16x32_bf16 v[140:143], v[92:95], v[84:87], v[140:143]
  v_add_u32 v230, 0, v208
  v_add_u32 v231, 0, v209
  v_mfma_f32_16x16x32_bf16 v[144:147], v[96:99], v[72:75], v[144:147]
  v_add_u32 v232, 0, v210
  v_add_u32 v233, 0, v211
  v_mfma_f32_16x16x32_bf16 v[148:151], v[96:99], v[76:79], v[148:151]
  v_add_u32 v234, 0, v212
  v_add_u32 v235, 0, v213
  v_mfma_f32_16x16x32_bf16 v[152:155], v[96:99], v[80:83], v[152:155]
  v_and_b32 v52, 0xffff0000, v48
  v_rcp_f32 v53, v52
  v_mfma_f32_16x16x32_bf16 v[156:159], v[96:99], v[84:87], v[156:159]
  v_mul_f32 v240, v52, v52
  v_mul_f32 v236, 0xc0135761, v53
  s_waitcnt lgkmcnt(0)
  s_barrier
  v_mfma_f32_16x16x32_bf16 v[160:163], v[100:103], v[72:75], v[160:163]
  ds_read_b128 v[56:59], v230 offset:0
  s_nop 1
  v_fma_f32 v158, -v35, v18, v158
  v_mfma_f32_16x16x32_bf16 v[164:167], v[100:103], v[76:79], v[164:167]
  ds_read_b128 v[60:63], v230 offset:2048
  v_fma_f32 v159, -v35, v19, v159
  v_mfma_f32_16x16x32_bf16 v[168:171], v[100:103], v[80:83], v[168:171]
  ds_read_b128 v[64:67], v230 offset:4096
  v_mul_f32 v54, v53, v53
  v_mfma_f32_16x16x32_bf16 v[172:175], v[100:103], v[84:87], v[172:175]
  ds_read_b128 v[68:71], v230 offset:6144
  v_mul_f32 v54, v54, v53
  v_mfma_f32_16x16x32_bf16 v[176:179], v[104:107], v[72:75], v[176:179]
  ds_read_b64_tr_b16 v[88:89], v232 offset:0
  v_mul_f32 v238, 0xbdd2d3e8, v54
  v_mfma_f32_16x16x32_bf16 v[180:183], v[104:107], v[76:79], v[180:183]
  ds_read_b64_tr_b16 v[90:91], v232 offset:768
  v_and_b32 v52, 0xffff0000, v49
  v_mfma_f32_16x16x32_bf16 v[184:187], v[104:107], v[80:83], v[184:187]
  ds_read_b64_tr_b16 v[92:93], v232 offset:12320
  v_rcp_f32 v53, v52
  v_mfma_f32_16x16x32_bf16 v[188:191], v[104:107], v[84:87], v[188:191]
  ds_read_b64_tr_b16 v[94:95], v232 offset:13088
  v_mul_f32 v246, v52, v52
  v_mfma_f32_16x16x32_bf16 v[192:195], v[108:111], v[72:75], v[192:195]
  ds_read_b64_tr_b16 v[96:97], v232 offset:32
  v_mul_f32 v242, 0xc0135761, v53
  v_mfma_f32_16x16x32_bf16 v[196:199], v[108:111], v[76:79], v[196:199]
  ds_read_b64_tr_b16 v[98:99], v232 offset:800
  v_mul_f32 v54, v53, v53
  v_mfma_f32_16x16x32_bf16 v[200:203], v[108:111], v[80:83], v[200:203]
  v_mul_f32 v54, v54, v53
  v_mul_f32 v244, 0xbdd2d3e8, v54
  v_mfma_f32_16x16x32_bf16 v[204:207], v[108:111], v[84:87], v[204:207]
  v_and_b32 v52, 0xffff0000, v50
  v_rcp_f32 v53, v52
  s_waitcnt lgkmcnt(0)
  v_mfma_f32_16x16x32_bf16 v[112:115], v[88:91], v[56:59], v[112:115]
  ds_read_b64_tr_b16 v[100:101], v232 offset:12352
  v_mul_f32 v252, v52, v52
  v_mfma_f32_16x16x32_bf16 v[116:119], v[88:91], v[60:63], v[116:119]
  ds_read_b64_tr_b16 v[102:103], v232 offset:13120
  v_mul_f32 v248, 0xc0135761, v53
  v_mfma_f32_16x16x32_bf16 v[120:123], v[88:91], v[64:67], v[120:123]
  ds_read_b64_tr_b16 v[104:105], v234 offset:64
  v_mul_f32 v54, v53, v53
  v_mfma_f32_16x16x32_bf16 v[124:127], v[88:91], v[68:71], v[124:127]
  ds_read_b64_tr_b16 v[106:107], v234 offset:832
  v_mul_f32 v54, v54, v53
  v_mfma_f32_16x16x32_bf16 v[128:131], v[92:95], v[56:59], v[128:131]
  ds_read_b64_tr_b16 v[108:109], v234 offset:12384
  v_mul_f32 v250, 0xbdd2d3e8, v54
  v_mfma_f32_16x16x32_bf16 v[132:135], v[92:95], v[60:63], v[132:135]
  ds_read_b64_tr_b16 v[110:111], v234 offset:13152
  v_and_b32 v52, 0xffff0000, v51
  v_mfma_f32_16x16x32_bf16 v[136:139], v[92:95], v[64:67], v[136:139]
  ds_read_b128 v[72:75], v231 offset:0
  v_rcp_f32 v53, v52
  v_mfma_f32_16x16x32_bf16 v[140:143], v[92:95], v[68:71], v[140:143]
  ds_read_b128 v[76:79], v231 offset:2048
  v_mul_f32 v6, v52, v52
  v_mfma_f32_16x16x32_bf16 v[144:147], v[96:99], v[56:59], v[144:147]
  v_mul_f32 v2, 0xc0135761, v53
  v_mul_f32 v54, v53, v53
  v_mfma_f32_16x16x32_bf16 v[148:151], v[96:99], v[60:63], v[148:151]
  v_mul_f32 v54, v54, v53
  v_mul_f32 v4, 0xbdd2d3e8, v54
  v_mfma_f32_16x16x32_bf16 v[152:155], v[96:99], v[64:67], v[152:155]
  v_mfma_f32_16x16x32_bf16 v[156:159], v[96:99], v[68:71], v[156:159]
  s_waitcnt lgkmcnt(0)
  v_mfma_f32_16x16x32_bf16 v[160:163], v[100:103], v[56:59], v[160:163]
  ds_read_b64_tr_b16 v[88:89], v233 offset:6144
  v_mfma_f32_16x16x32_bf16 v[164:167], v[100:103], v[60:63], v[164:167]
  ds_read_b64_tr_b16 v[90:91], v233 offset:6912
  v_mfma_f32_16x16x32_bf16 v[168:171], v[100:103], v[64:67], v[168:171]
  ds_read_b64_tr_b16 v[92:93], v233 offset:18464
  v_mfma_f32_16x16x32_bf16 v[172:175], v[100:103], v[68:71], v[172:175]
  ds_read_b64_tr_b16 v[94:95], v233 offset:19232
  v_mfma_f32_16x16x32_bf16 v[176:179], v[104:107], v[56:59], v[176:179]
  ds_read_b64_tr_b16 v[96:97], v233 offset:6176
  v_mfma_f32_16x16x32_bf16 v[180:183], v[104:107], v[60:63], v[180:183]
  ds_read_b64_tr_b16 v[98:99], v233 offset:6944
  v_mfma_f32_16x16x32_bf16 v[184:187], v[104:107], v[64:67], v[184:187]
  ds_read_b128 v[80:83], v231 offset:4096
  v_mfma_f32_16x16x32_bf16 v[188:191], v[104:107], v[68:71], v[188:191]
  ds_read_b128 v[84:87], v231 offset:6144
  v_mfma_f32_16x16x32_bf16 v[192:195], v[108:111], v[56:59], v[192:195]
  v_mfma_f32_16x16x32_bf16 v[196:199], v[108:111], v[60:63], v[196:199]
  v_mfma_f32_16x16x32_bf16 v[200:203], v[108:111], v[64:67], v[200:203]
  v_mfma_f32_16x16x32_bf16 v[204:207], v[108:111], v[68:71], v[204:207]
  s_waitcnt lgkmcnt(0)
  v_mfma_f32_16x16x32_bf16 v[112:115], v[88:91], v[72:75], v[112:115]
  ds_read_b64_tr_b16 v[100:101], v233 offset:18496
  v_mfma_f32_16x16x32_bf16 v[116:119], v[88:91], v[76:79], v[116:119]
  ds_read_b64_tr_b16 v[102:103], v233 offset:19264
  v_mfma_f32_16x16x32_bf16 v[120:123], v[88:91], v[80:83], v[120:123]
  ds_read_b64_tr_b16 v[104:105], v235 offset:6208
  v_mfma_f32_16x16x32_bf16 v[124:127], v[88:91], v[84:87], v[124:127]
  ds_read_b64_tr_b16 v[106:107], v235 offset:6976
  v_mfma_f32_16x16x32_bf16 v[128:131], v[92:95], v[72:75], v[128:131]
  ds_read_b64_tr_b16 v[108:109], v235 offset:18528
  v_mfma_f32_16x16x32_bf16 v[132:135], v[92:95], v[76:79], v[132:135]
  ds_read_b64_tr_b16 v[110:111], v235 offset:19296
  v_mfma_f32_16x16x32_bf16 v[136:139], v[92:95], v[80:83], v[136:139]
  v_mfma_f32_16x16x32_bf16 v[140:143], v[92:95], v[84:87], v[140:143]
  v_mfma_f32_16x16x32_bf16 v[144:147], v[96:99], v[72:75], v[144:147]
  v_mfma_f32_16x16x32_bf16 v[148:151], v[96:99], v[76:79], v[148:151]
  v_mfma_f32_16x16x32_bf16 v[152:155], v[96:99], v[80:83], v[152:155]
  v_mfma_f32_16x16x32_bf16 v[156:159], v[96:99], v[84:87], v[156:159]
  s_waitcnt lgkmcnt(0)
  s_barrier
  v_mfma_f32_16x16x32_bf16 v[160:163], v[100:103], v[72:75], v[160:163]
  v_mfma_f32_16x16x32_bf16 v[164:167], v[100:103], v[76:79], v[164:167]
  v_mfma_f32_16x16x32_bf16 v[168:171], v[100:103], v[80:83], v[168:171]
  v_mfma_f32_16x16x32_bf16 v[172:175], v[100:103], v[84:87], v[172:175]
  v_mfma_f32_16x16x32_bf16 v[176:179], v[104:107], v[72:75], v[176:179]
  v_mfma_f32_16x16x32_bf16 v[180:183], v[104:107], v[76:79], v[180:183]
  v_mfma_f32_16x16x32_bf16 v[184:187], v[104:107], v[80:83], v[184:187]
  v_mfma_f32_16x16x32_bf16 v[188:191], v[104:107], v[84:87], v[188:191]
  v_mfma_f32_16x16x32_bf16 v[192:195], v[108:111], v[72:75], v[192:195]
  v_mfma_f32_16x16x32_bf16 v[196:199], v[108:111], v[76:79], v[196:199]
  v_mfma_f32_16x16x32_bf16 v[200:203], v[108:111], v[80:83], v[200:203]
  v_mfma_f32_16x16x32_bf16 v[204:207], v[108:111], v[84:87], v[204:207]
  v_pk_mul_f32 v[56:57], v[112:113], v[112:113]
  v_pk_mul_f32 v[58:59], v[114:115], v[114:115]
  v_pk_mul_f32 v[60:61], v[144:145], v[144:145]
  v_pk_mul_f32 v[62:63], v[146:147], v[146:147]
  v_pk_fma_f32 v[56:57], v[56:57], v[238:239], v[236:237] op_sel_hi:[1,0,0]
  v_pk_fma_f32 v[58:59], v[58:59], v[238:239], v[236:237] op_sel_hi:[1,0,0]
  v_pk_fma_f32 v[60:61], v[60:61], v[238:239], v[236:237] op_sel_hi:[1,0,0]
  v_pk_fma_f32 v[62:63], v[62:63], v[238:239], v[236:237] op_sel_hi:[1,0,0]
  v_pk_mul_f32 v[64:65], v[112:113], v[56:57]
  v_pk_mul_f32 v[66:67], v[114:115], v[58:59]
  v_pk_mul_f32 v[68:69], v[144:145], v[60:61]
  v_pk_mul_f32 v[70:71], v[146:147], v[62:63]
  v_exp_f32 v72, v64
  v_exp_f32 v73, v65
  v_exp_f32 v74, v66
  v_exp_f32 v75, v67
  v_exp_f32 v76, v68
  v_exp_f32 v77, v69
  v_exp_f32 v78, v70
  v_exp_f32 v79, v71
  v_pk_mul_f32 v[80:81], v[112:113], v[128:129]
  v_pk_mul_f32 v[82:83], v[114:115], v[130:131]
  v_pk_mul_f32 v[84:85], v[144:145], v[160:161]
  v_pk_mul_f32 v[86:87], v[146:147], v[162:163]
  v_pk_fma_f32 v[56:57], v[72:73], v[240:241], v[240:241] op_sel_hi:[1,0,0]
  v_pk_fma_f32 v[58:59], v[74:75], v[240:241], v[240:241] op_sel_hi:[1,0,0]
  v_pk_fma_f32 v[60:61], v[76:77], v[240:241], v[240:241] op_sel_hi:[1,0,0]
  v_pk_fma_f32 v[62:63], v[78:79], v[240:241], v[240:241] op_sel_hi:[1,0,0]
  v_rcp_f32 v64, v56
  v_rcp_f32 v65, v57
  v_rcp_f32 v66, v58
  v_rcp_f32 v67, v59
  v_rcp_f32 v68, v60
  v_rcp_f32 v69, v61
  v_rcp_f32 v70, v62
  v_rcp_f32 v71, v63
  v_pk_mul_f32 v[80:81], v[80:81], v[64:65]
  v_pk_mul_f32 v[82:83], v[82:83], v[66:67]
  v_pk_mul_f32 v[84:85], v[84:85], v[68:69]
  v_pk_mul_f32 v[86:87], v[86:87], v[70:71]
  v_cvt_pk_bf16_f32 v8, v80, v81
  v_cvt_pk_bf16_f32 v9, v82, v83
  v_cvt_pk_bf16_f32 v10, v84, v85
  v_cvt_pk_bf16_f32 v11, v86, v87
  buffer_store_dwordx4 v[8:11], v228, s[28:31], s64 offen sc1
  s_add_u32 s64, s64, 50304
  v_pk_mul_f32 v[56:57], v[116:117], v[116:117]
  v_pk_mul_f32 v[58:59], v[118:119], v[118:119]
  v_pk_mul_f32 v[60:61], v[148:149], v[148:149]
  v_pk_mul_f32 v[62:63], v[150:151], v[150:151]
  v_pk_fma_f32 v[56:57], v[56:57], v[244:245], v[242:243] op_sel_hi:[1,0,0]
  v_pk_fma_f32 v[58:59], v[58:59], v[244:245], v[242:243] op_sel_hi:[1,0,0]
  v_pk_fma_f32 v[60:61], v[60:61], v[244:245], v[242:243] op_sel_hi:[1,0,0]
  v_pk_fma_f32 v[62:63], v[62:63], v[244:245], v[242:243] op_sel_hi:[1,0,0]
  v_pk_mul_f32 v[64:65], v[116:117], v[56:57]
  v_pk_mul_f32 v[66:67], v[118:119], v[58:59]
  v_pk_mul_f32 v[68:69], v[148:149], v[60:61]
  v_pk_mul_f32 v[70:71], v[150:151], v[62:63]
  v_exp_f32 v72, v64
  v_exp_f32 v73, v65
  v_exp_f32 v74, v66
  v_exp_f32 v75, v67
  v_exp_f32 v76, v68
  v_exp_f32 v77, v69
  v_exp_f32 v78, v70
  v_exp_f32 v79, v71
  v_pk_mul_f32 v[80:81], v[116:117], v[132:133]
  v_pk_mul_f32 v[82:83], v[118:119], v[134:135]
  v_pk_mul_f32 v[84:85], v[148:149], v[164:165]
  v_pk_mul_f32 v[86:87], v[150:151], v[166:167]
  v_pk_fma_f32 v[56:57], v[72:73], v[246:247], v[246:247] op_sel_hi:[1,0,0]
  v_pk_fma_f32 v[58:59], v[74:75], v[246:247], v[246:247] op_sel_hi:[1,0,0]
  v_pk_fma_f32 v[60:61], v[76:77], v[246:247], v[246:247] op_sel_hi:[1,0,0]
  v_pk_fma_f32 v[62:63], v[78:79], v[246:247], v[246:247] op_sel_hi:[1,0,0]
  v_rcp_f32 v64, v56
  v_rcp_f32 v65, v57
  v_rcp_f32 v66, v58
  v_rcp_f32 v67, v59
  v_rcp_f32 v68, v60
  v_rcp_f32 v69, v61
  v_rcp_f32 v70, v62
  v_rcp_f32 v71, v63
  v_pk_mul_f32 v[80:81], v[80:81], v[64:65]
  v_pk_mul_f32 v[82:83], v[82:83], v[66:67]
  v_pk_mul_f32 v[84:85], v[84:85], v[68:69]
  v_pk_mul_f32 v[86:87], v[86:87], v[70:71]
  v_cvt_pk_bf16_f32 v12, v80, v81
  v_cvt_pk_bf16_f32 v13, v82, v83
  v_cvt_pk_bf16_f32 v14, v84, v85
  v_cvt_pk_bf16_f32 v15, v86, v87
  buffer_store_dwordx4 v[12:15], v228, s[28:31], s64 offen sc1
  s_add_u32 s64, s64, 50304
  v_pk_mul_f32 v[56:57], v[120:121], v[120:121]
  v_pk_mul_f32 v[58:59], v[122:123], v[122:123]
  v_pk_mul_f32 v[60:61], v[152:153], v[152:153]
  v_pk_mul_f32 v[62:63], v[154:155], v[154:155]
  v_pk_fma_f32 v[56:57], v[56:57], v[250:251], v[248:249] op_sel_hi:[1,0,0]
  v_pk_fma_f32 v[58:59], v[58:59], v[250:251], v[248:249] op_sel_hi:[1,0,0]
  v_pk_fma_f32 v[60:61], v[60:61], v[250:251], v[248:249] op_sel_hi:[1,0,0]
  v_pk_fma_f32 v[62:63], v[62:63], v[250:251], v[248:249] op_sel_hi:[1,0,0]
  v_pk_mul_f32 v[64:65], v[120:121], v[56:57]
  v_pk_mul_f32 v[66:67], v[122:123], v[58:59]
  v_pk_mul_f32 v[68:69], v[152:153], v[60:61]
  v_pk_mul_f32 v[70:71], v[154:155], v[62:63]
  v_exp_f32 v72, v64
  v_exp_f32 v73, v65
  v_exp_f32 v74, v66
  v_exp_f32 v75, v67
  v_exp_f32 v76, v68
  v_exp_f32 v77, v69
  v_exp_f32 v78, v70
  v_exp_f32 v79, v71
  v_pk_mul_f32 v[80:81], v[120:121], v[136:137]
  v_pk_mul_f32 v[82:83], v[122:123], v[138:139]
  v_pk_mul_f32 v[84:85], v[152:153], v[168:169]
  v_pk_mul_f32 v[86:87], v[154:155], v[170:171]
  v_pk_fma_f32 v[56:57], v[72:73], v[252:253], v[252:253] op_sel_hi:[1,0,0]
  v_pk_fma_f32 v[58:59], v[74:75], v[252:253], v[252:253] op_sel_hi:[1,0,0]
  v_pk_fma_f32 v[60:61], v[76:77], v[252:253], v[252:253] op_sel_hi:[1,0,0]
  v_pk_fma_f32 v[62:63], v[78:79], v[252:253], v[252:253] op_sel_hi:[1,0,0]
  v_rcp_f32 v64, v56
  v_rcp_f32 v65, v57
  v_rcp_f32 v66, v58
  v_rcp_f32 v67, v59
  v_rcp_f32 v68, v60
  v_rcp_f32 v69, v61
  v_rcp_f32 v70, v62
  v_rcp_f32 v71, v63
  v_pk_mul_f32 v[80:81], v[80:81], v[64:65]
  v_pk_mul_f32 v[82:83], v[82:83], v[66:67]
  v_pk_mul_f32 v[84:85], v[84:85], v[68:69]
  v_pk_mul_f32 v[86:87], v[86:87], v[70:71]
  v_cvt_pk_bf16_f32 v8, v80, v81
  v_cvt_pk_bf16_f32 v9, v82, v83
  v_cvt_pk_bf16_f32 v10, v84, v85
  v_cvt_pk_bf16_f32 v11, v86, v87
  buffer_store_dwordx4 v[8:11], v228, s[28:31], s64 offen sc1
  s_add_u32 s64, s64, 50304
  v_pk_mul_f32 v[56:57], v[124:125], v[124:125]
  v_pk_mul_f32 v[58:59], v[126:127], v[126:127]
  v_pk_mul_f32 v[60:61], v[156:157], v[156:157]
  v_pk_mul_f32 v[62:63], v[158:159], v[158:159]
  v_pk_fma_f32 v[56:57], v[56:57], v[4:5], v[2:3] op_sel_hi:[1,0,0]
  v_pk_fma_f32 v[58:59], v[58:59], v[4:5], v[2:3] op_sel_hi:[1,0,0]
  v_pk_fma_f32 v[60:61], v[60:61], v[4:5], v[2:3] op_sel_hi:[1,0,0]
  v_pk_fma_f32 v[62:63], v[62:63], v[4:5], v[2:3] op_sel_hi:[1,0,0]
  v_pk_mul_f32 v[64:65], v[124:125], v[56:57]
  v_pk_mul_f32 v[66:67], v[126:127], v[58:59]
  v_pk_mul_f32 v[68:69], v[156:157], v[60:61]
  v_pk_mul_f32 v[70:71], v[158:159], v[62:63]
  v_exp_f32 v72, v64
  v_exp_f32 v73, v65
  v_exp_f32 v74, v66
  v_exp_f32 v75, v67
  v_exp_f32 v76, v68
  v_exp_f32 v77, v69
  v_exp_f32 v78, v70
  v_exp_f32 v79, v71
  v_pk_mul_f32 v[80:81], v[124:125], v[140:141]
  v_pk_mul_f32 v[82:83], v[126:127], v[142:143]
  v_pk_mul_f32 v[84:85], v[156:157], v[172:173]
  v_pk_mul_f32 v[86:87], v[158:159], v[174:175]
  v_pk_fma_f32 v[56:57], v[72:73], v[6:7], v[6:7] op_sel_hi:[1,0,0]
  v_pk_fma_f32 v[58:59], v[74:75], v[6:7], v[6:7] op_sel_hi:[1,0,0]
  v_pk_fma_f32 v[60:61], v[76:77], v[6:7], v[6:7] op_sel_hi:[1,0,0]
  v_pk_fma_f32 v[62:63], v[78:79], v[6:7], v[6:7] op_sel_hi:[1,0,0]
  v_rcp_f32 v64, v56
  v_rcp_f32 v65, v57
  v_rcp_f32 v66, v58
  v_rcp_f32 v67, v59
  v_rcp_f32 v68, v60
  v_rcp_f32 v69, v61
  v_rcp_f32 v70, v62
  v_rcp_f32 v71, v63
  v_pk_mul_f32 v[80:81], v[80:81], v[64:65]
  v_pk_mul_f32 v[82:83], v[82:83], v[66:67]
  v_pk_mul_f32 v[84:85], v[84:85], v[68:69]
  v_pk_mul_f32 v[86:87], v[86:87], v[70:71]
  v_cvt_pk_bf16_f32 v12, v80, v81
  v_cvt_pk_bf16_f32 v13, v82, v83
  v_cvt_pk_bf16_f32 v14, v84, v85
  v_cvt_pk_bf16_f32 v15, v86, v87
  buffer_store_dwordx4 v[12:15], v228, s[28:31], s64 offen sc1
  v_pk_mul_f32 v[56:57], v[176:177], v[176:177]
  v_pk_mul_f32 v[58:59], v[178:179], v[178:179]
  v_pk_mul_f32 v[60:61], v[180:181], v[180:181]
  v_pk_mul_f32 v[62:63], v[182:183], v[182:183]
  v_pk_fma_f32 v[56:57], v[56:57], v[238:239], v[236:237] op_sel_hi:[1,0,0]
  v_pk_fma_f32 v[58:59], v[58:59], v[238:239], v[236:237] op_sel_hi:[1,0,0]
  v_pk_fma_f32 v[60:61], v[60:61], v[244:245], v[242:243] op_sel_hi:[1,0,0]
  v_pk_fma_f32 v[62:63], v[62:63], v[244:245], v[242:243] op_sel_hi:[1,0,0]
  v_pk_mul_f32 v[64:65], v[176:177], v[56:57]
  v_pk_mul_f32 v[66:67], v[178:179], v[58:59]
  v_pk_mul_f32 v[68:69], v[180:181], v[60:61]
  v_pk_mul_f32 v[70:71], v[182:183], v[62:63]
  v_exp_f32 v72, v64
  v_exp_f32 v73, v65
  v_exp_f32 v74, v66
  v_exp_f32 v75, v67
  v_exp_f32 v76, v68
  v_exp_f32 v77, v69
  v_exp_f32 v78, v70
  v_exp_f32 v79, v71
  v_pk_mul_f32 v[80:81], v[176:177], v[192:193]
  v_pk_mul_f32 v[82:83], v[178:179], v[194:195]
  v_pk_mul_f32 v[84:85], v[180:181], v[196:197]
  v_pk_mul_f32 v[86:87], v[182:183], v[198:199]
  v_pk_fma_f32 v[56:57], v[72:73], v[240:241], v[240:241] op_sel_hi:[1,0,0]
  v_pk_fma_f32 v[58:59], v[74:75], v[240:241], v[240:241] op_sel_hi:[1,0,0]
  v_pk_fma_f32 v[60:61], v[76:77], v[246:247], v[246:247] op_sel_hi:[1,0,0]
  v_pk_fma_f32 v[62:63], v[78:79], v[246:247], v[246:247] op_sel_hi:[1,0,0]
  v_rcp_f32 v64, v56
  v_rcp_f32 v65, v57
  v_rcp_f32 v66, v58
  v_rcp_f32 v67, v59
  v_rcp_f32 v68, v60
  v_rcp_f32 v69, v61
  v_rcp_f32 v70, v62
  v_rcp_f32 v71, v63
  v_pk_mul_f32 v[80:81], v[80:81], v[64:65]
  v_pk_mul_f32 v[82:83], v[82:83], v[66:67]
  v_pk_mul_f32 v[84:85], v[84:85], v[68:69]
  v_pk_mul_f32 v[86:87], v[86:87], v[70:71]
  v_cvt_pk_bf16_f32 v16, v80, v81
  v_cvt_pk_bf16_f32 v17, v82, v83
  v_cvt_pk_bf16_f32 v18, v84, v85
  v_cvt_pk_bf16_f32 v19, v86, v87
  s_nop 0
  v_permlane16_swap_b32 v16, v18
  v_permlane16_swap_b32 v17, v19
  buffer_store_dwordx4 v[16:19], v229, s[28:31], s65 offen sc1
  s_add_u32 s65, s65, 100608
  v_pk_mul_f32 v[56:57], v[184:185], v[184:185]
  v_pk_mul_f32 v[58:59], v[186:187], v[186:187]
  v_pk_mul_f32 v[60:61], v[188:189], v[188:189]
  v_pk_mul_f32 v[62:63], v[190:191], v[190:191]
  v_pk_fma_f32 v[56:57], v[56:57], v[250:251], v[248:249] op_sel_hi:[1,0,0]
  v_pk_fma_f32 v[58:59], v[58:59], v[250:251], v[248:249] op_sel_hi:[1,0,0]
  v_pk_fma_f32 v[60:61], v[60:61], v[4:5], v[2:3] op_sel_hi:[1,0,0]
  v_pk_fma_f32 v[62:63], v[62:63], v[4:5], v[2:3] op_sel_hi:[1,0,0]
  v_pk_mul_f32 v[64:65], v[184:185], v[56:57]
  v_pk_mul_f32 v[66:67], v[186:187], v[58:59]
  v_pk_mul_f32 v[68:69], v[188:189], v[60:61]
  v_pk_mul_f32 v[70:71], v[190:191], v[62:63]
  v_exp_f32 v72, v64
  v_exp_f32 v73, v65
  v_exp_f32 v74, v66
  v_exp_f32 v75, v67
  v_exp_f32 v76, v68
  v_exp_f32 v77, v69
  v_exp_f32 v78, v70
  v_exp_f32 v79, v71
  v_pk_mul_f32 v[80:81], v[184:185], v[200:201]
  v_pk_mul_f32 v[82:83], v[186:187], v[202:203]
  v_pk_mul_f32 v[84:85], v[188:189], v[204:205]
  v_pk_mul_f32 v[86:87], v[190:191], v[206:207]
  v_pk_fma_f32 v[56:57], v[72:73], v[252:253], v[252:253] op_sel_hi:[1,0,0]
  v_pk_fma_f32 v[58:59], v[74:75], v[252:253], v[252:253] op_sel_hi:[1,0,0]
  v_pk_fma_f32 v[60:61], v[76:77], v[6:7], v[6:7] op_sel_hi:[1,0,0]
  v_pk_fma_f32 v[62:63], v[78:79], v[6:7], v[6:7] op_sel_hi:[1,0,0]
  v_rcp_f32 v64, v56
  v_rcp_f32 v65, v57
  v_rcp_f32 v66, v58
  v_rcp_f32 v67, v59
  v_rcp_f32 v68, v60
  v_rcp_f32 v69, v61
  v_rcp_f32 v70, v62
  v_rcp_f32 v71, v63
  v_pk_mul_f32 v[80:81], v[80:81], v[64:65]
  v_pk_mul_f32 v[82:83], v[82:83], v[66:67]
  v_pk_mul_f32 v[84:85], v[84:85], v[68:69]
  v_pk_mul_f32 v[86:87], v[86:87], v[70:71]
  v_cvt_pk_bf16_f32 v20, v80, v81
  v_cvt_pk_bf16_f32 v21, v82, v83
  v_cvt_pk_bf16_f32 v22, v84, v85
  v_cvt_pk_bf16_f32 v23, v86, v87
  s_nop 0
  v_permlane16_swap_b32 v20, v22
  v_permlane16_swap_b32 v21, v23
  buffer_store_dwordx4 v[20:23], v229, s[28:31], s65 offen sc1
  v_lshlrev_b32 v220, 4, v0
  v_and_b32 v3, 15, v0
  v_lshrrev_b32 v4, 4, v0
  v_mov_b32 v208, v220
  v_add_u32 v209, 8192, v220
  v_mov_b32 v210, v220
  v_add_u32 v211, 40960, v220
  v_add_u32 v212, 81920, v220
  s_lshr_b32 s62, s3, 1
  s_mul_i32 s62, s62, 10240
  s_and_b32 s63, s3, 1
  s_lshl_b32 s63, s63, 7
  s_add_u32 s62, s62, s63
  v_and_b32 v5, 1, v3
  v_mul_u32_u24 v5, 5120, v5
  v_lshl_add_u32 v5, v4, 8, v5
  v_lshrrev_b32 v6, 1, v3
  v_lshl_add_u32 v5, v6, 4, v5
  v_add_u32 v215, s62, v5
  v_and_b32 v5, 1, v3
  v_lshlrev_b32 v5, 7, v5
  v_xor_b32 v215, v215, v5
  v_add_u32 v216, 81920, v215
  s_lshl2_add_u32 s62, s57, s3
  s_mul_i32 s68, s62, 50304
  s_add_u32 s68, s68, 8794496
  s_mul_i32 s62, s62, 20480
  s_mul_i32 s63, s58, 160
  s_add_u32 s77, s62, s63
  v_mul_u32_u24 v5, 1280, v3
  v_mad_u32_u24 v213, v4, 40, v5
  v_and_b32 v5, 31, v0
  v_lshlrev_b32 v214, 7, v5
  s_lshl_b32 s76, s57, 12
  s_add_u32 s76, s76, 131072
  s_lshl2_add_u32 s62, s3, 163632
  v_mov_b32 v221, s62
  v_mov_b32 v222, 1
  v_mov_b32 v223, 163632
  s_waitcnt vmcnt(0)
  v_mov_b32 v8, s60
  v_mov_b32 v9, s60
  v_mov_b32 v10, s60
  v_mov_b32 v11, s60
  v_add_u32 v8, 2, v8
  v_add_u32 v9, 2, v9
  v_add_u32 v10, 2, v10
  v_add_u32 v11, 2, v11
  v_lshlrev_b32 v2, 4, v0
  s_mov_b64 exec, 0xff
  buffer_store_dwordx4 v[8:11], v2, s[28:31], s69 offen sc1
  s_mov_b64 exec, -1
  s_lshr_b32 s62, s3, 1
  s_lshl_b32 s62, s62, 3
  s_and_b32 s63, s3, 1
  s_add_u32 s62, s62, s63
  s_mul_i32 s63, s58, 48
  s_add_u32 s62, s62, s63
  s_mul_i32 s66, s62, 5120
  s_add_u32 s66, s66, 15233408
  s_mul_i32 s67, s3, 5120
  buffer_load_dwordx4 v[192:195], v213, s[24:27], s77 offen
  buffer_load_dwordx4 v[196:199], v213, s[24:27], s77 offen offset:16
  buffer_load_dwordx2 v[200:201], v213, s[24:27], s77 offen offset:32
  s_add_u32 s62, s71, 3
  s_and_b32 s62, s62, 3
  s_mul_i32 s62, s62, 10240
  s_add_u32 s62, s62, s66
  s_add_u32 m0, s67, 20480
  s_nop 0
  buffer_load_dwordx4 v220, s[28:31], s62 offen offset:0 sc1 lds
  buffer_load_dwordx4 v220, s[28:31], s62 offen offset:1024 sc1 lds
  buffer_load_dwordx4 v220, s[28:31], s62 offen offset:2048 sc1 lds
  buffer_load_dwordx4 v220, s[28:31], s62 offen offset:3072 sc1 lds
  s_add_u32 m0, s67, 24576
  s_add_u32 s62, s62, 4096
  buffer_load_dwordx4 v220, s[28:31], s62 offen offset:0 sc1 lds
  s_add_u32 s62, s71, 4
  s_and_b32 s62, s62, 3
  s_add_u32 s62, s62, 8
  s_mul_i32 s62, s62, 10240
  s_add_u32 s62, s62, s66
  s_add_u32 m0, s67, 40960
  s_nop 0
  buffer_load_dwordx4 v220, s[28:31], s62 offen offset:0 sc1 lds
  buffer_load_dwordx4 v220, s[28:31], s62 offen offset:1024 sc1 lds
  buffer_load_dwordx4 v220, s[28:31], s62 offen offset:2048 sc1 lds
  buffer_load_dwordx4 v220, s[28:31], s62 offen offset:3072 sc1 lds
  s_add_u32 m0, s67, 45056
  s_add_u32 s62, s62, 4096
  buffer_load_dwordx4 v220, s[28:31], s62 offen offset:0 sc1 lds
  s_add_u32 s62, s71, 5
  s_and_b32 s62, s62, 3
  s_add_u32 s62, s62, 8
  s_mul_i32 s62, s62, 10240
  s_add_u32 s62, s62, s66
  s_add_u32 m0, s67, 61440
  s_nop 0
  buffer_load_dwordx4 v220, s[28:31], s62 offen offset:0 sc1 lds
  buffer_load_dwordx4 v220, s[28:31], s62 offen offset:1024 sc1 lds
  buffer_load_dwordx4 v220, s[28:31], s62 offen offset:2048 sc1 lds
  buffer_load_dwordx4 v220, s[28:31], s62 offen offset:3072 sc1 lds
  s_add_u32 m0, s67, 65536
  s_add_u32 s62, s62, 4096
  buffer_load_dwordx4 v220, s[28:31], s62 offen offset:0 sc1 lds
  s_mov_b32 s73, 20000
L_poll1:
  buffer_load_dword v7, v214, s[28:31], s76 offen sc1
  s_waitcnt vmcnt(0)
L_pchk3:
  s_add_u32 s74, s60, 2
  v_subrev_u32 v7, s74, v7
  v_cmp_ge_u32 vcc, 0, v7
  s_nop 0
  s_cmp_eq_u64 vcc, exec
  s_cbranch_scc1 L_pdone2
  s_sub_u32 s73, s73, 1
  s_cmp_eq_u32 s73, 0
  s_cbranch_scc1 L_pdone2
  s_sleep 8
  s_branch L_poll1
L_pdone2:
  s_add_u32 s64, s71, 0
  s_and_b32 s64, s64, 3
  s_mul_i32 s64, s64, 2048
  s_add_u32 s64, s64, s68
  buffer_load_dwordx4 v[128:131], v208, s[28:31], s64 offen offset:0 sc1
  buffer_load_dwordx4 v[132:135], v208, s[28:31], s64 offen offset:1024 sc1
  buffer_load_dwordx4 v[136:139], v209, s[28:31], s64 offen offset:0 sc1
  buffer_load_dwordx4 v[140:143], v209, s[28:31], s64 offen offset:1024 sc1
  s_add_u32 s64, s71, 1
  s_and_b32 s64, s64, 3
  s_mul_i32 s64, s64, 2048
  s_add_u32 s64, s64, s68
  buffer_load_dwordx4 v[144:147], v208, s[28:31], s64 offen offset:0 sc1
  buffer_load_dwordx4 v[148:151], v208, s[28:31], s64 offen offset:1024 sc1
  buffer_load_dwordx4 v[152:155], v209, s[28:31], s64 offen offset:0 sc1
  buffer_load_dwordx4 v[156:159], v209, s[28:31], s64 offen offset:1024 sc1
  s_add_u32 s64, s71, 2
  s_and_b32 s64, s64, 3
  s_mul_i32 s64, s64, 2048
  s_add_u32 s64, s64, s68
  buffer_load_dwordx4 v[160:163], v208, s[28:31], s64 offen offset:0 sc1
  buffer_load_dwordx4 v[164:167], v208, s[28:31], s64 offen offset:1024 sc1
  buffer_load_dwordx4 v[168:171], v209, s[28:31], s64 offen offset:0 sc1
  buffer_load_dwordx4 v[172:175], v209, s[28:31], s64 offen offset:1024 sc1
  v_mov_b32 v2, 163604
  s_mov_b32 s73, 200000
L_ls4:
  ds_read_b32 v3, v2
  s_waitcnt lgkmcnt(0)
  v_readfirstlane_b32 s74, v3
  s_nop 0
  s_cmp_ge_u32 s74, 4
  s_cbranch_scc1 L_lsd5
  s_sub_u32 s73, s73, 1
  s_cmp_lg_u32 s73, 0
  s_cbranch_scc1 L_ls4
L_lsd5:
  ds_read_b128 v[28:31], v212 offset:0
  ds_read_b128 v[32:35], v212 offset:1024
  ds_read_b128 v[36:39], v212 offset:2048
  ds_read_b128 v[40:43], v212 offset:3072
  ds_read_b128 v[44:47], v212 offset:4096
  ds_read_b128 v[48:51], v212 offset:5120
  ds_read_b128 v[52:55], v212 offset:6144
  ds_read_b128 v[56:59], v212 offset:7168
  ds_read_b128 v[60:63], v212 offset:8192
  ds_read_b128 v[64:67], v212 offset:9216
  s_waitcnt vmcnt(11)
  s_waitcnt lgkmcnt(5)
  v_mfma_f32_16x16x32_bf16 v[8:11], v[28:31], v[128:131], 0
  ds_read_b128 v[68:71], v212 offset:10240
  v_mfma_f32_16x16x32_bf16 v[12:15], v[32:35], v[128:131], 0
  ds_read_b128 v[72:75], v212 offset:11264
  v_mfma_f32_16x16x32_bf16 v[16:19], v[36:39], v[128:131], 0
  ds_read_b128 v[76:79], v212 offset:12288
  v_mfma_f32_16x16x32_bf16 v[20:23], v[40:43], v[128:131], 0
  ds_read_b128 v[80:83], v212 offset:13312
  s_add_u32 s64, s71, 3
  s_and_b32 s64, s64, 3
  s_mul_i32 s64, s64, 2048
  s_add_u32 s64, s64, s68
  buffer_load_dwordx4 v[176:179], v208, s[28:31], s64 offen offset:0 sc1
  v_mfma_f32_16x16x32_bf16 v[24:27], v[44:47], v[128:131], 0
  ds_read_b128 v[84:87], v212 offset:14336
  s_waitcnt vmcnt(11)
  s_waitcnt lgkmcnt(5)
  v_mfma_f32_16x16x32_bf16 v[8:11], v[48:51], v[132:135], v[8:11]
  ds_read_b128 v[28:31], v212 offset:15360
  v_mfma_f32_16x16x32_bf16 v[12:15], v[52:55], v[132:135], v[12:15]
  ds_read_b128 v[32:35], v212 offset:16384
  v_mfma_f32_16x16x32_bf16 v[16:19], v[56:59], v[132:135], v[16:19]
  ds_read_b128 v[36:39], v212 offset:17408
  v_mfma_f32_16x16x32_bf16 v[20:23], v[60:63], v[132:135], v[20:23]
  ds_read_b128 v[40:43], v212 offset:18432
  buffer_load_dwordx4 v[180:183], v208, s[28:31], s64 offen offset:1024 sc1
  v_mfma_f32_16x16x32_bf16 v[24:27], v[64:67], v[132:135], v[24:27]
  ds_read_b128 v[44:47], v212 offset:19456
  s_waitcnt vmcnt(11)
  s_waitcnt lgkmcnt(5)
  v_mfma_f32_16x16x32_bf16 v[8:11], v[68:71], v[136:139], v[8:11]
  ds_read_b128 v[48:51], v212 offset:20480
  v_mfma_f32_16x16x32_bf16 v[12:15], v[72:75], v[136:139], v[12:15]
  ds_read_b128 v[52:55], v212 offset:21504
  v_mfma_f32_16x16x32_bf16 v[16:19], v[76:79], v[136:139], v[16:19]
  ds_read_b128 v[56:59], v212 offset:22528
  v_mfma_f32_16x16x32_bf16 v[20:23], v[80:83], v[136:139], v[20:23]
  ds_read_b128 v[60:63], v212 offset:23552
  buffer_load_dwordx4 v[184:187], v209, s[28:31], s64 offen offset:0 sc1
  v_mfma_f32_16x16x32_bf16 v[24:27], v[84:87], v[136:139], v[24:27]
  ds_read_b128 v[64:67], v212 offset:24576
  s_waitcnt vmcnt(11)
  s_waitcnt lgkmcnt(5)
  v_mfma_f32_16x16x32_bf16 v[8:11], v[28:31], v[140:143], v[8:11]
  ds_read_b128 v[68:71], v212 offset:25600
  v_mfma_f32_16x16x32_bf16 v[12:15], v[32:35], v[140:143], v[12:15]
  ds_read_b128 v[72:75], v212 offset:26624
  v_mfma_f32_16x16x32_bf16 v[16:19], v[36:39], v[140:143], v[16:19]
  ds_read_b128 v[76:79], v212 offset:27648
  v_mfma_f32_16x16x32_bf16 v[20:23], v[40:43], v[140:143], v[20:23]
  ds_read_b128 v[80:83], v212 offset:28672
  buffer_load_dwordx4 v[188:191], v209, s[28:31], s64 offen offset:1024 sc1
  v_mfma_f32_16x16x32_bf16 v[24:27], v[44:47], v[140:143], v[24:27]
  ds_read_b128 v[84:87], v212 offset:29696
  s_mov_b64 exec, 1
  ds_add_u32 v221, v222
  s_mov_b64 exec, -1
  s_waitcnt vmcnt(11)
  s_waitcnt lgkmcnt(6)
  v_mfma_f32_16x16x32_bf16 v[8:11], v[48:51], v[144:147], v[8:11]
  ds_read_b128 v[28:31], v212 offset:30720
  v_mfma_f32_16x16x32_bf16 v[12:15], v[52:55], v[144:147], v[12:15]
  ds_read_b128 v[32:35], v212 offset:31744
  v_mfma_f32_16x16x32_bf16 v[16:19], v[56:59], v[144:147], v[16:19]
  ds_read_b128 v[36:39], v212 offset:32768
  v_mfma_f32_16x16x32_bf16 v[20:23], v[60:63], v[144:147], v[20:23]
  ds_read_b128 v[40:43], v212 offset:33792
  s_add_u32 s64, s71, 4
  s_and_b32 s64, s64, 3
  s_add_u32 s64, s64, 8
  s_mul_i32 s64, s64, 2048
  s_add_u32 s64, s64, s68
  buffer_load_dwordx4 v[128:131], v208, s[28:31], s64 offen offset:0 sc1
  v_mfma_f32_16x16x32_bf16 v[24:27], v[64:67], v[144:147], v[24:27]
  ds_read_b128 v[44:47], v212 offset:34816
  s_waitcnt vmcnt(11)
  s_waitcnt lgkmcnt(6)
  v_mfma_f32_16x16x32_bf16 v[8:11], v[68:71], v[148:151], v[8:11]
  ds_read_b128 v[48:51], v212 offset:35840
  v_mfma_f32_16x16x32_bf16 v[12:15], v[72:75], v[148:151], v[12:15]
  ds_read_b128 v[52:55], v212 offset:36864
  v_mfma_f32_16x16x32_bf16 v[16:19], v[76:79], v[148:151], v[16:19]
  ds_read_b128 v[56:59], v212 offset:37888
  v_mfma_f32_16x16x32_bf16 v[20:23], v[80:83], v[148:151], v[20:23]
  ds_read_b128 v[60:63], v212 offset:38912
  buffer_load_dwordx4 v[132:135], v208, s[28:31], s64 offen offset:1024 sc1
  v_mfma_f32_16x16x32_bf16 v[24:27], v[84:87], v[148:151], v[24:27]
  ds_read_b128 v[64:67], v212 offset:39936
  ds_read_b128 v[224:227], v223
  s_waitcnt lgkmcnt(0)
  v_min3_u32 v224, v224, v225, v226
  v_min_u32 v224, v224, v227
  s_nop 0
  v_readfirstlane_b32 s74, v224
  s_nop 0
  s_cmp_ge_u32 s74, 1
  s_cbranch_scc1 L_ckd6
  s_mov_b32 s73, 200000
L_pw7:
  ds_read_b128 v[224:227], v223
  s_waitcnt lgkmcnt(0)
  v_min3_u32 v224, v224, v225, v226
  v_min_u32 v224, v224, v227
  s_nop 0
  v_readfirstlane_b32 s74, v224
  s_nop 0
  s_cmp_ge_u32 s74, 1
  s_cbranch_scc1 L_pwd8
  s_sub_u32 s73, s73, 1
  s_cmp_lg_u32 s73, 0
  s_cbranch_scc1 L_pw7
L_pwd8:
L_ckd6:
  s_waitcnt vmcnt(11)
  v_mfma_f32_16x16x32_bf16 v[8:11], v[28:31], v[152:155], v[8:11]
  ds_read_b128 v[68:71], v210 offset:0
  v_mfma_f32_16x16x32_bf16 v[12:15], v[32:35], v[152:155], v[12:15]
  ds_read_b128 v[72:75], v210 offset:1024
  s_add_u32 s62, s71, 6
  s_and_b32 s62, s62, 3
  s_add_u32 s62, s62, 8
  s_mul_i32 s62, s62, 10240
  s_add_u32 s62, s62, s66
  s_add_u32 m0, s67, 81920
  s_nop 0
  buffer_load_dwordx4 v220, s[28:31], s62 offen offset:0 sc1 lds
  v_mfma_f32_16x16x32_bf16 v[16:19], v[36:39], v[152:155], v[16:19]
  ds_read_b128 v[76:79], v210 offset:2048
  v_mfma_f32_16x16x32_bf16 v[20:23], v[40:43], v[152:155], v[20:23]
  ds_read_b128 v[80:83], v210 offset:3072
  buffer_load_dwordx4 v[136:139], v209, s[28:31], s64 offen offset:0 sc1
  v_mfma_f32_16x16x32_bf16 v[24:27], v[44:47], v[152:155], v[24:27]
  ds_read_b128 v[84:87], v210 offset:4096
  s_waitcnt vmcnt(12)
  v_mfma_f32_16x16x32_bf16 v[8:11], v[48:51], v[156:159], v[8:11]
  ds_read_b128 v[28:31], v210 offset:5120
  v_mfma_f32_16x16x32_bf16 v[12:15], v[52:55], v[156:159], v[12:15]
  ds_read_b128 v[32:35], v210 offset:6144
  buffer_load_dwordx4 v220, s[28:31], s62 offen offset:1024 sc1 lds
  v_mfma_f32_16x16x32_bf16 v[16:19], v[56:59], v[156:159], v[16:19]
  ds_read_b128 v[36:39], v210 offset:7168
  v_mfma_f32_16x16x32_bf16 v[20:23], v[60:63], v[156:159], v[20:23]
  ds_read_b128 v[40:43], v210 offset:8192
  buffer_load_dwordx4 v[140:143], v209, s[28:31], s64 offen offset:1024 sc1
  v_mfma_f32_16x16x32_bf16 v[24:27], v[64:67], v[156:159], v[24:27]
  ds_read_b128 v[44:47], v210 offset:9216
  buffer_load_dwordx4 v220, s[28:31], s62 offen offset:2048 sc1 lds
  s_mov_b64 exec, 1
  ds_add_u32 v221, v222
  s_mov_b64 exec, -1
  s_waitcnt vmcnt(14)
  s_waitcnt lgkmcnt(6)
  v_mfma_f32_16x16x32_bf16 v[8:11], v[68:71], v[160:163], v[8:11]
  ds_read_b128 v[48:51], v210 offset:10240
  v_mfma_f32_16x16x32_bf16 v[12:15], v[72:75], v[160:163], v[12:15]
  ds_read_b128 v[52:55], v210 offset:11264
  buffer_load_dwordx4 v220, s[28:31], s62 offen offset:3072 sc1 lds
  v_mfma_f32_16x16x32_bf16 v[16:19], v[76:79], v[160:163], v[16:19]
  ds_read_b128 v[56:59], v210 offset:12288
  v_mfma_f32_16x16x32_bf16 v[20:23], v[80:83], v[160:163], v[20:23]
  ds_read_b128 v[60:63], v210 offset:13312
  s_add_u32 s64, s71, 5
  s_and_b32 s64, s64, 3
  s_add_u32 s64, s64, 8
  s_mul_i32 s64, s64, 2048
  s_add_u32 s64, s64, s68
  buffer_load_dwordx4 v[144:147], v208, s[28:31], s64 offen offset:0 sc1
  v_mfma_f32_16x16x32_bf16 v[24:27], v[84:87], v[160:163], v[24:27]
  ds_read_b128 v[64:67], v210 offset:14336
  s_waitcnt vmcnt(15)
  s_waitcnt lgkmcnt(6)
  v_mfma_f32_16x16x32_bf16 v[8:11], v[28:31], v[164:167], v[8:11]
  ds_read_b128 v[68:71], v210 offset:15360
  v_mfma_f32_16x16x32_bf16 v[12:15], v[32:35], v[164:167], v[12:15]
  ds_read_b128 v[72:75], v210 offset:16384
  s_add_u32 m0, s67, 86016
  s_add_u32 s62, s62, 4096
  buffer_load_dwordx4 v220, s[28:31], s62 offen offset:0 sc1 lds
  v_mfma_f32_16x16x32_bf16 v[16:19], v[36:39], v[164:167], v[16:19]
  ds_read_b128 v[76:79], v210 offset:17408
  v_mfma_f32_16x16x32_bf16 v[20:23], v[40:43], v[164:167], v[20:23]
  ds_read_b128 v[80:83], v210 offset:18432
  buffer_load_dwordx4 v[148:151], v208, s[28:31], s64 offen offset:1024 sc1
  v_mfma_f32_16x16x32_bf16 v[24:27], v[44:47], v[164:167], v[24:27]
  ds_read_b128 v[84:87], v210 offset:19456
  ds_read_b128 v[224:227], v223
  s_waitcnt lgkmcnt(0)
  v_min3_u32 v224, v224, v225, v226
  v_min_u32 v224, v224, v227
  s_nop 0
  v_readfirstlane_b32 s74, v224
  s_nop 0
  s_cmp_ge_u32 s74, 2
  s_cbranch_scc1 L_ckd9
  s_mov_b32 s73, 200000
L_pw10:
  ds_read_b128 v[224:227], v223
  s_waitcnt lgkmcnt(0)
  v_min3_u32 v224, v224, v225, v226
  v_min_u32 v224, v224, v227
  s_nop 0
  v_readfirstlane_b32 s74, v224
  s_nop 0
  s_cmp_ge_u32 s74, 2
  s_cbranch_scc1 L_pwd11
  s_sub_u32 s73, s73, 1
  s_cmp_lg_u32 s73, 0
  s_cbranch_scc1 L_pw10
L_pwd11:
L_ckd9:
  s_waitcnt vmcnt(16)
  v_mfma_f32_16x16x32_bf16 v[8:11], v[48:51], v[168:171], v[8:11]
  ds_read_b128 v[28:31], v210 offset:20480
  v_mfma_f32_16x16x32_bf16 v[12:15], v[52:55], v[168:171], v[12:15]
  ds_read_b128 v[32:35], v210 offset:21504
  s_add_u32 s62, s71, 7
  s_and_b32 s62, s62, 3
  s_add_u32 s62, s62, 8
  s_mul_i32 s62, s62, 10240
  s_add_u32 s62, s62, s66
  s_add_u32 m0, s67, 102400
  s_nop 0
  buffer_load_dwordx4 v220, s[28:31], s62 offen offset:0 sc1 lds
  v_mfma_f32_16x16x32_bf16 v[16:19], v[56:59], v[168:171], v[16:19]
  ds_read_b128 v[36:39], v210 offset:22528
  v_mfma_f32_16x16x32_bf16 v[20:23], v[60:63], v[168:171], v[20:23]
  ds_read_b128 v[40:43], v210 offset:23552
  buffer_load_dwordx4 v[152:155], v209, s[28:31], s64 offen offset:0 sc1
  v_mfma_f32_16x16x32_bf16 v[24:27], v[64:67], v[168:171], v[24:27]
  ds_read_b128 v[44:47], v210 offset:24576
  s_waitcnt vmcnt(17)
  v_mfma_f32_16x16x32_bf16 v[8:11], v[68:71], v[172:175], v[8:11]
  ds_read_b128 v[48:51], v210 offset:25600
  v_mfma_f32_16x16x32_bf16 v[12:15], v[72:75], v[172:175], v[12:15]
  ds_read_b128 v[52:55], v210 offset:26624
  buffer_load_dwordx4 v220, s[28:31], s62 offen offset:1024 sc1 lds
  v_mfma_f32_16x16x32_bf16 v[16:19], v[76:79], v[172:175], v[16:19]
  ds_read_b128 v[56:59], v210 offset:27648
  v_mfma_f32_16x16x32_bf16 v[20:23], v[80:83], v[172:175], v[20:23]
  ds_read_b128 v[60:63], v210 offset:28672
  buffer_load_dwordx4 v[156:159], v209, s[28:31], s64 offen offset:1024 sc1
  v_mfma_f32_16x16x32_bf16 v[24:27], v[84:87], v[172:175], v[24:27]
  ds_read_b128 v[64:67], v210 offset:29696
  buffer_load_dwordx4 v220, s[28:31], s62 offen offset:2048 sc1 lds
  s_mov_b64 exec, 1
  ds_add_u32 v221, v222
  s_mov_b64 exec, -1
  s_waitcnt vmcnt(19)
  s_waitcnt lgkmcnt(6)
  v_mfma_f32_16x16x32_bf16 v[8:11], v[28:31], v[176:179], v[8:11]
  ds_read_b128 v[68:71], v210 offset:30720
  v_mfma_f32_16x16x32_bf16 v[12:15], v[32:35], v[176:179], v[12:15]
  ds_read_b128 v[72:75], v210 offset:31744
  buffer_load_dwordx4 v220, s[28:31], s62 offen offset:3072 sc1 lds
  v_mfma_f32_16x16x32_bf16 v[16:19], v[36:39], v[176:179], v[16:19]
  ds_read_b128 v[76:79], v210 offset:32768
  v_mfma_f32_16x16x32_bf16 v[20:23], v[40:43], v[176:179], v[20:23]
  ds_read_b128 v[80:83], v210 offset:33792
  s_add_u32 s64, s71, 6
  s_and_b32 s64, s64, 3
  s_add_u32 s64, s64, 8
  s_mul_i32 s64, s64, 2048
  s_add_u32 s64, s64, s68
  buffer_load_dwordx4 v[160:163], v208, s[28:31], s64 offen offset:0 sc1
  v_mfma_f32_16x16x32_bf16 v[24:27], v[44:47], v[176:179], v[24:27]
  ds_read_b128 v[84:87], v210 offset:34816
  s_waitcnt vmcnt(20)
  s_waitcnt lgkmcnt(6)
  v_mfma_f32_16x16x32_bf16 v[8:11], v[48:51], v[180:183], v[8:11]
  ds_read_b128 v[28:31], v210 offset:35840
  v_mfma_f32_16x16x32_bf16 v[12:15], v[52:55], v[180:183], v[12:15]
  ds_read_b128 v[32:35], v210 offset:36864
  s_add_u32 m0, s67, 106496
  s_add_u32 s62, s62, 4096
  buffer_load_dwordx4 v220, s[28:31], s62 offen offset:0 sc1 lds
  v_mfma_f32_16x16x32_bf16 v[16:19], v[56:59], v[180:183], v[16:19]
  ds_read_b128 v[36:39], v210 offset:37888
  v_mfma_f32_16x16x32_bf16 v[20:23], v[60:63], v[180:183], v[20:23]
  ds_read_b128 v[40:43], v210 offset:38912
  buffer_load_dwordx4 v[164:167], v208, s[28:31], s64 offen offset:1024 sc1
  v_mfma_f32_16x16x32_bf16 v[24:27], v[64:67], v[180:183], v[24:27]
  ds_read_b128 v[44:47], v210 offset:39936
  ds_read_b128 v[224:227], v223
  s_waitcnt lgkmcnt(0)
  v_min3_u32 v224, v224, v225, v226
  v_min_u32 v224, v224, v227
  s_nop 0
  v_readfirstlane_b32 s74, v224
  s_nop 0
  s_cmp_ge_u32 s74, 3
  s_cbranch_scc1 L_ckd12
  s_mov_b32 s73, 200000
L_pw13:
  ds_read_b128 v[224:227], v223
  s_waitcnt lgkmcnt(0)
  v_min3_u32 v224, v224, v225, v226
  v_min_u32 v224, v224, v227
  s_nop 0
  v_readfirstlane_b32 s74, v224
  s_nop 0
  s_cmp_ge_u32 s74, 3
  s_cbranch_scc1 L_pwd14
  s_sub_u32 s73, s73, 1
  s_cmp_lg_u32 s73, 0
  s_cbranch_scc1 L_pw13
L_pwd14:
L_ckd12:
  s_waitcnt vmcnt(21)
  v_mfma_f32_16x16x32_bf16 v[8:11], v[68:71], v[184:187], v[8:11]
  ds_read_b128 v[48:51], v211 offset:0
  v_mfma_f32_16x16x32_bf16 v[12:15], v[72:75], v[184:187], v[12:15]
  ds_read_b128 v[52:55], v211 offset:1024
  s_add_u32 s62, s71, 8
  s_and_b32 s62, s62, 3
  s_add_u32 s62, s62, 16
  s_mul_i32 s62, s62, 10240
  s_add_u32 s62, s62, s66
  s_add_u32 m0, s67, 0
  s_nop 0
  buffer_load_dwordx4 v220, s[28:31], s62 offen offset:0 sc1 lds
  v_mfma_f32_16x16x32_bf16 v[16:19], v[76:79], v[184:187], v[16:19]
  ds_read_b128 v[56:59], v211 offset:2048
  v_mfma_f32_16x16x32_bf16 v[20:23], v[80:83], v[184:187], v[20:23]
  ds_read_b128 v[60:63], v211 offset:3072
  buffer_load_dwordx4 v[168:171], v209, s[28:31], s64 offen offset:0 sc1
  v_mfma_f32_16x16x32_bf16 v[24:27], v[84:87], v[184:187], v[24:27]
  ds_read_b128 v[64:67], v211 offset:4096
  s_waitcnt vmcnt(22)
  v_mfma_f32_16x16x32_bf16 v[8:11], v[28:31], v[188:191], v[8:11]
  ds_read_b128 v[68:71], v211 offset:5120
  v_mfma_f32_16x16x32_bf16 v[12:15], v[32:35], v[188:191], v[12:15]
  ds_read_b128 v[72:75], v211 offset:6144
  buffer_load_dwordx4 v220, s[28:31], s62 offen offset:1024 sc1 lds
  v_mfma_f32_16x16x32_bf16 v[16:19], v[36:39], v[188:191], v[16:19]
  ds_read_b128 v[76:79], v211 offset:7168
  v_mfma_f32_16x16x32_bf16 v[20:23], v[40:43], v[188:191], v[20:23]
  ds_read_b128 v[80:83], v211 offset:8192
  buffer_load_dwordx4 v[172:175], v209, s[28:31], s64 offen offset:1024 sc1
  v_mfma_f32_16x16x32_bf16 v[24:27], v[44:47], v[188:191], v[24:27]
  ds_read_b128 v[84:87], v211 offset:9216
  buffer_load_dwordx4 v220, s[28:31], s62 offen offset:2048 sc1 lds
  s_mov_b64 exec, 1
  ds_add_u32 v221, v222
  s_mov_b64 exec, -1
  s_waitcnt vmcnt(24)
  s_waitcnt lgkmcnt(6)
  v_mfma_f32_16x16x32_bf16 v[8:11], v[48:51], v[128:131], v[8:11]
  ds_read_b128 v[28:31], v211 offset:10240
  v_mfma_f32_16x16x32_bf16 v[12:15], v[52:55], v[128:131], v[12:15]
  ds_read_b128 v[32:35], v211 offset:11264
  buffer_load_dwordx4 v220, s[28:31], s62 offen offset:3072 sc1 lds
  v_mfma_f32_16x16x32_bf16 v[16:19], v[56:59], v[128:131], v[16:19]
  ds_read_b128 v[36:39], v211 offset:12288
  v_mfma_f32_16x16x32_bf16 v[20:23], v[60:63], v[128:131], v[20:23]
  ds_read_b128 v[40:43], v211 offset:13312
  s_add_u32 s64, s71, 7
  s_and_b32 s64, s64, 3
  s_add_u32 s64, s64, 8
  s_mul_i32 s64, s64, 2048
  s_add_u32 s64, s64, s68
  buffer_load_dwordx4 v[176:179], v208, s[28:31], s64 offen offset:0 sc1
  v_mfma_f32_16x16x32_bf16 v[24:27], v[64:67], v[128:131], v[24:27]
  ds_read_b128 v[44:47], v211 offset:14336
  s_waitcnt vmcnt(25)
  s_waitcnt lgkmcnt(6)
  v_mfma_f32_16x16x32_bf16 v[8:11], v[68:71], v[132:135], v[8:11]
  ds_read_b128 v[48:51], v211 offset:15360
  v_mfma_f32_16x16x32_bf16 v[12:15], v[72:75], v[132:135], v[12:15]
  ds_read_b128 v[52:55], v211 offset:16384
  s_add_u32 m0, s67, 4096
  s_add_u32 s62, s62, 4096
  buffer_load_dwordx4 v220, s[28:31], s62 offen offset:0 sc1 lds
  v_mfma_f32_16x16x32_bf16 v[16:19], v[76:79], v[132:135], v[16:19]
  ds_read_b128 v[56:59], v211 offset:17408
  v_mfma_f32_16x16x32_bf16 v[20:23], v[80:83], v[132:135], v[20:23]
  ds_read_b128 v[60:63], v211 offset:18432
  buffer_load_dwordx4 v[180:183], v208, s[28:31], s64 offen offset:1024 sc1
  v_mfma_f32_16x16x32_bf16 v[24:27], v[84:87], v[132:135], v[24:27]
  ds_read_b128 v[64:67], v211 offset:19456
  ds_read_b128 v[224:227], v223
  s_waitcnt lgkmcnt(0)
  v_min3_u32 v224, v224, v225, v226
  v_min_u32 v224, v224, v227
  s_nop 0
  v_readfirstlane_b32 s74, v224
  s_nop 0
  s_cmp_ge_u32 s74, 4
  s_cbranch_scc1 L_ckd15
  s_mov_b32 s73, 200000
L_pw16:
  ds_read_b128 v[224:227], v223
  s_waitcnt lgkmcnt(0)
  v_min3_u32 v224, v224, v225, v226
  v_min_u32 v224, v224, v227
  s_nop 0
  v_readfirstlane_b32 s74, v224
  s_nop 0
  s_cmp_ge_u32 s74, 4
  s_cbranch_scc1 L_pwd17
  s_sub_u32 s73, s73, 1
  s_cmp_lg_u32 s73, 0
  s_cbranch_scc1 L_pw16
L_pwd17:
L_ckd15:
  s_waitcnt vmcnt(25)
  v_mfma_f32_16x16x32_bf16 v[8:11], v[28:31], v[136:139], v[8:11]
  ds_read_b128 v[68:71], v211 offset:20480
  v_mfma_f32_16x16x32_bf16 v[12:15], v[32:35], v[136:139], v[12:15]
  ds_read_b128 v[72:75], v211 offset:21504
  s_add_u32 s62, s71, 9
  s_and_b32 s62, s62, 3
  s_add_u32 s62, s62, 16
  s_mul_i32 s62, s62, 10240
  s_add_u32 s62, s62, s66
  s_add_u32 m0, s67, 20480
  s_nop 0
  buffer_load_dwordx4 v220, s[28:31], s62 offen offset:0 sc1 lds
  v_mfma_f32_16x16x32_bf16 v[16:19], v[36:39], v[136:139], v[16:19]
  ds_read_b128 v[76:79], v211 offset:22528
  v_mfma_f32_16x16x32_bf16 v[20:23], v[40:43], v[136:139], v[20:23]
  ds_read_b128 v[80:83], v211 offset:23552
  buffer_load_dwordx4 v[184:187], v209, s[28:31], s64 offen offset:0 sc1
  v_mfma_f32_16x16x32_bf16 v[24:27], v[44:47], v[136:139], v[24:27]
  ds_read_b128 v[84:87], v211 offset:24576
  s_waitcnt vmcnt(25)
  v_mfma_f32_16x16x32_bf16 v[8:11], v[48:51], v[140:143], v[8:11]
  ds_read_b128 v[28:31], v211 offset:25600
  v_mfma_f32_16x16x32_bf16 v[12:15], v[52:55], v[140:143], v[12:15]
  ds_read_b128 v[32:35], v211 offset:26624
  buffer_load_dwordx4 v220, s[28:31], s62 offen offset:1024 sc1 lds
  v_mfma_f32_16x16x32_bf16 v[16:19], v[56:59], v[140:143], v[16:19]
  ds_read_b128 v[36:39], v211 offset:27648
  v_mfma_f32_16x16x32_bf16 v[20:23], v[60:63], v[140:143], v[20:23]
  ds_read_b128 v[40:43], v211 offset:28672
  buffer_load_dwordx4 v[188:191], v209, s[28:31], s64 offen offset:1024 sc1
  v_mfma_f32_16x16x32_bf16 v[24:27], v[64:67], v[140:143], v[24:27]
  ds_read_b128 v[44:47], v211 offset:29696
  buffer_load_dwordx4 v220, s[28:31], s62 offen offset:2048 sc1 lds
  s_waitcnt vmcnt(24)
  s_mov_b64 exec, 1
  ds_add_u32 v221, v222
  s_mov_b64 exec, -1
  s_waitcnt lgkmcnt(6)
  v_mfma_f32_16x16x32_bf16 v[8:11], v[68:71], v[144:147], v[8:11]
  ds_read_b128 v[48:51], v211 offset:30720
  v_mfma_f32_16x16x32_bf16 v[12:15], v[72:75], v[144:147], v[12:15]
  ds_read_b128 v[52:55], v211 offset:31744
  buffer_load_dwordx4 v220, s[28:31], s62 offen offset:3072 sc1 lds
  v_mfma_f32_16x16x32_bf16 v[16:19], v[76:79], v[144:147], v[16:19]
  ds_read_b128 v[56:59], v211 offset:32768
  v_mfma_f32_16x16x32_bf16 v[20:23], v[80:83], v[144:147], v[20:23]
  ds_read_b128 v[60:63], v211 offset:33792
  s_add_u32 s64, s71, 8
  s_and_b32 s64, s64, 3
  s_add_u32 s64, s64, 16
  s_mul_i32 s64, s64, 2048
  s_add_u32 s64, s64, s68
  buffer_load_dwordx4 v[128:131], v208, s[28:31], s64 offen offset:0 sc1
  v_mfma_f32_16x16x32_bf16 v[24:27], v[84:87], v[144:147], v[24:27]
  ds_read_b128 v[64:67], v211 offset:34816
  s_waitcnt vmcnt(25)
  s_waitcnt lgkmcnt(6)
  v_mfma_f32_16x16x32_bf16 v[8:11], v[28:31], v[148:151], v[8:11]
  ds_read_b128 v[68:71], v211 offset:35840
  v_mfma_f32_16x16x32_bf16 v[12:15], v[32:35], v[148:151], v[12:15]
  ds_read_b128 v[72:75], v211 offset:36864
  s_add_u32 m0, s67, 24576
  s_add_u32 s62, s62, 4096
  buffer_load_dwordx4 v220, s[28:31], s62 offen offset:0 sc1 lds
  v_mfma_f32_16x16x32_bf16 v[16:19], v[36:39], v[148:151], v[16:19]
  ds_read_b128 v[76:79], v211 offset:37888
  v_mfma_f32_16x16x32_bf16 v[20:23], v[40:43], v[148:151], v[20:23]
  ds_read_b128 v[80:83], v211 offset:38912
  buffer_load_dwordx4 v[132:135], v208, s[28:31], s64 offen offset:1024 sc1
  v_mfma_f32_16x16x32_bf16 v[24:27], v[44:47], v[148:151], v[24:27]
  ds_read_b128 v[84:87], v211 offset:39936
  ds_read_b128 v[224:227], v223
  s_waitcnt lgkmcnt(0)
  v_min3_u32 v224, v224, v225, v226
  v_min_u32 v224, v224, v227
  s_nop 0
  v_readfirstlane_b32 s74, v224
  s_nop 0
  s_cmp_ge_u32 s74, 5
  s_cbranch_scc1 L_ckd18
  s_mov_b32 s73, 200000
L_pw19:
  ds_read_b128 v[224:227], v223
  s_waitcnt lgkmcnt(0)
  v_min3_u32 v224, v224, v225, v226
  v_min_u32 v224, v224, v227
  s_nop 0
  v_readfirstlane_b32 s74, v224
  s_nop 0
  s_cmp_ge_u32 s74, 5
  s_cbranch_scc1 L_pwd20
  s_sub_u32 s73, s73, 1
  s_cmp_lg_u32 s73, 0
  s_cbranch_scc1 L_pw19
L_pwd20:
L_ckd18:
  s_waitcnt vmcnt(25)
  v_mfma_f32_16x16x32_bf16 v[8:11], v[48:51], v[152:155], v[8:11]
  ds_read_b128 v[28:31], v212 offset:0
  v_mfma_f32_16x16x32_bf16 v[12:15], v[52:55], v[152:155], v[12:15]
  ds_read_b128 v[32:35], v212 offset:1024
  s_add_u32 s62, s71, 10
  s_and_b32 s62, s62, 3
  s_add_u32 s62, s62, 16
  s_mul_i32 s62, s62, 10240
  s_add_u32 s62, s62, s66
  s_add_u32 m0, s67, 40960
  s_nop 0
  buffer_load_dwordx4 v220, s[28:31], s62 offen offset:0 sc1 lds
  v_mfma_f32_16x16x32_bf16 v[16:19], v[56:59], v[152:155], v[16:19]
  ds_read_b128 v[36:39], v212 offset:2048
  v_mfma_f32_16x16x32_bf16 v[20:23], v[60:63], v[152:155], v[20:23]
  ds_read_b128 v[40:43], v212 offset:3072
  buffer_load_dwordx4 v[136:139], v209, s[28:31], s64 offen offset:0 sc1
  v_mfma_f32_16x16x32_bf16 v[24:27], v[64:67], v[152:155], v[24:27]
  ds_read_b128 v[44:47], v212 offset:4096
  s_waitcnt vmcnt(25)
  v_mfma_f32_16x16x32_bf16 v[8:11], v[68:71], v[156:159], v[8:11]
  ds_read_b128 v[48:51], v212 offset:5120
  v_mfma_f32_16x16x32_bf16 v[12:15], v[72:75], v[156:159], v[12:15]
  ds_read_b128 v[52:55], v212 offset:6144
  buffer_load_dwordx4 v220, s[28:31], s62 offen offset:1024 sc1 lds
  v_mfma_f32_16x16x32_bf16 v[16:19], v[76:79], v[156:159], v[16:19]
  ds_read_b128 v[56:59], v212 offset:7168
  v_mfma_f32_16x16x32_bf16 v[20:23], v[80:83], v[156:159], v[20:23]
  ds_read_b128 v[60:63], v212 offset:8192
  buffer_load_dwordx4 v[140:143], v209, s[28:31], s64 offen offset:1024 sc1
  v_mfma_f32_16x16x32_bf16 v[24:27], v[84:87], v[156:159], v[24:27]
  ds_read_b128 v[64:67], v212 offset:9216
  buffer_load_dwordx4 v220, s[28:31], s62 offen offset:2048 sc1 lds
  s_waitcnt vmcnt(24)
  s_mov_b64 exec, 1
  ds_add_u32 v221, v222
  s_mov_b64 exec, -1
  s_waitcnt lgkmcnt(6)
  v_mfma_f32_16x16x32_bf16 v[8:11], v[28:31], v[160:163], v[8:11]
  ds_read_b128 v[68:71], v212 offset:10240
  v_mfma_f32_16x16x32_bf16 v[12:15], v[32:35], v[160:163], v[12:15]
  ds_read_b128 v[72:75], v212 offset:11264
  buffer_load_dwordx4 v220, s[28:31], s62 offen offset:3072 sc1 lds
  v_mfma_f32_16x16x32_bf16 v[16:19], v[36:39], v[160:163], v[16:19]
  ds_read_b128 v[76:79], v212 offset:12288
  v_mfma_f32_16x16x32_bf16 v[20:23], v[40:43], v[160:163], v[20:23]
  ds_read_b128 v[80:83], v212 offset:13312
  s_add_u32 s64, s71, 9
  s_and_b32 s64, s64, 3
  s_add_u32 s64, s64, 16
  s_mul_i32 s64, s64, 2048
  s_add_u32 s64, s64, s68
  buffer_load_dwordx4 v[144:147], v208, s[28:31], s64 offen offset:0 sc1
  v_mfma_f32_16x16x32_bf16 v[24:27], v[44:47], v[160:163], v[24:27]
  ds_read_b128 v[84:87], v212 offset:14336
  s_waitcnt vmcnt(25)
  s_waitcnt lgkmcnt(6)
  v_mfma_f32_16x16x32_bf16 v[8:11], v[48:51], v[164:167], v[8:11]
  ds_read_b128 v[28:31], v212 offset:15360
  v_mfma_f32_16x16x32_bf16 v[12:15], v[52:55], v[164:167], v[12:15]
  ds_read_b128 v[32:35], v212 offset:16384
  s_add_u32 m0, s67, 45056
  s_add_u32 s62, s62, 4096
  buffer_load_dwordx4 v220, s[28:31], s62 offen offset:0 sc1 lds
  v_mfma_f32_16x16x32_bf16 v[16:19], v[56:59], v[164:167], v[16:19]
  ds_read_b128 v[36:39], v212 offset:17408
  v_mfma_f32_16x16x32_bf16 v[20:23], v[60:63], v[164:167], v[20:23]
  ds_read_b128 v[40:43], v212 offset:18432
  buffer_load_dwordx4 v[148:151], v208, s[28:31], s64 offen offset:1024 sc1
  v_mfma_f32_16x16x32_bf16 v[24:27], v[64:67], v[164:167], v[24:27]
  ds_read_b128 v[44:47], v212 offset:19456
  ds_read_b128 v[224:227], v223
  s_waitcnt lgkmcnt(0)
  v_min3_u32 v224, v224, v225, v226
  v_min_u32 v224, v224, v227
  s_nop 0
  v_readfirstlane_b32 s74, v224
  s_nop 0
  s_cmp_ge_u32 s74, 6
  s_cbranch_scc1 L_ckd21
  s_mov_b32 s73, 200000
L_pw22:
  ds_read_b128 v[224:227], v223
  s_waitcnt lgkmcnt(0)
  v_min3_u32 v224, v224, v225, v226
  v_min_u32 v224, v224, v227
  s_nop 0
  v_readfirstlane_b32 s74, v224
  s_nop 0
  s_cmp_ge_u32 s74, 6
  s_cbranch_scc1 L_pwd23
  s_sub_u32 s73, s73, 1
  s_cmp_lg_u32 s73, 0
  s_cbranch_scc1 L_pw22
L_pwd23:
L_ckd21:
  s_waitcnt vmcnt(25)
  v_mfma_f32_16x16x32_bf16 v[8:11], v[68:71], v[168:171], v[8:11]
  ds_read_b128 v[48:51], v212 offset:20480
  v_mfma_f32_16x16x32_bf16 v[12:15], v[72:75], v[168:171], v[12:15]
  ds_read_b128 v[52:55], v212 offset:21504
  s_add_u32 s62, s71, 11
  s_and_b32 s62, s62, 3
  s_add_u32 s62, s62, 16
  s_mul_i32 s62, s62, 10240
  s_add_u32 s62, s62, s66
  s_add_u32 m0, s67, 61440
  s_nop 0
  buffer_load_dwordx4 v220, s[28:31], s62 offen offset:0 sc1 lds
  v_mfma_f32_16x16x32_bf16 v[16:19], v[76:79], v[168:171], v[16:19]
  ds_read_b128 v[56:59], v212 offset:22528
  v_mfma_f32_16x16x32_bf16 v[20:23], v[80:83], v[168:171], v[20:23]
  ds_read_b128 v[60:63], v212 offset:23552
  buffer_load_dwordx4 v[152:155], v209, s[28:31], s64 offen offset:0 sc1
  v_mfma_f32_16x16x32_bf16 v[24:27], v[84:87], v[168:171], v[24:27]
  ds_read_b128 v[64:67], v212 offset:24576
  s_waitcnt vmcnt(25)
  v_mfma_f32_16x16x32_bf16 v[8:11], v[28:31], v[172:175], v[8:11]
  ds_read_b128 v[68:71], v212 offset:25600
  v_mfma_f32_16x16x32_bf16 v[12:15], v[32:35], v[172:175], v[12:15]
  ds_read_b128 v[72:75], v212 offset:26624
  buffer_load_dwordx4 v220, s[28:31], s62 offen offset:1024 sc1 lds
  v_mfma_f32_16x16x32_bf16 v[16:19], v[36:39], v[172:175], v[16:19]
  ds_read_b128 v[76:79], v212 offset:27648
  v_mfma_f32_16x16x32_bf16 v[20:23], v[40:43], v[172:175], v[20:23]
  ds_read_b128 v[80:83], v212 offset:28672
  buffer_load_dwordx4 v[156:159], v209, s[28:31], s64 offen offset:1024 sc1
  v_mfma_f32_16x16x32_bf16 v[24:27], v[44:47], v[172:175], v[24:27]
  ds_read_b128 v[84:87], v212 offset:29696
  buffer_load_dwordx4 v220, s[28:31], s62 offen offset:2048 sc1 lds
  s_waitcnt vmcnt(24)
  s_mov_b64 exec, 1
  ds_add_u32 v221, v222
  s_mov_b64 exec, -1
  s_waitcnt lgkmcnt(6)
  v_mfma_f32_16x16x32_bf16 v[8:11], v[48:51], v[176:179], v[8:11]
  ds_read_b128 v[28:31], v212 offset:30720
  v_mfma_f32_16x16x32_bf16 v[12:15], v[52:55], v[176:179], v[12:15]
  ds_read_b128 v[32:35], v212 offset:31744
  buffer_load_dwordx4 v220, s[28:31], s62 offen offset:3072 sc1 lds
  v_mfma_f32_16x16x32_bf16 v[16:19], v[56:59], v[176:179], v[16:19]
  ds_read_b128 v[36:39], v212 offset:32768
  v_mfma_f32_16x16x32_bf16 v[20:23], v[60:63], v[176:179], v[20:23]
  ds_read_b128 v[40:43], v212 offset:33792
  s_add_u32 s64, s71, 10
  s_and_b32 s64, s64, 3
  s_add_u32 s64, s64, 16
  s_mul_i32 s64, s64, 2048
  s_add_u32 s64, s64, s68
  buffer_load_dwordx4 v[160:163], v208, s[28:31], s64 offen offset:0 sc1
  v_mfma_f32_16x16x32_bf16 v[24:27], v[64:67], v[176:179], v[24:27]
  ds_read_b128 v[44:47], v212 offset:34816
  s_waitcnt vmcnt(25)
  s_waitcnt lgkmcnt(6)
  v_mfma_f32_16x16x32_bf16 v[8:11], v[68:71], v[180:183], v[8:11]
  ds_read_b128 v[48:51], v212 offset:35840
  v_mfma_f32_16x16x32_bf16 v[12:15], v[72:75], v[180:183], v[12:15]
  ds_read_b128 v[52:55], v212 offset:36864
  s_add_u32 m0, s67, 65536
  s_add_u32 s62, s62, 4096
  buffer_load_dwordx4 v220, s[28:31], s62 offen offset:0 sc1 lds
  v_mfma_f32_16x16x32_bf16 v[16:19], v[76:79], v[180:183], v[16:19]
  ds_read_b128 v[56:59], v212 offset:37888
  v_mfma_f32_16x16x32_bf16 v[20:23], v[80:83], v[180:183], v[20:23]
  ds_read_b128 v[60:63], v212 offset:38912
  buffer_load_dwordx4 v[164:167], v208, s[28:31], s64 offen offset:1024 sc1
  v_mfma_f32_16x16x32_bf16 v[24:27], v[84:87], v[180:183], v[24:27]
  ds_read_b128 v[64:67], v212 offset:39936
  ds_read_b128 v[224:227], v223
  s_waitcnt lgkmcnt(0)
  v_min3_u32 v224, v224, v225, v226
  v_min_u32 v224, v224, v227
  s_nop 0
  v_readfirstlane_b32 s74, v224
  s_nop 0
  s_cmp_ge_u32 s74, 7
  s_cbranch_scc1 L_ckd24
  s_mov_b32 s73, 200000
L_pw25:
  ds_read_b128 v[224:227], v223
  s_waitcnt lgkmcnt(0)
  v_min3_u32 v224, v224, v225, v226
  v_min_u32 v224, v224, v227
  s_nop 0
  v_readfirstlane_b32 s74, v224
  s_nop 0
  s_cmp_ge_u32 s74, 7
  s_cbranch_scc1 L_pwd26
  s_sub_u32 s73, s73, 1
  s_cmp_lg_u32 s73, 0
  s_cbranch_scc1 L_pw25
L_pwd26:
L_ckd24:
  s_waitcnt vmcnt(25)
  v_mfma_f32_16x16x32_bf16 v[8:11], v[28:31], v[184:187], v[8:11]
  ds_read_b128 v[68:71], v210 offset:0
  v_mfma_f32_16x16x32_bf16 v[12:15], v[32:35], v[184:187], v[12:15]
  ds_read_b128 v[72:75], v210 offset:1024
  v_mfma_f32_16x16x32_bf16 v[16:19], v[36:39], v[184:187], v[16:19]
  ds_read_b128 v[76:79], v210 offset:2048
  v_mfma_f32_16x16x32_bf16 v[20:23], v[40:43], v[184:187], v[20:23]
  ds_read_b128 v[80:83], v210 offset:3072
  buffer_load_dwordx4 v[168:171], v209, s[28:31], s64 offen offset:0 sc1
  v_mfma_f32_16x16x32_bf16 v[24:27], v[44:47], v[184:187], v[24:27]
  ds_read_b128 v[84:87], v210 offset:4096
  s_waitcnt vmcnt(24)
  v_mfma_f32_16x16x32_bf16 v[8:11], v[48:51], v[188:191], v[8:11]
  ds_read_b128 v[28:31], v210 offset:5120
  v_mfma_f32_16x16x32_bf16 v[12:15], v[52:55], v[188:191], v[12:15]
  ds_read_b128 v[32:35], v210 offset:6144
  v_mfma_f32_16x16x32_bf16 v[16:19], v[56:59], v[188:191], v[16:19]
  ds_read_b128 v[36:39], v210 offset:7168
  v_mfma_f32_16x16x32_bf16 v[20:23], v[60:63], v[188:191], v[20:23]
  ds_read_b128 v[40:43], v210 offset:8192
  buffer_load_dwordx4 v[172:175], v209, s[28:31], s64 offen offset:1024 sc1
  v_mfma_f32_16x16x32_bf16 v[24:27], v[64:67], v[188:191], v[24:27]
  ds_read_b128 v[44:47], v210 offset:9216
  s_waitcnt vmcnt(21)
  s_mov_b64 exec, 1
  ds_add_u32 v221, v222
  s_mov_b64 exec, -1
  s_waitcnt lgkmcnt(6)
  v_mfma_f32_16x16x32_bf16 v[8:11], v[68:71], v[128:131], v[8:11]
  ds_read_b128 v[48:51], v210 offset:10240
  v_mfma_f32_16x16x32_bf16 v[12:15], v[72:75], v[128:131], v[12:15]
  ds_read_b128 v[52:55], v210 offset:11264
  v_mfma_f32_16x16x32_bf16 v[16:19], v[76:79], v[128:131], v[16:19]
  ds_read_b128 v[56:59], v210 offset:12288
  v_mfma_f32_16x16x32_bf16 v[20:23], v[80:83], v[128:131], v[20:23]
  ds_read_b128 v[60:63], v210 offset:13312
  s_add_u32 s64, s71, 11
  s_and_b32 s64, s64, 3
  s_add_u32 s64, s64, 16
  s_mul_i32 s64, s64, 2048
  s_add_u32 s64, s64, s68
  buffer_load_dwordx4 v[176:179], v208, s[28:31], s64 offen offset:0 sc1
  v_mfma_f32_16x16x32_bf16 v[24:27], v[84:87], v[128:131], v[24:27]
  ds_read_b128 v[64:67], v210 offset:14336
  s_waitcnt vmcnt(21)
  s_waitcnt lgkmcnt(6)
  v_mfma_f32_16x16x32_bf16 v[8:11], v[28:31], v[132:135], v[8:11]
  ds_read_b128 v[68:71], v210 offset:15360
  v_mfma_f32_16x16x32_bf16 v[12:15], v[32:35], v[132:135], v[12:15]
  ds_read_b128 v[72:75], v210 offset:16384
  v_mfma_f32_16x16x32_bf16 v[16:19], v[36:39], v[132:135], v[16:19]
  ds_read_b128 v[76:79], v210 offset:17408
  v_mfma_f32_16x16x32_bf16 v[20:23], v[40:43], v[132:135], v[20:23]
  ds_read_b128 v[80:83], v210 offset:18432
  buffer_load_dwordx4 v[180:183], v208, s[28:31], s64 offen offset:1024 sc1
  v_mfma_f32_16x16x32_bf16 v[24:27], v[44:47], v[132:135], v[24:27]
  ds_read_b128 v[84:87], v210 offset:19456
  ds_read_b128 v[224:227], v223
  s_waitcnt lgkmcnt(0)
  v_min3_u32 v224, v224, v225, v226
  v_min_u32 v224, v224, v227
  s_nop 0
  v_readfirstlane_b32 s74, v224
  s_nop 0
  s_cmp_ge_u32 s74, 8
  s_cbranch_scc1 L_ckd27
  s_mov_b32 s73, 200000
L_pw28:
  ds_read_b128 v[224:227], v223
  s_waitcnt lgkmcnt(0)
  v_min3_u32 v224, v224, v225, v226
  v_min_u32 v224, v224, v227
  s_nop 0
  v_readfirstlane_b32 s74, v224
  s_nop 0
  s_cmp_ge_u32 s74, 8
  s_cbranch_scc1 L_pwd29
  s_sub_u32 s73, s73, 1
  s_cmp_lg_u32 s73, 0
  s_cbranch_scc1 L_pw28
L_pwd29:
L_ckd27:
  s_waitcnt vmcnt(20)
  v_mfma_f32_16x16x32_bf16 v[8:11], v[48:51], v[136:139], v[8:11]
  ds_read_b128 v[28:31], v210 offset:20480
  v_mfma_f32_16x16x32_bf16 v[12:15], v[52:55], v[136:139], v[12:15]
  ds_read_b128 v[32:35], v210 offset:21504
  v_mfma_f32_16x16x32_bf16 v[16:19], v[56:59], v[136:139], v[16:19]
  ds_read_b128 v[36:39], v210 offset:22528
  v_mfma_f32_16x16x32_bf16 v[20:23], v[60:63], v[136:139], v[20:23]
  ds_read_b128 v[40:43], v210 offset:23552
  buffer_load_dwordx4 v[184:187], v209, s[28:31], s64 offen offset:0 sc1
  v_mfma_f32_16x16x32_bf16 v[24:27], v[64:67], v[136:139], v[24:27]
  ds_read_b128 v[44:47], v210 offset:24576
  s_waitcnt vmcnt(19)
  v_mfma_f32_16x16x32_bf16 v[8:11], v[68:71], v[140:143], v[8:11]
  ds_read_b128 v[48:51], v210 offset:25600
  v_mfma_f32_16x16x32_bf16 v[12:15], v[72:75], v[140:143], v[12:15]
  ds_read_b128 v[52:55], v210 offset:26624
  v_mfma_f32_16x16x32_bf16 v[16:19], v[76:79], v[140:143], v[16:19]
  ds_read_b128 v[56:59], v210 offset:27648
  v_mfma_f32_16x16x32_bf16 v[20:23], v[80:83], v[140:143], v[20:23]
  ds_read_b128 v[60:63], v210 offset:28672
  buffer_load_dwordx4 v[188:191], v209, s[28:31], s64 offen offset:1024 sc1
  v_mfma_f32_16x16x32_bf16 v[24:27], v[84:87], v[140:143], v[24:27]
  ds_read_b128 v[64:67], v210 offset:29696
  s_waitcnt vmcnt(16)
  s_mov_b64 exec, 1
  ds_add_u32 v221, v222
  s_mov_b64 exec, -1
  s_waitcnt lgkmcnt(6)
  v_mfma_f32_16x16x32_bf16 v[8:11], v[28:31], v[144:147], v[8:11]
  ds_read_b128 v[68:71], v210 offset:30720
  v_mfma_f32_16x16x32_bf16 v[12:15], v[32:35], v[144:147], v[12:15]
  ds_read_b128 v[72:75], v210 offset:31744
  v_mfma_f32_16x16x32_bf16 v[16:19], v[36:39], v[144:147], v[16:19]
  ds_read_b128 v[76:79], v210 offset:32768
  v_mfma_f32_16x16x32_bf16 v[20:23], v[40:43], v[144:147], v[20:23]
  ds_read_b128 v[80:83], v210 offset:33792
  v_mfma_f32_16x16x32_bf16 v[24:27], v[44:47], v[144:147], v[24:27]
  ds_read_b128 v[84:87], v210 offset:34816
  s_waitcnt vmcnt(15)
  s_waitcnt lgkmcnt(6)
  v_mfma_f32_16x16x32_bf16 v[8:11], v[48:51], v[148:151], v[8:11]
  ds_read_b128 v[28:31], v210 offset:35840
  v_mfma_f32_16x16x32_bf16 v[12:15], v[52:55], v[148:151], v[12:15]
  ds_read_b128 v[32:35], v210 offset:36864
  v_mfma_f32_16x16x32_bf16 v[16:19], v[56:59], v[148:151], v[16:19]
  ds_read_b128 v[36:39], v210 offset:37888
  v_mfma_f32_16x16x32_bf16 v[20:23], v[60:63], v[148:151], v[20:23]
  ds_read_b128 v[40:43], v210 offset:38912
  v_mfma_f32_16x16x32_bf16 v[24:27], v[64:67], v[148:151], v[24:27]
  ds_read_b128 v[44:47], v210 offset:39936
  ds_read_b128 v[224:227], v223
  s_waitcnt lgkmcnt(0)
  v_min3_u32 v224, v224, v225, v226
  v_min_u32 v224, v224, v227
  s_nop 0
  v_readfirstlane_b32 s74, v224
  s_nop 0
  s_cmp_ge_u32 s74, 9
  s_cbranch_scc1 L_ckd30
  s_mov_b32 s73, 200000
L_pw31:
  ds_read_b128 v[224:227], v223
  s_waitcnt lgkmcnt(0)
  v_min3_u32 v224, v224, v225, v226
  v_min_u32 v224, v224, v227
  s_nop 0
  v_readfirstlane_b32 s74, v224
  s_nop 0
  s_cmp_ge_u32 s74, 9
  s_cbranch_scc1 L_pwd32
  s_sub_u32 s73, s73, 1
  s_cmp_lg_u32 s73, 0
  s_cbranch_scc1 L_pw31
L_pwd32:
L_ckd30:
  s_waitcnt vmcnt(13)
  v_mfma_f32_16x16x32_bf16 v[8:11], v[68:71], v[152:155], v[8:11]
  ds_read_b128 v[48:51], v211 offset:0
  v_mfma_f32_16x16x32_bf16 v[12:15], v[72:75], v[152:155], v[12:15]
  ds_read_b128 v[52:55], v211 offset:1024
  v_mfma_f32_16x16x32_bf16 v[16:19], v[76:79], v[152:155], v[16:19]
  ds_read_b128 v[56:59], v211 offset:2048
  v_mfma_f32_16x16x32_bf16 v[20:23], v[80:83], v[152:155], v[20:23]
  ds_read_b128 v[60:63], v211 offset:3072
  v_mfma_f32_16x16x32_bf16 v[24:27], v[84:87], v[152:155], v[24:27]
  ds_read_b128 v[64:67], v211 offset:4096
  s_waitcnt vmcnt(11)
  v_mfma_f32_16x16x32_bf16 v[8:11], v[28:31], v[156:159], v[8:11]
  ds_read_b128 v[68:71], v211 offset:5120
  v_mfma_f32_16x16x32_bf16 v[12:15], v[32:35], v[156:159], v[12:15]
  ds_read_b128 v[72:75], v211 offset:6144
  v_mfma_f32_16x16x32_bf16 v[16:19], v[36:39], v[156:159], v[16:19]
  ds_read_b128 v[76:79], v211 offset:7168
  v_mfma_f32_16x16x32_bf16 v[20:23], v[40:43], v[156:159], v[20:23]
  ds_read_b128 v[80:83], v211 offset:8192
  v_mfma_f32_16x16x32_bf16 v[24:27], v[44:47], v[156:159], v[24:27]
  ds_read_b128 v[84:87], v211 offset:9216
  s_waitcnt vmcnt(7)
  s_mov_b64 exec, 1
  ds_add_u32 v221, v222
  s_mov_b64 exec, -1
  s_waitcnt lgkmcnt(6)
  v_mfma_f32_16x16x32_bf16 v[8:11], v[48:51], v[160:163], v[8:11]
  ds_read_b128 v[28:31], v211 offset:10240
  v_mfma_f32_16x16x32_bf16 v[12:15], v[52:55], v[160:163], v[12:15]
  ds_read_b128 v[32:35], v211 offset:11264
  v_mfma_f32_16x16x32_bf16 v[16:19], v[56:59], v[160:163], v[16:19]
  ds_read_b128 v[36:39], v211 offset:12288
  v_mfma_f32_16x16x32_bf16 v[20:23], v[60:63], v[160:163], v[20:23]
  ds_read_b128 v[40:43], v211 offset:13312
  v_mfma_f32_16x16x32_bf16 v[24:27], v[64:67], v[160:163], v[24:27]
  ds_read_b128 v[44:47], v211 offset:14336
  s_waitcnt vmcnt(6)
  s_waitcnt lgkmcnt(6)
  v_mfma_f32_16x16x32_bf16 v[8:11], v[68:71], v[164:167], v[8:11]
  ds_read_b128 v[48:51], v211 offset:15360
  v_mfma_f32_16x16x32_bf16 v[12:15], v[72:75], v[164:167], v[12:15]
  ds_read_b128 v[52:55], v211 offset:16384
  v_mfma_f32_16x16x32_bf16 v[16:19], v[76:79], v[164:167], v[16:19]
  ds_read_b128 v[56:59], v211 offset:17408
  v_mfma_f32_16x16x32_bf16 v[20:23], v[80:83], v[164:167], v[20:23]
  ds_read_b128 v[60:63], v211 offset:18432
  v_mfma_f32_16x16x32_bf16 v[24:27], v[84:87], v[164:167], v[24:27]
  ds_read_b128 v[64:67], v211 offset:19456
  ds_read_b128 v[224:227], v223
  s_waitcnt lgkmcnt(0)
  v_min3_u32 v224, v224, v225, v226
  v_min_u32 v224, v224, v227
  s_nop 0
  v_readfirstlane_b32 s74, v224
  s_nop 0
  s_cmp_ge_u32 s74, 10
  s_cbranch_scc1 L_ckd33
  s_mov_b32 s73, 200000
L_pw34:
  ds_read_b128 v[224:227], v223
  s_waitcnt lgkmcnt(0)
  v_min3_u32 v224, v224, v225, v226
  v_min_u32 v224, v224, v227
  s_nop 0
  v_readfirstlane_b32 s74, v224
  s_nop 0
  s_cmp_ge_u32 s74, 10
  s_cbranch_scc1 L_pwd35
  s_sub_u32 s73, s73, 1
  s_cmp_lg_u32 s73, 0
  s_cbranch_scc1 L_pw34
L_pwd35:
L_ckd33:
  s_waitcnt vmcnt(5)
  v_mfma_f32_16x16x32_bf16 v[8:11], v[28:31], v[168:171], v[8:11]
  ds_read_b128 v[68:71], v211 offset:20480
  v_mfma_f32_16x16x32_bf16 v[12:15], v[32:35], v[168:171], v[12:15]
  ds_read_b128 v[72:75], v211 offset:21504
  v_mfma_f32_16x16x32_bf16 v[16:19], v[36:39], v[168:171], v[16:19]
  ds_read_b128 v[76:79], v211 offset:22528
  v_mfma_f32_16x16x32_bf16 v[20:23], v[40:43], v[168:171], v[20:23]
  ds_read_b128 v[80:83], v211 offset:23552
  v_mfma_f32_16x16x32_bf16 v[24:27], v[44:47], v[168:171], v[24:27]
  ds_read_b128 v[84:87], v211 offset:24576
  s_waitcnt vmcnt(4)
  v_mfma_f32_16x16x32_bf16 v[8:11], v[48:51], v[172:175], v[8:11]
  ds_read_b128 v[28:31], v211 offset:25600
  v_mfma_f32_16x16x32_bf16 v[12:15], v[52:55], v[172:175], v[12:15]
  ds_read_b128 v[32:35], v211 offset:26624
  v_mfma_f32_16x16x32_bf16 v[16:19], v[56:59], v[172:175], v[16:19]
  ds_read_b128 v[36:39], v211 offset:27648
  v_mfma_f32_16x16x32_bf16 v[20:23], v[60:63], v[172:175], v[20:23]
  ds_read_b128 v[40:43], v211 offset:28672
  v_mfma_f32_16x16x32_bf16 v[24:27], v[64:67], v[172:175], v[24:27]
  ds_read_b128 v[44:47], v211 offset:29696
  s_mov_b64 exec, 1
  ds_add_u32 v221, v222
  s_mov_b64 exec, -1
  s_waitcnt vmcnt(3)
  s_waitcnt lgkmcnt(6)
  v_mfma_f32_16x16x32_bf16 v[8:11], v[68:71], v[176:179], v[8:11]
  ds_read_b128 v[48:51], v211 offset:30720
  v_mfma_f32_16x16x32_bf16 v[12:15], v[72:75], v[176:179], v[12:15]
  ds_read_b128 v[52:55], v211 offset:31744
  v_mfma_f32_16x16x32_bf16 v[16:19], v[76:79], v[176:179], v[16:19]
  ds_read_b128 v[56:59], v211 offset:32768
  v_mfma_f32_16x16x32_bf16 v[20:23], v[80:83], v[176:179], v[20:23]
  ds_read_b128 v[60:63], v211 offset:33792
  v_mfma_f32_16x16x32_bf16 v[24:27], v[84:87], v[176:179], v[24:27]
  ds_read_b128 v[64:67], v211 offset:34816
  s_waitcnt vmcnt(2)
  s_waitcnt lgkmcnt(6)
  v_mfma_f32_16x16x32_bf16 v[8:11], v[28:31], v[180:183], v[8:11]
  ds_read_b128 v[68:71], v211 offset:35840
  v_mfma_f32_16x16x32_bf16 v[12:15], v[32:35], v[180:183], v[12:15]
  ds_read_b128 v[72:75], v211 offset:36864
  v_mfma_f32_16x16x32_bf16 v[16:19], v[36:39], v[180:183], v[16:19]
  ds_read_b128 v[76:79], v211 offset:37888
  v_mfma_f32_16x16x32_bf16 v[20:23], v[40:43], v[180:183], v[20:23]
  ds_read_b128 v[80:83], v211 offset:38912
  v_mfma_f32_16x16x32_bf16 v[24:27], v[44:47], v[180:183], v[24:27]
  ds_read_b128 v[84:87], v211 offset:39936
  s_waitcnt vmcnt(1)
  s_waitcnt lgkmcnt(5)
  v_mfma_f32_16x16x32_bf16 v[8:11], v[48:51], v[184:187], v[8:11]
  v_mfma_f32_16x16x32_bf16 v[12:15], v[52:55], v[184:187], v[12:15]
  v_mfma_f32_16x16x32_bf16 v[16:19], v[56:59], v[184:187], v[16:19]
  v_mfma_f32_16x16x32_bf16 v[20:23], v[60:63], v[184:187], v[20:23]
  v_mfma_f32_16x16x32_bf16 v[24:27], v[64:67], v[184:187], v[24:27]
  s_waitcnt vmcnt(0)
  s_waitcnt lgkmcnt(0)
  v_mfma_f32_16x16x32_bf16 v[8:11], v[68:71], v[188:191], v[8:11]
  v_mfma_f32_16x16x32_bf16 v[12:15], v[72:75], v[188:191], v[12:15]
  v_mfma_f32_16x16x32_bf16 v[16:19], v[76:79], v[188:191], v[16:19]
  v_mfma_f32_16x16x32_bf16 v[20:23], v[80:83], v[188:191], v[20:23]
  v_mfma_f32_16x16x32_bf16 v[24:27], v[84:87], v[188:191], v[24:27]
  v_lshlrev_b32 v28, 16, v192
  v_and_b32 v29, 0xffff0000, v192
  v_lshlrev_b32 v30, 16, v193
  v_and_b32 v31, 0xffff0000, v193
  v_lshlrev_b32 v32, 16, v194
  v_and_b32 v33, 0xffff0000, v194
  v_lshlrev_b32 v34, 16, v195
  v_and_b32 v35, 0xffff0000, v195
  v_lshlrev_b32 v36, 16, v196
  v_and_b32 v37, 0xffff0000, v196
  v_lshlrev_b32 v38, 16, v197
  v_and_b32 v39, 0xffff0000, v197
  v_lshlrev_b32 v40, 16, v198
  v_and_b32 v41, 0xffff0000, v198
  v_lshlrev_b32 v42, 16, v199
  v_and_b32 v43, 0xffff0000, v199
  v_lshlrev_b32 v44, 16, v200
  v_and_b32 v45, 0xffff0000, v200
  v_lshlrev_b32 v46, 16, v201
  v_and_b32 v47, 0xffff0000, v201
  v_mul_f32 v48, 0xbfb8aa3b, v8
  v_mul_f32 v49, 0xbfb8aa3b, v9
  v_mul_f32 v50, 0xbfb8aa3b, v10
  v_mul_f32 v51, 0xbfb8aa3b, v11
  v_mul_f32 v52, 0xbfb8aa3b, v12
  v_mul_f32 v53, 0xbfb8aa3b, v13
  v_mul_f32 v54, 0xbfb8aa3b, v14
  v_mul_f32 v55, 0xbfb8aa3b, v15
  v_mul_f32 v56, 0xbfb8aa3b, v16
  v_mul_f32 v57, 0xbfb8aa3b, v17
  v_mul_f32 v58, 0xbfb8aa3b, v18
  v_mul_f32 v59, 0xbfb8aa3b, v19
  v_mul_f32 v60, 0xbfb8aa3b, v20
  v_mul_f32 v61, 0xbfb8aa3b, v21
  v_mul_f32 v62, 0xbfb8aa3b, v22
  v_mul_f32 v63, 0xbfb8aa3b, v23
  v_mul_f32 v64, 0xbfb8aa3b, v24
  v_mul_f32 v65, 0xbfb8aa3b, v25
  v_mul_f32 v66, 0xbfb8aa3b, v26
  v_mul_f32 v67, 0xbfb8aa3b, v27
  v_exp_f32 v48, v48
  v_exp_f32 v49, v49
  v_exp_f32 v50, v50
  v_exp_f32 v51, v51
  v_exp_f32 v52, v52
  v_exp_f32 v53, v53
  v_exp_f32 v54, v54
  v_exp_f32 v55, v55
  v_exp_f32 v56, v56
  v_exp_f32 v57, v57
  v_exp_f32 v58, v58
  v_exp_f32 v59, v59
  v_exp_f32 v60, v60
  v_exp_f32 v61, v61
  v_exp_f32 v62, v62
  v_exp_f32 v63, v63
  v_exp_f32 v64, v64
  v_exp_f32 v65, v65
  v_exp_f32 v66, v66
  v_exp_f32 v67, v67
  v_add_f32 v48, 1.0, v48
  v_add_f32 v49, 1.0, v49
  v_add_f32 v50, 1.0, v50
  v_add_f32 v51, 1.0, v51
  v_add_f32 v52, 1.0, v52
  v_add_f32 v53, 1.0, v53
  v_add_f32 v54, 1.0, v54
  v_add_f32 v55, 1.0, v55
  v_add_f32 v56, 1.0, v56
  v_add_f32 v57, 1.0, v57
  v_add_f32 v58, 1.0, v58
  v_add_f32 v59, 1.0, v59
  v_add_f32 v60, 1.0, v60
  v_add_f32 v61, 1.0, v61
  v_add_f32 v62, 1.0, v62
  v_add_f32 v63, 1.0, v63
  v_add_f32 v64, 1.0, v64
  v_add_f32 v65, 1.0, v65
  v_add_f32 v66, 1.0, v66
  v_add_f32 v67, 1.0, v67
  v_rcp_f32 v48, v48
  v_rcp_f32 v49, v49
  v_rcp_f32 v50, v50
  v_rcp_f32 v51, v51
  v_rcp_f32 v52, v52
  v_rcp_f32 v53, v53
  v_rcp_f32 v54, v54
  v_rcp_f32 v55, v55
  v_rcp_f32 v56, v56
  v_rcp_f32 v57, v57
  v_rcp_f32 v58, v58
  v_rcp_f32 v59, v59
  v_rcp_f32 v60, v60
  v_rcp_f32 v61, v61
  v_rcp_f32 v62, v62
  v_rcp_f32 v63, v63
  v_rcp_f32 v64, v64
  v_rcp_f32 v65, v65
  v_rcp_f32 v66, v66
  v_rcp_f32 v67, v67
  v_pk_mul_f32 v[8:9], v[8:9], v[48:49]
  v_pk_mul_f32 v[10:11], v[10:11], v[50:51]
  v_pk_mul_f32 v[12:13], v[12:13], v[52:53]
  v_pk_mul_f32 v[14:15], v[14:15], v[54:55]
  v_pk_mul_f32 v[16:17], v[16:17], v[56:57]
  v_pk_mul_f32 v[18:19], v[18:19], v[58:59]
  v_pk_mul_f32 v[20:21], v[20:21], v[60:61]
  v_pk_mul_f32 v[22:23], v[22:23], v[62:63]
  v_pk_mul_f32 v[24:25], v[24:25], v[64:65]
  v_pk_mul_f32 v[26:27], v[26:27], v[66:67]
  s_barrier
  ds_read_b128 v[108:111], v215 offset:0
  ds_read_b128 v[112:115], v216 offset:0
  ds_read_b128 v[116:119], v216 offset:20480
  ds_read_b128 v[120:123], v216 offset:40960
  ds_read_b128 v[124:127], v215 offset:1024
  ds_read_b128 v[128:131], v216 offset:1024
  ds_read_b128 v[132:135], v216 offset:21504
  ds_read_b128 v[136:139], v216 offset:41984
  ds_read_b128 v[140:143], v215 offset:2048
  ds_read_b128 v[144:147], v216 offset:2048
  ds_read_b128 v[148:151], v216 offset:22528
  ds_read_b128 v[152:155], v216 offset:43008
  ds_read_b128 v[156:159], v215 offset:3072
  ds_read_b128 v[160:163], v216 offset:3072
  ds_read_b128 v[164:167], v216 offset:23552
  ds_read_b128 v[168:171], v216 offset:44032
  ds_read_b128 v[172:175], v215 offset:4096
  ds_read_b128 v[176:179], v216 offset:4096
  ds_read_b128 v[180:183], v216 offset:24576
  ds_read_b128 v[184:187], v216 offset:45056
  s_waitcnt lgkmcnt(15)
  v_pk_add_f32 v[108:109], v[108:109], v[112:113]
  v_pk_add_f32 v[110:111], v[110:111], v[114:115]
  v_pk_add_f32 v[116:117], v[116:117], v[120:121]
  v_pk_add_f32 v[118:119], v[118:119], v[122:123]
  v_pk_add_f32 v[108:109], v[108:109], v[116:117]
  v_pk_add_f32 v[110:111], v[110:111], v[118:119]
  v_pk_fma_f32 v[8:9], v[8:9], v[108:109], v[28:29]
  v_pk_fma_f32 v[10:11], v[10:11], v[110:111], v[30:31]
  v_cvt_pk_bf16_f32 v72, v8, v9
  v_cvt_pk_bf16_f32 v73, v10, v11
  s_waitcnt lgkmcnt(12)
  v_pk_add_f32 v[124:125], v[124:125], v[128:129]
  v_pk_add_f32 v[126:127], v[126:127], v[130:131]
  v_pk_add_f32 v[132:133], v[132:133], v[136:137]
  v_pk_add_f32 v[134:135], v[134:135], v[138:139]
  v_pk_add_f32 v[124:125], v[124:125], v[132:133]
  v_pk_add_f32 v[126:127], v[126:127], v[134:135]
  v_pk_fma_f32 v[12:13], v[12:13], v[124:125], v[32:33]
  v_pk_fma_f32 v[14:15], v[14:15], v[126:127], v[34:35]
  v_cvt_pk_bf16_f32 v74, v12, v13
  v_cvt_pk_bf16_f32 v75, v14, v15
  buffer_store_dwordx4 v[72:75], v213, s[48:51], s77 offen
  s_waitcnt lgkmcnt(8)
  v_pk_add_f32 v[140:141], v[140:141], v[144:145]
  v_pk_add_f32 v[142:143], v[142:143], v[146:147]
  v_pk_add_f32 v[148:149], v[148:149], v[152:153]
  v_pk_add_f32 v[150:151], v[150:151], v[154:155]
  v_pk_add_f32 v[140:141], v[140:141], v[148:149]
  v_pk_add_f32 v[142:143], v[142:143], v[150:151]
  v_pk_fma_f32 v[16:17], v[16:17], v[140:141], v[36:37]
  v_pk_fma_f32 v[18:19], v[18:19], v[142:143], v[38:39]
  v_cvt_pk_bf16_f32 v76, v16, v17
  v_cvt_pk_bf16_f32 v77, v18, v19
  s_waitcnt lgkmcnt(4)
  v_pk_add_f32 v[156:157], v[156:157], v[160:161]
  v_pk_add_f32 v[158:159], v[158:159], v[162:163]
  v_pk_add_f32 v[164:165], v[164:165], v[168:169]
  v_pk_add_f32 v[166:167], v[166:167], v[170:171]
  v_pk_add_f32 v[156:157], v[156:157], v[164:165]
  v_pk_add_f32 v[158:159], v[158:159], v[166:167]
  v_pk_fma_f32 v[20:21], v[20:21], v[156:157], v[40:41]
  v_pk_fma_f32 v[22:23], v[22:23], v[158:159], v[42:43]
  v_cvt_pk_bf16_f32 v78, v20, v21
  v_cvt_pk_bf16_f32 v79, v22, v23
  buffer_store_dwordx4 v[76:79], v213, s[48:51], s77 offen offset:16
  s_waitcnt lgkmcnt(0)
  v_pk_add_f32 v[172:173], v[172:173], v[176:177]
  v_pk_add_f32 v[174:175], v[174:175], v[178:179]
  v_pk_add_f32 v[180:181], v[180:181], v[184:185]
  v_pk_add_f32 v[182:183], v[182:183], v[186:187]
  v_pk_add_f32 v[172:173], v[172:173], v[180:181]
  v_pk_add_f32 v[174:175], v[174:175], v[182:183]
  v_pk_fma_f32 v[24:25], v[24:25], v[172:173], v[44:45]
  v_pk_fma_f32 v[26:27], v[26:27], v[174:175], v[46:47]
  v_cvt_pk_bf16_f32 v80, v24, v25
  v_cvt_pk_bf16_f32 v81, v26, v27
  buffer_store_dwordx2 v[80:81], v213, s[48:51], s77 offen offset:32
  s_branch L_end
L_ld0:
  s_setprio 2
  s_cmp_ge_u32 s61, 2
  s_cselect_b32 s78, 2, 1
  s_cmp_eq_u32 s78, 2
  s_cbranch_scc1 L_sd0
  v_lshrrev_b32 v2, 3, v0
  v_mul_u32_u24 v2, 1280, v2
  v_lshrrev_b32 v3, 4, v0
  v_and_b32 v4, 7, v0
  v_add_u32 v5, 0, v3
  v_xor_b32 v5, v5, v4
  v_lshl_add_u32 v5, v5, 4, v2
  v_add_u32 v8, 0, v5
  v_add_u32 v5, 4, v3
  v_xor_b32 v5, v5, v4
  v_lshl_add_u32 v5, v5, 4, v2
  v_add_u32 v9, 9216, v5
  v_add_u32 v5, 0, v3
  v_xor_b32 v5, v5, v4
  v_lshl_add_u32 v5, v5, 4, v2
  v_add_u32 v10, 18432, v5
  v_add_u32 v5, 4, v3
  v_xor_b32 v5, v5, v4
  v_lshl_add_u32 v5, v5, 4, v2
  v_add_u32 v11, 27648, v5
  s_mov_b32 s64, 21846
  v_add_u32 v2, 0, v0
  v_mul_u32_u24 v3, s64, v2
  v_lshrrev_b32 v3, 18, v3
  v_mul_u32_u24 v4, 12, v3
  v_sub_u32 v4, v2, v4
  v_bfe_u32 v5, v3, 3, 1
  v_lshlrev_b32 v5, 1, v5
  v_sub_u32 v4, v4, v5
  v_add_u32 v5, 12, v4
  v_min_u32 v4, v4, v5
  v_mul_u32_u24 v3, 3072, v3
  v_lshl_add_u32 v3, v4, 4, v3
  v_subrev_u32 v12, 0, v3
  v_add_u32 v2, 64, v0
  v_mul_u32_u24 v3, s64, v2
  v_lshrrev_b32 v3, 18, v3
  v_mul_u32_u24 v4, 12, v3
  v_sub_u32 v4, v2, v4
  v_bfe_u32 v5, v3, 3, 1
  v_lshlrev_b32 v5, 1, v5
  v_sub_u32 v4, v4, v5
  v_add_u32 v5, 12, v4
  v_min_u32 v4, v4, v5
  v_mul_u32_u24 v3, 3072, v3
  v_lshl_add_u32 v3, v4, 4, v3
  v_subrev_u32 v13, 1024, v3
  v_add_u32 v2, 128, v0
  v_mul_u32_u24 v3, s64, v2
  v_lshrrev_b32 v3, 18, v3
  v_mul_u32_u24 v4, 12, v3
  v_sub_u32 v4, v2, v4
  v_bfe_u32 v5, v3, 3, 1
  v_lshlrev_b32 v5, 1, v5
  v_sub_u32 v4, v4, v5
  v_add_u32 v5, 12, v4
  v_min_u32 v4, v4, v5
  v_mul_u32_u24 v3, 3072, v3
  v_lshl_add_u32 v3, v4, 4, v3
  v_subrev_u32 v14, 2048, v3
  v_add_u32 v2, 192, v0
  v_mul_u32_u24 v3, s64, v2
  v_lshrrev_b32 v3, 18, v3
  v_mul_u32_u24 v4, 12, v3
  v_sub_u32 v4, v2, v4
  v_bfe_u32 v5, v3, 3, 1
  v_lshlrev_b32 v5, 1, v5
  v_sub_u32 v4, v4, v5
  v_add_u32 v5, 12, v4
  v_min_u32 v4, v4, v5
  v_mul_u32_u24 v3, 3072, v3
  v_lshl_add_u32 v3, v4, 4, v3
  v_subrev_u32 v15, 3072, v3
  v_add_u32 v2, 256, v0
  v_mul_u32_u24 v3, s64, v2
  v_lshrrev_b32 v3, 18, v3
  v_mul_u32_u24 v4, 12, v3
  v_sub_u32 v4, v2, v4
  v_bfe_u32 v5, v3, 3, 1
  v_lshlrev_b32 v5, 1, v5
  v_sub_u32 v4, v4, v5
  v_add_u32 v5, 12, v4
  v_min_u32 v4, v4, v5
  v_mul_u32_u24 v3, 3072, v3
  v_lshl_add_u32 v3, v4, 4, v3
  v_subrev_u32 v16, 0, v3
  v_add_u32 v2, 320, v0
  v_mul_u32_u24 v3, s64, v2
  v_lshrrev_b32 v3, 18, v3
  v_mul_u32_u24 v4, 12, v3
  v_sub_u32 v4, v2, v4
  v_bfe_u32 v5, v3, 3, 1
  v_lshlrev_b32 v5, 1, v5
  v_sub_u32 v4, v4, v5
  v_add_u32 v5, 12, v4
  v_min_u32 v4, v4, v5
  v_mul_u32_u24 v3, 3072, v3
  v_lshl_add_u32 v3, v4, 4, v3
  v_subrev_u32 v17, 1024, v3
  s_lshl1_add_u32 s66, s54, s61
  s_mul_i32 s66, s66, 81920
  s_mul_i32 s67, s55, 192
  s_lshl_b32 s68, s61, 13
  s_mul_i32 s69, s61, 12320
  s_add_u32 s69, s69, 16384
  s_lshl_b32 s62, s56, 7
  s_add_u32 s62, s62, s66
  s_add_u32 m0, s68, 0
  s_mul_i32 s79, s56, 196608
  s_add_u32 s79, s79, s67
  buffer_load_dwordx4 v8, s[24:27], s62 offen offset:0 lds
  buffer_load_dwordx4 v9, s[24:27], s62 offen offset:1024 lds
  buffer_load_dwordx4 v10, s[24:27], s62 offen offset:2048 lds
  buffer_load_dwordx4 v11, s[24:27], s62 offen offset:3072 lds
  s_add_u32 m0, s68, 4096
  s_add_u32 s62, s62, 40960
  buffer_load_dwordx4 v8, s[24:27], s62 offen offset:0 lds
  buffer_load_dwordx4 v9, s[24:27], s62 offen offset:1024 lds
  buffer_load_dwordx4 v10, s[24:27], s62 offen offset:2048 lds
  buffer_load_dwordx4 v11, s[24:27], s62 offen offset:3072 lds
  s_add_u32 m0, s69, 0
  s_add_u32 s56, s56, 1
  s_cmp_eq_u32 s56, 10
  s_cselect_b32 s56, 0, s56
  buffer_load_dwordx4 v12, s[32:35], s79 offen offset:0 lds
  buffer_load_dwordx4 v13, s[32:35], s79 offen offset:1024 lds
  buffer_load_dwordx4 v14, s[32:35], s79 offen offset:2048 lds
  buffer_load_dwordx4 v15, s[32:35], s79 offen offset:3072 lds
  s_add_u32 m0, s69, 4096
  s_nop 0
  buffer_load_dwordx4 v16, s[32:35], s79 offen offset:0 lds
  buffer_load_dwordx4 v17, s[32:35], s79 offen offset:1024 lds
  s_add_u32 m0, s69, 6144
  s_add_u32 s79, s79, 98304
  buffer_load_dwordx4 v12, s[32:35], s79 offen offset:0 lds
  buffer_load_dwordx4 v13, s[32:35], s79 offen offset:1024 lds
  buffer_load_dwordx4 v14, s[32:35], s79 offen offset:2048 lds
  buffer_load_dwordx4 v15, s[32:35], s79 offen offset:3072 lds
  s_add_u32 m0, s69, 10240
  s_nop 0
  buffer_load_dwordx4 v16, s[32:35], s79 offen offset:0 lds
  buffer_load_dwordx4 v17, s[32:35], s79 offen offset:1024 lds
  s_branch L_cl
L_sd0:
  v_lshlrev_b32 v18, 4, v0
  s_mov_b32 s64, 2731
  s_mov_b32 s65, 40704
  v_add_u32 v2, 0, v0
  v_mul_u32_u24 v3, s64, v2
  v_lshrrev_b32 v3, 16, v3
  v_mad_u32_u24 v84, v3, s65, v18
  v_add_u32 v2, 64, v0
  v_mul_u32_u24 v3, s64, v2
  v_lshrrev_b32 v3, 16, v3
  v_mad_u32_u24 v85, v3, s65, v18
  v_add_u32 v2, 128, v0
  v_mul_u32_u24 v3, s64, v2
  v_lshrrev_b32 v3, 16, v3
  v_mad_u32_u24 v86, v3, s65, v18
  s_and_b32 s62, s2, 63
  s_lshr_b32 s63, s2, 6
  s_lshl_b32 s63, s63, 9
  s_add_u32 s62, s62, s63
  s_mul_i32 s62, s62, 642
  s_and_b32 s62, s62, -4
  s_and_b32 s63, s61, 1
  s_mul_i32 s64, s63, 384
  s_add_u32 s62, s62, s64
  s_mul_i32 s63, s63, 6144
  s_add_u32 m0, s63, 147648
  s_nop 0
  buffer_load_dwordx4 v84, s[36:39], s62 offen offset:0 nt lds
  buffer_load_dwordx4 v85, s[36:39], s62 offen offset:1024 nt lds
  buffer_load_dwordx4 v86, s[36:39], s62 offen offset:2048 nt lds
  s_add_u32 m0, s63, 150720
  s_nop 0
  buffer_load_dwordx4 v84, s[40:43], s62 offen offset:0 nt lds
  buffer_load_dwordx4 v85, s[40:43], s62 offen offset:1024 nt lds
  buffer_load_dwordx4 v86, s[40:43], s62 offen offset:2048 nt lds
L_cl:
  s_setprio 0
  v_and_b32 v60, 15, v0
  v_lshrrev_b32 v61, 4, v0
  v_cvt_f32_u32 v62, v60
  v_lshlrev_b32 v61, 2, v61
  v_cvt_f32_u32 v63, v61
  s_lshl_b32 s62, s61, 4
  v_cvt_f32_u32 v64, s62
  v_add_f32 v65, v62, v64
  v_mul_f32 v66, 0x3c800000, v65
  v_mul_f32 v67, v63, v66
  v_fmamk_f32 v71, v66, 0x3f800000, v67
  v_fmamk_f32 v72, v66, 0x40000000, v67
  v_fmamk_f32 v73, v66, 0x40400000, v67
  v_fmamk_f32 v74, v66, 0x41800000, v67
  v_fmamk_f32 v75, v66, 0x41880000, v67
  v_fmamk_f32 v76, v66, 0x41900000, v67
  v_fmamk_f32 v77, v66, 0x41980000, v67
  v_cos_f32 v78, v67
  v_cos_f32 v79, v71
  v_cos_f32 v80, v72
  v_cos_f32 v81, v73
  v_cos_f32 v82, v74
  v_cos_f32 v83, v75
  v_cos_f32 v84, v76
  v_cos_f32 v85, v77
  v_sin_f32 v86, v67
  v_sin_f32 v87, v71
  v_sin_f32 v88, v72
  v_sin_f32 v89, v73
  v_sin_f32 v90, v74
  v_sin_f32 v91, v75
  v_sin_f32 v92, v76
  v_sin_f32 v93, v77
  v_cvt_pk_bf16_f32 v208, v78, v79
  v_cvt_pk_bf16_f32 v209, v80, v81
  v_cvt_pk_bf16_f32 v210, v82, v83
  v_cvt_pk_bf16_f32 v211, v84, v85
  v_cvt_pk_bf16_f32 v216, v86, v87
  v_cvt_pk_bf16_f32 v217, v88, v89
  v_cvt_pk_bf16_f32 v218, v90, v91
  v_cvt_pk_bf16_f32 v219, v92, v93
  v_fmamk_f32 v70, v66, 0x42000000, v67
  v_fmamk_f32 v71, v66, 0x42040000, v67
  v_fmamk_f32 v72, v66, 0x42080000, v67
  v_fmamk_f32 v73, v66, 0x420c0000, v67
  v_fmamk_f32 v74, v66, 0x42400000, v67
  v_fmamk_f32 v75, v66, 0x42440000, v67
  v_fmamk_f32 v76, v66, 0x42480000, v67
  v_fmamk_f32 v77, v66, 0x424c0000, v67
  v_cos_f32 v78, v70
  v_cos_f32 v79, v71
  v_cos_f32 v80, v72
  v_cos_f32 v81, v73
  v_cos_f32 v82, v74
  v_cos_f32 v83, v75
  v_cos_f32 v84, v76
  v_cos_f32 v85, v77
  v_sin_f32 v86, v70
  v_sin_f32 v87, v71
  v_sin_f32 v88, v72
  v_sin_f32 v89, v73
  v_sin_f32 v90, v74
  v_sin_f32 v91, v75
  v_sin_f32 v92, v76
  v_sin_f32 v93, v77
  v_cvt_pk_bf16_f32 v212, v78, v79
  v_cvt_pk_bf16_f32 v213, v80, v81
  v_cvt_pk_bf16_f32 v214, v82, v83
  v_cvt_pk_bf16_f32 v215, v84, v85
  v_cvt_pk_bf16_f32 v220, v86, v87
  v_cvt_pk_bf16_f32 v221, v88, v89
  v_cvt_pk_bf16_f32 v222, v90, v91
  v_cvt_pk_bf16_f32 v223, v92, v93
  v_mul_f32 v66, 0x3a000000, v65
  v_mul_f32 v67, v63, v66
  v_fmamk_f32 v71, v66, 0x3f800000, v67
  v_fmamk_f32 v72, v66, 0x40000000, v67
  v_fmamk_f32 v73, v66, 0x40400000, v67
  v_fmamk_f32 v74, v66, 0x41800000, v67
  v_fmamk_f32 v75, v66, 0x41880000, v67
  v_fmamk_f32 v76, v66, 0x41900000, v67
  v_fmamk_f32 v77, v66, 0x41980000, v67
  v_cos_f32 v78, v67
  v_cos_f32 v79, v71
  v_cos_f32 v80, v72
  v_cos_f32 v81, v73
  v_cos_f32 v82, v74
  v_cos_f32 v83, v75
  v_cos_f32 v84, v76
  v_cos_f32 v85, v77
  v_sin_f32 v86, v67
  v_sin_f32 v87, v71
  v_sin_f32 v88, v72
  v_sin_f32 v89, v73
  v_sin_f32 v90, v74
  v_sin_f32 v91, v75
  v_sin_f32 v92, v76
  v_sin_f32 v93, v77
  v_cvt_pk_f16_f32 v240, v78, v86
  v_cvt_pk_f16_f32 v241, v79, v87
  v_cvt_pk_f16_f32 v242, v80, v88
  v_cvt_pk_f16_f32 v243, v81, v89
  v_cvt_pk_f16_f32 v244, v82, v90
  v_cvt_pk_f16_f32 v245, v83, v91
  v_cvt_pk_f16_f32 v246, v84, v92
  v_cvt_pk_f16_f32 v247, v85, v93
  v_add_f32 v64, v64, v63
  v_mul_f32 v66, 0x3d000000, v62
  v_mul_f32 v67, v63, v66
  v_fmamk_f32 v71, v66, 0x3f800000, v67
  v_fmamk_f32 v72, v66, 0x40000000, v67
  v_fmamk_f32 v73, v66, 0x40400000, v67
  v_fmamk_f32 v74, v66, 0x41800000, v67
  v_fmamk_f32 v75, v66, 0x41880000, v67
  v_fmamk_f32 v76, v66, 0x41900000, v67
  v_fmamk_f32 v77, v66, 0x41980000, v67
  v_cos_f32 v78, v67
  v_cos_f32 v79, v71
  v_cos_f32 v80, v72
  v_cos_f32 v81, v73
  v_cos_f32 v82, v74
  v_cos_f32 v83, v75
  v_cos_f32 v84, v76
  v_cos_f32 v85, v77
  v_sin_f32 v86, v67
  v_sin_f32 v87, v71
  v_sin_f32 v88, v72
  v_sin_f32 v89, v73
  v_sin_f32 v90, v74
  v_sin_f32 v91, v75
  v_sin_f32 v92, v76
  v_sin_f32 v93, v77
  v_cvt_pk_bf16_f32 v224, v78, v79
  v_cvt_pk_bf16_f32 v225, v80, v81
  v_cvt_pk_bf16_f32 v226, v82, v83
  v_cvt_pk_bf16_f32 v227, v84, v85
  v_cvt_pk_bf16_f32 v232, v86, v87
  v_cvt_pk_bf16_f32 v233, v88, v89
  v_cvt_pk_bf16_f32 v234, v90, v91
  v_cvt_pk_bf16_f32 v235, v92, v93
  v_mul_f32 v66, 0x3a000000, v62
  v_mul_f32 v67, v64, v66
  v_fmamk_f32 v71, v66, 0x3f800000, v67
  v_fmamk_f32 v72, v66, 0x40000000, v67
  v_fmamk_f32 v73, v66, 0x40400000, v67
  v_cos_f32 v74, v67
  v_cos_f32 v75, v71
  v_cos_f32 v76, v72
  v_cos_f32 v77, v73
  v_sin_f32 v78, v67
  v_sin_f32 v79, v71
  v_sin_f32 v80, v72
  v_sin_f32 v81, v73
  v_cvt_pk_f16_f32 v248, v74, v78
  v_cvt_pk_f16_f32 v249, v75, v79
  v_cvt_pk_f16_f32 v250, v76, v80
  v_cvt_pk_f16_f32 v251, v77, v81
  v_add_f32 v62, 0x41800000, v62
  v_mul_f32 v66, 0x3d000000, v62
  v_mul_f32 v67, v63, v66
  v_fmamk_f32 v71, v66, 0x3f800000, v67
  v_fmamk_f32 v72, v66, 0x40000000, v67
  v_fmamk_f32 v73, v66, 0x40400000, v67
  v_fmamk_f32 v74, v66, 0x41800000, v67
  v_fmamk_f32 v75, v66, 0x41880000, v67
  v_fmamk_f32 v76, v66, 0x41900000, v67
  v_fmamk_f32 v77, v66, 0x41980000, v67
  v_cos_f32 v78, v67
  v_cos_f32 v79, v71
  v_cos_f32 v80, v72
  v_cos_f32 v81, v73
  v_cos_f32 v82, v74
  v_cos_f32 v83, v75
  v_cos_f32 v84, v76
  v_cos_f32 v85, v77
  v_sin_f32 v86, v67
  v_sin_f32 v87, v71
  v_sin_f32 v88, v72
  v_sin_f32 v89, v73
  v_sin_f32 v90, v74
  v_sin_f32 v91, v75
  v_sin_f32 v92, v76
  v_sin_f32 v93, v77
  v_cvt_pk_bf16_f32 v228, v78, v79
  v_cvt_pk_bf16_f32 v229, v80, v81
  v_cvt_pk_bf16_f32 v230, v82, v83
  v_cvt_pk_bf16_f32 v231, v84, v85
  v_cvt_pk_bf16_f32 v236, v86, v87
  v_cvt_pk_bf16_f32 v237, v88, v89
  v_cvt_pk_bf16_f32 v238, v90, v91
  v_cvt_pk_bf16_f32 v239, v92, v93
  v_mul_f32 v66, 0x3a000000, v62
  v_mul_f32 v67, v64, v66
  v_fmamk_f32 v71, v66, 0x3f800000, v67
  v_fmamk_f32 v72, v66, 0x40000000, v67
  v_fmamk_f32 v73, v66, 0x40400000, v67
  v_cos_f32 v74, v67
  v_cos_f32 v75, v71
  v_cos_f32 v76, v72
  v_cos_f32 v77, v73
  v_sin_f32 v78, v67
  v_sin_f32 v79, v71
  v_sin_f32 v80, v72
  v_sin_f32 v81, v73
  v_cvt_pk_f16_f32 v252, v74, v78
  v_cvt_pk_f16_f32 v253, v75, v79
  v_cvt_pk_f16_f32 v254, v76, v80
  v_cvt_pk_f16_f32 v255, v77, v81
  v_xor_b32 v192, 0x80008000, v216
  v_xor_b32 v200, 0x80008000, v232
  v_xor_b32 v193, 0x80008000, v217
  v_xor_b32 v201, 0x80008000, v233
  v_xor_b32 v194, 0x80008000, v218
  v_xor_b32 v202, 0x80008000, v234
  v_xor_b32 v195, 0x80008000, v219
  v_xor_b32 v203, 0x80008000, v235
  v_xor_b32 v196, 0x80008000, v220
  v_xor_b32 v204, 0x80008000, v236
  v_xor_b32 v197, 0x80008000, v221
  v_xor_b32 v205, 0x80008000, v237
  v_xor_b32 v198, 0x80008000, v222
  v_xor_b32 v206, 0x80008000, v238
  v_xor_b32 v199, 0x80008000, v223
  v_xor_b32 v207, 0x80008000, v239
  v_lshlrev_b32 v18, 4, v0
  v_lshlrev_b32 v2, 2, v0
  v_add_u32 v2, 163584, v2
  v_mov_b32 v3, 0
  s_mov_b64 exec, 0xff0ff
  ds_write_b32 v2, v3
  s_mov_b64 exec, -1
  s_cmp_eq_u32 s78, 2
  s_cbranch_scc1 L_sd1
  s_lshl_b32 s62, s56, 7
  s_add_u32 s62, s62, s66
  s_add_u32 m0, s68, 41024
  s_mul_i32 s79, s56, 196608
  s_add_u32 s79, s79, s67
  buffer_load_dwordx4 v8, s[24:27], s62 offen offset:0 lds
  buffer_load_dwordx4 v9, s[24:27], s62 offen offset:1024 lds
  buffer_load_dwordx4 v10, s[24:27], s62 offen offset:2048 lds
  buffer_load_dwordx4 v11, s[24:27], s62 offen offset:3072 lds
  s_add_u32 m0, s68, 45120
  s_add_u32 s62, s62, 40960
  buffer_load_dwordx4 v8, s[24:27], s62 offen offset:0 lds
  buffer_load_dwordx4 v9, s[24:27], s62 offen offset:1024 lds
  buffer_load_dwordx4 v10, s[24:27], s62 offen offset:2048 lds
  buffer_load_dwordx4 v11, s[24:27], s62 offen offset:3072 lds
  s_add_u32 m0, s69, 41024
  s_add_u32 s56, s56, 1
  s_cmp_eq_u32 s56, 10
  s_cselect_b32 s56, 0, s56
  buffer_load_dwordx4 v12, s[32:35], s79 offen offset:0 lds
  buffer_load_dwordx4 v13, s[32:35], s79 offen offset:1024 lds
  buffer_load_dwordx4 v14, s[32:35], s79 offen offset:2048 lds
  buffer_load_dwordx4 v15, s[32:35], s79 offen offset:3072 lds
  s_waitcnt vmcnt(32)
  v_readfirstlane_b32 s60, v1
  s_nop 0
  s_mul_i32 s60, s60, 0x9e3779b1
  s_add_u32 s60, s60, 0x7f4a7c15
  s_waitcnt lgkmcnt(0)
  s_waitcnt vmcnt(12)
  s_barrier
  s_add_u32 m0, s69, 45120
  s_nop 0
  buffer_load_dwordx4 v16, s[32:35], s79 offen offset:0 lds
  buffer_load_dwordx4 v17, s[32:35], s79 offen offset:1024 lds
  s_add_u32 m0, s69, 47168
  s_add_u32 s79, s79, 98304
  buffer_load_dwordx4 v12, s[32:35], s79 offen offset:0 lds
  buffer_load_dwordx4 v13, s[32:35], s79 offen offset:1024 lds
  buffer_load_dwordx4 v14, s[32:35], s79 offen offset:2048 lds
  buffer_load_dwordx4 v15, s[32:35], s79 offen offset:3072 lds
  s_add_u32 m0, s69, 51264
  s_nop 0
  buffer_load_dwordx4 v16, s[32:35], s79 offen offset:0 lds
  buffer_load_dwordx4 v17, s[32:35], s79 offen offset:1024 lds
  s_lshl_b32 s62, s56, 7
  s_add_u32 s62, s62, s66
  s_add_u32 m0, s68, 82048
  s_mul_i32 s79, s56, 196608
  s_add_u32 s79, s79, s67
  buffer_load_dwordx4 v8, s[24:27], s62 offen offset:0 lds
  buffer_load_dwordx4 v9, s[24:27], s62 offen offset:1024 lds
  buffer_load_dwordx4 v10, s[24:27], s62 offen offset:2048 lds
  buffer_load_dwordx4 v11, s[24:27], s62 offen offset:3072 lds
  s_add_u32 m0, s68, 86144
  s_add_u32 s62, s62, 40960
  buffer_load_dwordx4 v8, s[24:27], s62 offen offset:0 lds
  buffer_load_dwordx4 v9, s[24:27], s62 offen offset:1024 lds
  buffer_load_dwordx4 v10, s[24:27], s62 offen offset:2048 lds
  buffer_load_dwordx4 v11, s[24:27], s62 offen offset:3072 lds
  s_add_u32 m0, s69, 82048
  s_add_u32 s56, s56, 1
  s_cmp_eq_u32 s56, 10
  s_cselect_b32 s56, 0, s56
  buffer_load_dwordx4 v12, s[32:35], s79 offen offset:0 lds
  buffer_load_dwordx4 v13, s[32:35], s79 offen offset:1024 lds
  buffer_load_dwordx4 v14, s[32:35], s79 offen offset:2048 lds
  buffer_load_dwordx4 v15, s[32:35], s79 offen offset:3072 lds
  s_add_u32 m0, s69, 86144
  s_nop 0
  buffer_load_dwordx4 v16, s[32:35], s79 offen offset:0 lds
  buffer_load_dwordx4 v17, s[32:35], s79 offen offset:1024 lds
  s_add_u32 m0, s69, 88192
  s_add_u32 s79, s79, 98304
  buffer_load_dwordx4 v12, s[32:35], s79 offen offset:0 lds
  buffer_load_dwordx4 v13, s[32:35], s79 offen offset:1024 lds
  buffer_load_dwordx4 v14, s[32:35], s79 offen offset:2048 lds
  buffer_load_dwordx4 v15, s[32:35], s79 offen offset:3072 lds
  s_add_u32 m0, s69, 92288
  s_nop 0
  buffer_load_dwordx4 v16, s[32:35], s79 offen offset:0 lds
  buffer_load_dwordx4 v17, s[32:35], s79 offen offset:1024 lds
  s_waitcnt vmcnt(20)
  s_barrier
  s_lshl_b32 s62, s56, 7
  s_add_u32 s62, s62, s66
  s_add_u32 m0, s68, 0
  s_mul_i32 s79, s56, 196608
  s_add_u32 s79, s79, s67
  buffer_load_dwordx4 v8, s[24:27], s62 offen offset:0 lds
  buffer_load_dwordx4 v9, s[24:27], s62 offen offset:1024 lds
  buffer_load_dwordx4 v10, s[24:27], s62 offen offset:2048 lds
  buffer_load_dwordx4 v11, s[24:27], s62 offen offset:3072 lds
  s_add_u32 m0, s68, 4096
  s_add_u32 s62, s62, 40960
  buffer_load_dwordx4 v8, s[24:27], s62 offen offset:0 lds
  buffer_load_dwordx4 v9, s[24:27], s62 offen offset:1024 lds
  buffer_load_dwordx4 v10, s[24:27], s62 offen offset:2048 lds
  buffer_load_dwordx4 v11, s[24:27], s62 offen offset:3072 lds
  s_add_u32 m0, s69, 0
  s_add_u32 s56, s56, 1
  s_cmp_eq_u32 s56, 10
  s_cselect_b32 s56, 0, s56
  buffer_load_dwordx4 v12, s[32:35], s79 offen offset:0 lds
  buffer_load_dwordx4 v13, s[32:35], s79 offen offset:1024 lds
  buffer_load_dwordx4 v14, s[32:35], s79 offen offset:2048 lds
  buffer_load_dwordx4 v15, s[32:35], s79 offen offset:3072 lds
  s_add_u32 m0, s69, 4096
  s_nop 0
  buffer_load_dwordx4 v16, s[32:35], s79 offen offset:0 lds
  buffer_load_dwordx4 v17, s[32:35], s79 offen offset:1024 lds
  s_add_u32 m0, s69, 6144
  s_add_u32 s79, s79, 98304
  buffer_load_dwordx4 v12, s[32:35], s79 offen offset:0 lds
  buffer_load_dwordx4 v13, s[32:35], s79 offen offset:1024 lds
  buffer_load_dwordx4 v14, s[32:35], s79 offen offset:2048 lds
  buffer_load_dwordx4 v15, s[32:35], s79 offen offset:3072 lds
  s_add_u32 m0, s69, 10240
  s_nop 0
  buffer_load_dwordx4 v16, s[32:35], s79 offen offset:0 lds
  buffer_load_dwordx4 v17, s[32:35], s79 offen offset:1024 lds
  s_waitcnt vmcnt(20)
  s_barrier
  s_lshl_b32 s62, s56, 7
  s_add_u32 s62, s62, s66
  s_add_u32 m0, s68, 41024
  s_mul_i32 s79, s56, 196608
  s_add_u32 s79, s79, s67
  buffer_load_dwordx4 v8, s[24:27], s62 offen offset:0 lds
  buffer_load_dwordx4 v9, s[24:27], s62 offen offset:1024 lds
  buffer_load_dwordx4 v10, s[24:27], s62 offen offset:2048 lds
  buffer_load_dwordx4 v11, s[24:27], s62 offen offset:3072 lds
  s_add_u32 m0, s68, 45120
  s_add_u32 s62, s62, 40960
  buffer_load_dwordx4 v8, s[24:27], s62 offen offset:0 lds
  buffer_load_dwordx4 v9, s[24:27], s62 offen offset:1024 lds
  buffer_load_dwordx4 v10, s[24:27], s62 offen offset:2048 lds
  buffer_load_dwordx4 v11, s[24:27], s62 offen offset:3072 lds
  s_add_u32 m0, s69, 41024
  s_add_u32 s56, s56, 1
  s_cmp_eq_u32 s56, 10
  s_cselect_b32 s56, 0, s56
  buffer_load_dwordx4 v12, s[32:35], s79 offen offset:0 lds
  buffer_load_dwordx4 v13, s[32:35], s79 offen offset:1024 lds
  buffer_load_dwordx4 v14, s[32:35], s79 offen offset:2048 lds
  buffer_load_dwordx4 v15, s[32:35], s79 offen offset:3072 lds
  s_add_u32 m0, s69, 45120
  s_nop 0
  buffer_load_dwordx4 v16, s[32:35], s79 offen offset:0 lds
  buffer_load_dwordx4 v17, s[32:35], s79 offen offset:1024 lds
  s_add_u32 m0, s69, 47168
  s_add_u32 s79, s79, 98304
  buffer_load_dwordx4 v12, s[32:35], s79 offen offset:0 lds
  buffer_load_dwordx4 v13, s[32:35], s79 offen offset:1024 lds
  buffer_load_dwordx4 v14, s[32:35], s79 offen offset:2048 lds
  buffer_load_dwordx4 v15, s[32:35], s79 offen offset:3072 lds
  s_add_u32 m0, s69, 51264
  s_nop 0
  buffer_load_dwordx4 v16, s[32:35], s79 offen offset:0 lds
  buffer_load_dwordx4 v17, s[32:35], s79 offen offset:1024 lds
  s_waitcnt vmcnt(20)
  s_barrier
  s_lshl_b32 s62, s56, 7
  s_add_u32 s62, s62, s66
  s_add_u32 m0, s68, 82048
  s_mul_i32 s79, s56, 196608
  s_add_u32 s79, s79, s67
  buffer_load_dwordx4 v8, s[24:27], s62 offen offset:0 lds
  buffer_load_dwordx4 v9, s[24:27], s62 offen offset:1024 lds
  buffer_load_dwordx4 v10, s[24:27], s62 offen offset:2048 lds
  buffer_load_dwordx4 v11, s[24:27], s62 offen offset:3072 lds
  s_add_u32 m0, s68, 86144
  s_add_u32 s62, s62, 40960
  buffer_load_dwordx4 v8, s[24:27], s62 offen offset:0 lds
  buffer_load_dwordx4 v9, s[24:27], s62 offen offset:1024 lds
  buffer_load_dwordx4 v10, s[24:27], s62 offen offset:2048 lds
  buffer_load_dwordx4 v11, s[24:27], s62 offen offset:3072 lds
  s_add_u32 m0, s69, 82048
  s_add_u32 s56, s56, 1
  s_cmp_eq_u32 s56, 10
  s_cselect_b32 s56, 0, s56
  buffer_load_dwordx4 v12, s[32:35], s79 offen offset:0 lds
  buffer_load_dwordx4 v13, s[32:35], s79 offen offset:1024 lds
  buffer_load_dwordx4 v14, s[32:35], s79 offen offset:2048 lds
  buffer_load_dwordx4 v15, s[32:35], s79 offen offset:3072 lds
  s_add_u32 m0, s69, 86144
  s_nop 0
  buffer_load_dwordx4 v16, s[32:35], s79 offen offset:0 lds
  buffer_load_dwordx4 v17, s[32:35], s79 offen offset:1024 lds
  s_add_u32 m0, s69, 88192
  s_add_u32 s79, s79, 98304
  buffer_load_dwordx4 v12, s[32:35], s79 offen offset:0 lds
  buffer_load_dwordx4 v13, s[32:35], s79 offen offset:1024 lds
  buffer_load_dwordx4 v14, s[32:35], s79 offen offset:2048 lds
  buffer_load_dwordx4 v15, s[32:35], s79 offen offset:3072 lds
  s_add_u32 m0, s69, 92288
  s_nop 0
  buffer_load_dwordx4 v16, s[32:35], s79 offen offset:0 lds
  buffer_load_dwordx4 v17, s[32:35], s79 offen offset:1024 lds
  s_waitcnt vmcnt(20)
  s_barrier
  s_lshl_b32 s62, s56, 7
  s_add_u32 s62, s62, s66
  s_add_u32 m0, s68, 0
  s_mul_i32 s79, s56, 196608
  s_add_u32 s79, s79, s67
  buffer_load_dwordx4 v8, s[24:27], s62 offen offset:0 lds
  buffer_load_dwordx4 v9, s[24:27], s62 offen offset:1024 lds
  buffer_load_dwordx4 v10, s[24:27], s62 offen offset:2048 lds
  buffer_load_dwordx4 v11, s[24:27], s62 offen offset:3072 lds
  s_add_u32 m0, s68, 4096
  s_add_u32 s62, s62, 40960
  buffer_load_dwordx4 v8, s[24:27], s62 offen offset:0 lds
  buffer_load_dwordx4 v9, s[24:27], s62 offen offset:1024 lds
  buffer_load_dwordx4 v10, s[24:27], s62 offen offset:2048 lds
  buffer_load_dwordx4 v11, s[24:27], s62 offen offset:3072 lds
  s_add_u32 m0, s69, 0
  s_add_u32 s56, s56, 1
  s_cmp_eq_u32 s56, 10
  s_cselect_b32 s56, 0, s56
  buffer_load_dwordx4 v12, s[32:35], s79 offen offset:0 lds
  buffer_load_dwordx4 v13, s[32:35], s79 offen offset:1024 lds
  buffer_load_dwordx4 v14, s[32:35], s79 offen offset:2048 lds
  buffer_load_dwordx4 v15, s[32:35], s79 offen offset:3072 lds
  s_add_u32 m0, s69, 4096
  s_nop 0
  buffer_load_dwordx4 v16, s[32:35], s79 offen offset:0 lds
  buffer_load_dwordx4 v17, s[32:35], s79 offen offset:1024 lds
  s_add_u32 m0, s69, 6144
  s_add_u32 s79, s79, 98304
  buffer_load_dwordx4 v12, s[32:35], s79 offen offset:0 lds
  buffer_load_dwordx4 v13, s[32:35], s79 offen offset:1024 lds
  buffer_load_dwordx4 v14, s[32:35], s79 offen offset:2048 lds
  buffer_load_dwordx4 v15, s[32:35], s79 offen offset:3072 lds
  s_add_u32 m0, s69, 10240
  s_nop 0
  buffer_load_dwordx4 v16, s[32:35], s79 offen offset:0 lds
  buffer_load_dwordx4 v17, s[32:35], s79 offen offset:1024 lds
  s_waitcnt vmcnt(20)
  s_barrier
  s_lshl_b32 s62, s56, 7
  s_add_u32 s62, s62, s66
  s_add_u32 m0, s68, 41024
  s_mul_i32 s79, s56, 196608
  s_add_u32 s79, s79, s67
  buffer_load_dwordx4 v8, s[24:27], s62 offen offset:0 lds
  buffer_load_dwordx4 v9, s[24:27], s62 offen offset:1024 lds
  buffer_load_dwordx4 v10, s[24:27], s62 offen offset:2048 lds
  buffer_load_dwordx4 v11, s[24:27], s62 offen offset:3072 lds
  s_add_u32 m0, s68, 45120
  s_add_u32 s62, s62, 40960
  buffer_load_dwordx4 v8, s[24:27], s62 offen offset:0 lds
  buffer_load_dwordx4 v9, s[24:27], s62 offen offset:1024 lds
  buffer_load_dwordx4 v10, s[24:27], s62 offen offset:2048 lds
  buffer_load_dwordx4 v11, s[24:27], s62 offen offset:3072 lds
  s_add_u32 m0, s69, 41024
  s_add_u32 s56, s56, 1
  s_cmp_eq_u32 s56, 10
  s_cselect_b32 s56, 0, s56
  buffer_load_dwordx4 v12, s[32:35], s79 offen offset:0 lds
  buffer_load_dwordx4 v13, s[32:35], s79 offen offset:1024 lds
  buffer_load_dwordx4 v14, s[32:35], s79 offen offset:2048 lds
  buffer_load_dwordx4 v15, s[32:35], s79 offen offset:3072 lds
  s_add_u32 m0, s69, 45120
  s_nop 0
  buffer_load_dwordx4 v16, s[32:35], s79 offen offset:0 lds
  buffer_load_dwordx4 v17, s[32:35], s79 offen offset:1024 lds
  s_add_u32 m0, s69, 47168
  s_add_u32 s79, s79, 98304
  buffer_load_dwordx4 v12, s[32:35], s79 offen offset:0 lds
  buffer_load_dwordx4 v13, s[32:35], s79 offen offset:1024 lds
  buffer_load_dwordx4 v14, s[32:35], s79 offen offset:2048 lds
  buffer_load_dwordx4 v15, s[32:35], s79 offen offset:3072 lds
  s_add_u32 m0, s69, 51264
  s_nop 0
  buffer_load_dwordx4 v16, s[32:35], s79 offen offset:0 lds
  buffer_load_dwordx4 v17, s[32:35], s79 offen offset:1024 lds
  s_waitcnt vmcnt(20)
  s_barrier
  s_lshl_b32 s62, s56, 7
  s_add_u32 s62, s62, s66
  s_add_u32 m0, s68, 82048
  s_mul_i32 s79, s56, 196608
  s_add_u32 s79, s79, s67
  buffer_load_dwordx4 v8, s[24:27], s62 offen offset:0 lds
  buffer_load_dwordx4 v9, s[24:27], s62 offen offset:1024 lds
  buffer_load_dwordx4 v10, s[24:27], s62 offen offset:2048 lds
  buffer_load_dwordx4 v11, s[24:27], s62 offen offset:3072 lds
  s_add_u32 m0, s68, 86144
  s_add_u32 s62, s62, 40960
  buffer_load_dwordx4 v8, s[24:27], s62 offen offset:0 lds
  buffer_load_dwordx4 v9, s[24:27], s62 offen offset:1024 lds
  buffer_load_dwordx4 v10, s[24:27], s62 offen offset:2048 lds
  buffer_load_dwordx4 v11, s[24:27], s62 offen offset:3072 lds
  s_add_u32 m0, s69, 82048
  s_add_u32 s56, s56, 1
  s_cmp_eq_u32 s56, 10
  s_cselect_b32 s56, 0, s56
  buffer_load_dwordx4 v12, s[32:35], s79 offen offset:0 lds
  buffer_load_dwordx4 v13, s[32:35], s79 offen offset:1024 lds
  buffer_load_dwordx4 v14, s[32:35], s79 offen offset:2048 lds
  buffer_load_dwordx4 v15, s[32:35], s79 offen offset:3072 lds
  s_add_u32 m0, s69, 86144
  s_nop 0
  buffer_load_dwordx4 v16, s[32:35], s79 offen offset:0 lds
  buffer_load_dwordx4 v17, s[32:35], s79 offen offset:1024 lds
  s_add_u32 m0, s69, 88192
  s_add_u32 s79, s79, 98304
  buffer_load_dwordx4 v12, s[32:35], s79 offen offset:0 lds
  buffer_load_dwordx4 v13, s[32:35], s79 offen offset:1024 lds
  buffer_load_dwordx4 v14, s[32:35], s79 offen offset:2048 lds
  buffer_load_dwordx4 v15, s[32:35], s79 offen offset:3072 lds
  s_add_u32 m0, s69, 92288
  s_nop 0
  buffer_load_dwordx4 v16, s[32:35], s79 offen offset:0 lds
  buffer_load_dwordx4 v17, s[32:35], s79 offen offset:1024 lds
  s_waitcnt vmcnt(20)
  s_barrier
  s_lshl_b32 s62, s56, 7
  s_add_u32 s62, s62, s66
  s_add_u32 m0, s68, 0
  s_mul_i32 s79, s56, 196608
  s_add_u32 s79, s79, s67
  buffer_load_dwordx4 v8, s[24:27], s62 offen offset:0 lds
  buffer_load_dwordx4 v9, s[24:27], s62 offen offset:1024 lds
  buffer_load_dwordx4 v10, s[24:27], s62 offen offset:2048 lds
  buffer_load_dwordx4 v11, s[24:27], s62 offen offset:3072 lds
  s_add_u32 m0, s68, 4096
  s_add_u32 s62, s62, 40960
  buffer_load_dwordx4 v8, s[24:27], s62 offen offset:0 lds
  buffer_load_dwordx4 v9, s[24:27], s62 offen offset:1024 lds
  buffer_load_dwordx4 v10, s[24:27], s62 offen offset:2048 lds
  buffer_load_dwordx4 v11, s[24:27], s62 offen offset:3072 lds
  s_add_u32 m0, s69, 0
  s_add_u32 s56, s56, 1
  s_cmp_eq_u32 s56, 10
  s_cselect_b32 s56, 0, s56
  buffer_load_dwordx4 v12, s[32:35], s79 offen offset:0 lds
  buffer_load_dwordx4 v13, s[32:35], s79 offen offset:1024 lds
  buffer_load_dwordx4 v14, s[32:35], s79 offen offset:2048 lds
  buffer_load_dwordx4 v15, s[32:35], s79 offen offset:3072 lds
  s_add_u32 m0, s69, 4096
  s_nop 0
  buffer_load_dwordx4 v16, s[32:35], s79 offen offset:0 lds
  buffer_load_dwordx4 v17, s[32:35], s79 offen offset:1024 lds
  s_add_u32 m0, s69, 6144
  s_add_u32 s79, s79, 98304
  buffer_load_dwordx4 v12, s[32:35], s79 offen offset:0 lds
  buffer_load_dwordx4 v13, s[32:35], s79 offen offset:1024 lds
  buffer_load_dwordx4 v14, s[32:35], s79 offen offset:2048 lds
  buffer_load_dwordx4 v15, s[32:35], s79 offen offset:3072 lds
  s_add_u32 m0, s69, 10240
  s_nop 0
  buffer_load_dwordx4 v16, s[32:35], s79 offen offset:0 lds
  buffer_load_dwordx4 v17, s[32:35], s79 offen offset:1024 lds
  s_waitcnt vmcnt(20)
  s_barrier
  v_lshlrev_b32 v22, 4, v0
  v_add_u32 v23, 1024, v22
  s_lshl_b32 s77, s61, 11
  s_add_u32 s77, s77, 40960
  buffer_load_dword v20, v22, s[28:31], s77 offen sc1
  buffer_load_dword v21, v23, s[28:31], s77 offen sc1
  s_waitcnt vmcnt(2)
  s_mov_b32 s73, 20000
  s_waitcnt vmcnt(0)
  s_branch L_pchk38
L_poll36:
  buffer_load_dword v20, v22, s[28:31], s77 offen sc1
  buffer_load_dword v21, v23, s[28:31], s77 offen sc1
  s_waitcnt vmcnt(0)
L_pchk38:
  v_cmp_eq_u32 vcc, s60, v20
  v_cmp_eq_u32 s[74:75], s60, v21
  s_nop 0
  s_and_b64 vcc, vcc, s[74:75]
  s_cmp_eq_u64 vcc, exec
  s_cbranch_scc1 L_pdone37
  s_sub_u32 s73, s73, 1
  s_cmp_eq_u32 s73, 0
  s_cbranch_scc1 L_pdone37
  s_sleep 8
  s_branch L_poll36
L_pdone37:
  s_barrier
  s_branch L_lj
L_sd1:
  s_setprio 1
  s_waitcnt vmcnt(6)
  v_readfirstlane_b32 s60, v1
  s_nop 0
  s_mul_i32 s60, s60, 0x9e3779b1
  s_add_u32 s60, s60, 0x7f4a7c15
  s_lshr_b32 s62, s53, 2
  s_mul_i32 s66, s52, 6
  s_add_u32 s66, s66, s62
  s_lshr_b32 s67, s66, 4
  s_cmp_eq_u32 s67, 2
  s_cselect_b32 s63, 40960, 0
  v_add_u32 v3, 0, v0
  v_mul_u32_u24 v3, 6554, v3
  v_lshrrev_b32 v3, 16, v3
  v_lshrrev_b32 v4, 4, v3
  v_mul_u32_u24 v4, s63, v4
  v_mul_u32_u24 v3, 1120, v3
  v_add3_u32 v8, v3, v4, v18
  v_add_u32 v3, 64, v0
  v_mul_u32_u24 v3, 6554, v3
  v_lshrrev_b32 v3, 16, v3
  v_lshrrev_b32 v4, 4, v3
  v_mul_u32_u24 v4, s63, v4
  v_mul_u32_u24 v3, 1120, v3
  v_add3_u32 v9, v3, v4, v18
  v_add_u32 v3, 128, v0
  v_mul_u32_u24 v3, 6554, v3
  v_lshrrev_b32 v3, 16, v3
  v_lshrrev_b32 v4, 4, v3
  v_mul_u32_u24 v4, s63, v4
  v_mul_u32_u24 v3, 1120, v3
  v_add3_u32 v10, v3, v4, v18
  v_add_u32 v3, 192, v0
  v_mul_u32_u24 v3, 6554, v3
  v_lshrrev_b32 v3, 16, v3
  v_lshrrev_b32 v4, 4, v3
  v_mul_u32_u24 v4, s63, v4
  v_mul_u32_u24 v3, 1120, v3
  v_add3_u32 v11, v3, v4, v18
  v_add_u32 v3, 256, v0
  v_mul_u32_u24 v3, 6554, v3
  v_lshrrev_b32 v3, 16, v3
  v_lshrrev_b32 v4, 4, v3
  v_mul_u32_u24 v4, s63, v4
  v_mul_u32_u24 v3, 1120, v3
  v_add3_u32 v12, v3, v4, v18
  v_add_u32 v12, 4096, v12
  s_waitcnt lgkmcnt(0)
  s_barrier
  s_and_b32 s62, s61, 1
  s_mul_i32 s62, s62, 6144
  s_add_u32 s63, s62, 135360
  v_add_u32 v3, s63, v18
  ds_read_b128 v[60:63], v3 offset:0
  ds_read_b128 v[64:67], v3 offset:1024
  ds_read_b128 v[68:71], v3 offset:2048
  ds_read_b128 v[72:75], v3 offset:3072
  ds_read_b128 v[76:79], v3 offset:4096
  ds_read_b128 v[80:83], v3 offset:5120
  s_barrier
  s_and_b32 s62, s61, 1
  s_mul_i32 s62, s62, 6144
  s_mul_i32 s63, s2, 11392
  s_add_u32 s62, s62, s63
  s_add_u32 s62, s62, 262144
  s_waitcnt lgkmcnt(5)
  buffer_store_dwordx4 v[60:63], v18, s[28:31], s62 offen offset:0 sc1
  s_waitcnt lgkmcnt(4)
  buffer_store_dwordx4 v[64:67], v18, s[28:31], s62 offen offset:1024 sc1
  s_waitcnt lgkmcnt(3)
  buffer_store_dwordx4 v[68:71], v18, s[28:31], s62 offen offset:2048 sc1
  s_waitcnt lgkmcnt(2)
  buffer_store_dwordx4 v[72:75], v18, s[28:31], s62 offen offset:3072 sc1
  s_add_u32 s62, s62, 4096
  s_waitcnt lgkmcnt(1)
  buffer_store_dwordx4 v[76:79], v18, s[28:31], s62 offen offset:0 sc1
  s_cmp_eq_u32 s61, 3
  s_cselect_b32 s62, 2147418112, s62
  s_waitcnt lgkmcnt(0)
  buffer_store_dwordx4 v[80:83], v18, s[28:31], s62 offen offset:1024 sc1
  s_and_b32 s62, s61, 1
  s_mul_i32 s63, s62, 1536
  s_add_u32 s63, s63, 160512
  v_lshl_add_u32 v2, v0, 2, s63
  ds_read_b32 v32, v2 offset:0
  ds_read_b32 v33, v2 offset:256
  ds_read_b32 v34, v2 offset:512
  ds_read_b32 v36, v2 offset:768
  ds_read_b32 v37, v2 offset:1024
  ds_read_b32 v38, v2 offset:1280
  s_lshl1_add_u32 s62, s55, s62
  s_mul_i32 s62, s62, 10
  s_add_u32 s62, s62, s56
  s_lshl_b32 s62, s62, 9
  s_add_u32 s62, s62, 17723776
  s_cmp_lt_u32 s54, 10
  s_cselect_b32 s62, s62, 2147418112
  s_waitcnt lgkmcnt(0)
  v_add_f32 v32, v32, v36
  v_add_f32 v33, v33, v37
  v_add_f32 v34, v34, v38
  v_xor_b32 v35, s60, v32
  v_xor_b32 v35, v35, v33
  v_xor_b32 v35, v35, v34
  s_mov_b32 exec_hi, 0
  buffer_store_dwordx4 v[32:35], v18, s[28:31], s62 offen sc1
  s_mov_b32 exec_hi, -1
  v_bfe_u32 v2, v0, 4, 1
  v_bfe_u32 v3, v0, 2, 2
  v_lshl_add_u32 v3, v2, 2, v3
  v_mul_u32_u24 v3, 384, v3
  v_and_b32 v4, 3, v0
  v_lshl_add_u32 v3, v4, 3, v3
  v_lshrrev_b32 v4, 5, v0
  v_lshl_add_u32 v3, v4, 5, v3
  s_and_b32 s62, s61, 1
  s_mul_i32 s63, s62, 6144
  s_add_u32 s63, s63, 147648
  v_add_u32 v3, s63, v3
  s_waitcnt vmcnt(7)
  ds_read_b64_tr_b16 v[100:101], v3 offset:0
  ds_read_b64_tr_b16 v[102:103], v3 offset:3072
  ds_read_b64_tr_b16 v[104:105], v3 offset:64
  ds_read_b64_tr_b16 v[106:107], v3 offset:3136
  ds_read_b64_tr_b16 v[108:109], v3 offset:128
  ds_read_b64_tr_b16 v[110:111], v3 offset:3200
  ds_read_b64_tr_b16 v[112:113], v3 offset:192
  ds_read_b64_tr_b16 v[114:115], v3 offset:3264
  ds_read_b64_tr_b16 v[116:117], v3 offset:256
  ds_read_b64_tr_b16 v[118:119], v3 offset:3328
  ds_read_b64_tr_b16 v[120:121], v3 offset:320
  ds_read_b64_tr_b16 v[122:123], v3 offset:3392
  v_and_b32 v5, 15, v0
  v_lshl_add_u32 v5, v4, 4, v5
  v_lshlrev_b32 v5, 5, v5
  v_lshl_add_u32 v5, v2, 4, v5
  s_mul_i32 s62, s62, 6144
  s_add_u32 s63, s62, 147648
  v_add_u32 v5, s63, v5
  v_add_u32 v6, s63, v18
  s_waitcnt lgkmcnt(0)
  ds_write_b128 v5, v[100:103] offset:0
  ds_write_b128 v5, v[104:107] offset:1024
  ds_write_b128 v5, v[108:111] offset:2048
  ds_write_b128 v5, v[112:115] offset:3072
  ds_write_b128 v5, v[116:119] offset:4096
  ds_write_b128 v5, v[120:123] offset:5120
  ds_read_b128 v[124:127], v6 offset:0
  ds_read_b128 v[128:131], v6 offset:1024
  ds_read_b128 v[132:135], v6 offset:2048
  ds_read_b128 v[136:139], v6 offset:3072
  ds_read_b128 v[140:143], v6 offset:4096
  ds_read_b128 v[144:147], v6 offset:5120
  s_mul_i32 s63, s2, 11392
  s_add_u32 s62, s62, s63
  s_and_b32 s63, s2, 1
  s_lshl_b32 s63, s63, 5
  s_sub_u32 s62, s62, s63
  s_add_u32 s62, s62, 3178496
  s_cmp_eq_u32 s61, 3
  s_cselect_b32 s64, 8, 64
  s_cselect_b32 s65, 0, 64
  v_mov_b32 v4, 2147418112
  v_cmp_gt_u32 vcc, s64, v0
  s_nop 1
  v_cndmask_b32 v2, v4, v18, vcc
  v_cmp_gt_u32 vcc, s65, v0
  s_nop 1
  v_cndmask_b32 v3, v4, v18, vcc
  s_waitcnt lgkmcnt(5)
  buffer_store_dwordx4 v[124:127], v18, s[28:31], s62 offen offset:0 sc1
  s_waitcnt lgkmcnt(4)
  buffer_store_dwordx4 v[128:131], v18, s[28:31], s62 offen offset:1024 sc1
  s_waitcnt lgkmcnt(3)
  buffer_store_dwordx4 v[132:135], v18, s[28:31], s62 offen offset:2048 sc1
  s_waitcnt lgkmcnt(2)
  buffer_store_dwordx4 v[136:139], v18, s[28:31], s62 offen offset:3072 sc1
  s_add_u32 s62, s62, 4096
  s_waitcnt lgkmcnt(1)
  buffer_store_dwordx4 v[140:143], v2, s[28:31], s62 offen offset:0 sc1
  s_waitcnt lgkmcnt(0)
  buffer_store_dwordx4 v[144:147], v3, s[28:31], s62 offen offset:1024 sc1
  s_barrier
  s_and_b32 s62, s66, 15
  s_mul_i32 s62, s62, 96
  s_mul_i32 s63, s67, 48
  s_cmp_eq_u32 s67, 2
  s_cselect_b32 s63, 32, s63
  s_add_u32 s62, s62, s63
  s_mul_i32 s62, s62, 1280
  s_and_b32 s64, s61, 1
  s_and_b32 s63, s53, 3
  s_lshl1_add_u32 s63, s63, s64
  s_mul_i32 s63, s63, 160
  s_add_u32 s62, s62, s63
  s_cmp_lt_u32 s53, 24
  s_cselect_b32 s62, s62, 2147418112
  s_mul_i32 s63, s64, 5120
  s_add_u32 m0, s63, 123072
  s_nop 0
  buffer_load_dwordx4 v8, s[44:47], s62 offen offset:0 nt lds
  buffer_load_dwordx4 v9, s[44:47], s62 offen offset:1024 nt lds
  buffer_load_dwordx4 v10, s[44:47], s62 offen offset:2048 nt lds
  buffer_load_dwordx4 v11, s[44:47], s62 offen offset:3072 nt lds
  s_add_u32 m0, s63, 127168
  s_nop 0
  buffer_load_dwordx4 v12, s[44:47], s62 offen offset:0 nt lds
  s_waitcnt vmcnt(5)
  s_barrier
  s_cmp_eq_u32 s67, 2
  s_cselect_b32 s62, 8, 4
  s_cselect_b32 s63, 4, 16
  s_mul_i32 s63, s63, 160
  v_lshrrev_b32 v2, 4, v0
  v_bfe_u32 v3, v0, 2, 2
  v_mad_u32_u24 v3, v2, s62, v3
  v_mul_u32_u24 v3, 160, v3
  v_and_b32 v4, 3, v0
  v_mad_u32_u24 v3, v4, 40, v3
  s_and_b32 s74, s61, 1
  s_mul_i32 s62, s74, 5120
  s_add_u32 s62, s62, 123072
  v_add_u32 v3, s62, v3
  v_add_u32 v4, s63, v3
  s_waitcnt vmcnt(0)
  ds_read_b64_tr_b16 v[148:149], v3 offset:0
  ds_read_b64_tr_b16 v[150:151], v4 offset:0
  ds_read_b64_tr_b16 v[152:153], v3 offset:8
  ds_read_b64_tr_b16 v[154:155], v4 offset:8
  ds_read_b64_tr_b16 v[156:157], v3 offset:16
  ds_read_b64_tr_b16 v[158:159], v4 offset:16
  ds_read_b64_tr_b16 v[160:161], v3 offset:24
  ds_read_b64_tr_b16 v[162:163], v4 offset:24
  ds_read_b64_tr_b16 v[164:165], v3 offset:32
  ds_read_b64_tr_b16 v[166:167], v4 offset:32
  s_and_b32 s62, s53, 3
  s_lshl1_add_u32 s62, s62, s74
  s_mul_i32 s62, s62, 48
  s_add_u32 s62, s62, s66
  s_mul_i32 s62, s62, 5120
  s_add_u32 s62, s62, 15233408
  s_cmp_lt_u32 s53, 24
  s_cselect_b32 s62, s62, 2147418112
  s_waitcnt lgkmcnt(8)
  buffer_store_dwordx4 v[148:151], v18, s[28:31], s62 offen offset:0 sc1
  s_waitcnt lgkmcnt(6)
  buffer_store_dwordx4 v[152:155], v18, s[28:31], s62 offen offset:1024 sc1
  s_waitcnt lgkmcnt(4)
  buffer_store_dwordx4 v[156:159], v18, s[28:31], s62 offen offset:2048 sc1
  s_waitcnt lgkmcnt(2)
  buffer_store_dwordx4 v[160:163], v18, s[28:31], s62 offen offset:3072 sc1
  s_waitcnt lgkmcnt(0)
  s_add_u32 s62, s62, 4096
  buffer_store_dwordx4 v[164:167], v18, s[28:31], s62 offen offset:0 sc1
  s_lshl_b32 s62, s2, 4
  s_add_u32 s62, s62, 98304
  s_cmp_eq_u32 s61, 2
  s_cselect_b32 s62, s62, 2147418112
  v_mov_b32 v2, s60
  v_mov_b32 v3, 0
  s_mov_b64 exec, 1
  buffer_store_dword v2, v3, s[28:31], s62 offen sc1
  s_mov_b64 exec, -1
  s_barrier
  s_waitcnt vmcnt(1)
  s_barrier
  s_lshl_b32 s62, s2, 4
  s_add_u32 s62, s62, 40960
  s_cmp_eq_u32 s61, 2
  s_cselect_b32 s62, s62, 2147418112
  v_mov_b32 v2, s60
  v_mov_b32 v3, 0
  s_mov_b64 exec, 1
  buffer_store_dword v2, v3, s[28:31], s62 offen sc1
  s_mov_b64 exec, -1
  v_lshlrev_b32 v25, 3, v0
  s_and_b32 s62, s61, 1
  s_lshl1_add_u32 s77, s54, s62
  s_lshl_b32 s77, s77, 9
  s_add_u32 s77, s77, 81920
  s_lshl1_add_u32 s68, s55, s62
  s_mul_i32 s68, s68, 5120
  s_add_u32 s68, s68, 17723776
  s_add_u32 s69, s68, 4096
  buffer_load_dwordx2 v[32:33], v25, s[28:31], s77 offen sc1
  buffer_load_dwordx4 v[36:39], v18, s[28:31], s68 offen offset:0 sc1
  buffer_load_dwordx4 v[40:43], v18, s[28:31], s68 offen offset:1024 sc1
  buffer_load_dwordx4 v[44:47], v18, s[28:31], s68 offen offset:2048 sc1
  buffer_load_dwordx4 v[48:51], v18, s[28:31], s68 offen offset:3072 sc1
  buffer_load_dwordx4 v[52:55], v18, s[28:31], s69 offen offset:0 sc1
  s_barrier
  s_mov_b32 s73, 20000
  s_waitcnt vmcnt(0)
  s_branch L_pchk41
L_poll39:
  buffer_load_dwordx2 v[32:33], v25, s[28:31], s77 offen sc1
  buffer_load_dwordx4 v[36:39], v18, s[28:31], s68 offen offset:0 sc1
  buffer_load_dwordx4 v[40:43], v18, s[28:31], s68 offen offset:1024 sc1
  buffer_load_dwordx4 v[44:47], v18, s[28:31], s68 offen offset:2048 sc1
  buffer_load_dwordx4 v[48:51], v18, s[28:31], s68 offen offset:3072 sc1
  buffer_load_dwordx4 v[52:55], v18, s[28:31], s69 offen offset:0 sc1
  s_waitcnt vmcnt(0)
L_pchk41:
  v_xor_b32 v39, v39, v36
  v_xor_b32 v39, v39, v37
  v_xor_b32 v39, v39, v38
  v_xor_b32 v43, v43, v40
  v_xor_b32 v43, v43, v41
  v_xor_b32 v43, v43, v42
  v_xor_b32 v47, v47, v44
  v_xor_b32 v47, v47, v45
  v_xor_b32 v47, v47, v46
  v_xor_b32 v51, v51, v48
  v_xor_b32 v51, v51, v49
  v_xor_b32 v51, v51, v50
  v_xor_b32 v55, v55, v52
  v_xor_b32 v55, v55, v53
  v_xor_b32 v55, v55, v54
  v_cmp_eq_u32 vcc, s60, v33
  v_cmp_eq_u32 s[74:75], s60, v39
  s_nop 0
  s_and_b64 vcc, vcc, s[74:75]
  v_cmp_eq_u32 s[74:75], s60, v43
  s_nop 0
  s_and_b64 vcc, vcc, s[74:75]
  v_cmp_eq_u32 s[74:75], s60, v47
  s_nop 0
  s_and_b64 vcc, vcc, s[74:75]
  v_cmp_eq_u32 s[74:75], s60, v51
  s_nop 0
  s_and_b64 vcc, vcc, s[74:75]
  v_cmp_eq_u32 s[74:75], s60, v55
  s_nop 0
  s_and_b64 vcc, vcc, s[74:75]
  s_cmp_eq_u64 vcc, exec
  s_cbranch_scc1 L_pdone40
  s_sub_u32 s73, s73, 1
  s_cmp_eq_u32 s73, 0
  s_cbranch_scc1 L_pdone40
  s_sleep 8
  s_branch L_poll39
L_pdone40:
  s_and_b32 s62, s61, 1
  s_lshl_b32 s63, s62, 8
  s_add_u32 s63, s63, 162048
  v_lshl_add_u32 v2, v0, 2, s63
  ds_write_b32 v2, v32
  s_mul_i32 s63, s62, 768
  s_add_u32 s63, s63, 160512
  v_lshl_add_u32 v3, v0, 2, s63
  v_add_f32 v36, v36, v40
  v_add_f32 v44, v44, v48
  v_add_f32 v36, v36, v52
  v_add_f32 v36, v36, v44
  v_mov_b32 v40, v36
  v_add_f32 v37, v37, v41
  v_add_f32 v45, v45, v49
  v_add_f32 v37, v37, v53
  v_add_f32 v37, v37, v45
  v_mov_b32 v41, v37
  v_add_f32 v38, v38, v42
  v_add_f32 v46, v46, v50
  v_add_f32 v38, v38, v54
  v_add_f32 v38, v38, v46
  v_mov_b32 v42, v38
  v_permlane32_swap_b32 v36, v40
  v_permlane32_swap_b32 v37, v41
  v_permlane32_swap_b32 v38, v42
  v_add_f32 v36, v36, v40
  v_add_f32 v37, v37, v41
  v_add_f32 v38, v38, v42
  s_mov_b32 exec_hi, 0
  ds_write_b32 v3, v36 offset:0
  ds_write_b32 v3, v37 offset:256
  ds_write_b32 v3, v38 offset:512
  s_mov_b32 exec_hi, -1
  s_waitcnt lgkmcnt(0)
  s_barrier
  v_lshlrev_b32 v24, 4, v0
  v_add_u32 v26, 1024, v24
  s_and_b32 s76, s61, 1
  s_lshl_b32 s76, s76, 11
  s_add_u32 s76, s76, 98304
  buffer_load_dword v30, v24, s[28:31], s76 offen sc1
  buffer_load_dword v31, v26, s[28:31], s76 offen sc1
  s_mov_b32 s73, 20000
  s_waitcnt vmcnt(0)
  s_branch L_pchk44
L_poll42:
  buffer_load_dword v30, v24, s[28:31], s76 offen sc1
  buffer_load_dword v31, v26, s[28:31], s76 offen sc1
  s_waitcnt vmcnt(0)
L_pchk44:
  v_cmp_eq_u32 vcc, s60, v30
  v_cmp_eq_u32 s[74:75], s60, v31
  s_nop 0
  s_and_b64 vcc, vcc, s[74:75]
  s_cmp_eq_u64 vcc, exec
  s_cbranch_scc1 L_pdone43
  s_sub_u32 s73, s73, 1
  s_cmp_eq_u32 s73, 0
  s_cbranch_scc1 L_pdone43
  s_sleep 8
  s_branch L_poll42
L_pdone43:
  s_barrier
  s_cmp_eq_u32 s100, 0
  s_cbranch_scc1 L_noyi45
  v_lshrrev_b32 v2, 2, v0
  v_mul_u32_u24 v2, 11392, v2
  v_lshrrev_b32 v3, 4, v0
  v_xor_b32 v3, v3, v0
  v_and_b32 v3, 3, v3
  v_lshl_add_u32 v14, v3, 4, v2
  s_and_b32 s65, s61, 1
  s_lshl_b32 s63, s59, 6
  s_mul_i32 s62, s65, 1458176
  s_add_u32 s62, s62, s63
  s_add_u32 s62, s62, 262144
  s_lshl_b32 s64, s65, 13
  s_add_u32 m0, s64, 123072
  s_nop 0
  buffer_load_dwordx4 v14, s[28:31], s62 offen offset:0 sc1 lds
  s_add_u32 s62, s62, 181248
  buffer_load_dwordx4 v14, s[28:31], s62 offen offset:1024 sc1 lds
  s_add_u32 s62, s62, 181248
  buffer_load_dwordx4 v14, s[28:31], s62 offen offset:2048 sc1 lds
  s_add_u32 s62, s62, 181248
  buffer_load_dwordx4 v14, s[28:31], s62 offen offset:3072 sc1 lds
  s_add_u32 m0, s64, 127168
  s_add_u32 s62, s62, 185344
  buffer_load_dwordx4 v14, s[28:31], s62 offen offset:0 sc1 lds
  s_add_u32 s62, s62, 181248
  buffer_load_dwordx4 v14, s[28:31], s62 offen offset:1024 sc1 lds
  s_add_u32 s62, s62, 181248
  buffer_load_dwordx4 v14, s[28:31], s62 offen offset:2048 sc1 lds
  s_add_u32 s62, s62, 181248
  buffer_load_dwordx4 v14, s[28:31], s62 offen offset:3072 sc1 lds
  s_cmp_eq_u32 s2, 0
  s_cselect_b32 s62, 0, 2147418112
  s_cmp_eq_u32 s61, 2
  s_cselect_b32 s62, s62, 2147418112
  v_mov_b32 v2, s60
  v_mov_b32 v3, 0
  s_mov_b64 exec, 1
  buffer_store_dword v2, v3, s[28:31], s62 offen sc1
  s_mov_b64 exec, -1
L_noyi45:
  s_barrier
  s_cmp_eq_u32 s100, 0
  s_cbranch_scc1 L_nowp46
  s_lshl1_add_u32 s62, s65, 0
  s_mul_i32 s62, s62, 182272
  s_add_u32 s62, s62, s63
  s_add_u32 s62, s62, 3178496
  s_add_u32 m0, s64, 139456
  s_nop 0
  buffer_load_dwordx4 v14, s[28:31], s62 offen offset:0 sc1 lds
  s_add_u32 s62, s62, 728064
  buffer_load_dwordx4 v14, s[28:31], s62 offen offset:1024 sc1 lds
  s_add_u32 s62, s62, 728064
  buffer_load_dwordx4 v14, s[28:31], s62 offen offset:2048 sc1 lds
  s_add_u32 s62, s62, 728064
  buffer_load_dwordx4 v14, s[28:31], s62 offen offset:3072 sc1 lds
  s_lshl1_add_u32 s62, s65, 1
  s_mul_i32 s62, s62, 182272
  s_add_u32 s62, s62, s63
  s_add_u32 s62, s62, 3178496
  s_add_u32 m0, s64, 143552
  s_nop 0
  buffer_load_dwordx4 v14, s[28:31], s62 offen offset:0 sc1 lds
  s_add_u32 s62, s62, 728064
  buffer_load_dwordx4 v14, s[28:31], s62 offen offset:1024 sc1 lds
  s_add_u32 s62, s62, 728064
  buffer_load_dwordx4 v14, s[28:31], s62 offen offset:2048 sc1 lds
  s_add_u32 s62, s62, 728064
  buffer_load_dwordx4 v14, s[28:31], s62 offen offset:3072 sc1 lds
L_nowp46:
L_lj:
  s_setprio 0
  s_lshr_b32 s62, s61, 1
  s_lshl_b32 s62, s62, 3
  s_and_b32 s63, s61, 1
  s_add_u32 s62, s62, s63
  s_mul_i32 s63, s58, 48
  s_add_u32 s62, s62, s63
  s_mul_i32 s66, s62, 5120
  s_add_u32 s66, s66, 15233408
  s_mul_i32 s67, s61, 5120
  v_and_b32 v4, 15, v0
  v_lshrrev_b32 v3, 2, v4
  v_mul_u32_u24 v3, 20, v3
  v_and_b32 v2, 3, v4
  v_add_u32 v3, v2, v3
  s_mul_i32 s62, s58, 80
  v_add_u32 v3, s62, v3
  v_cvt_f32_u32 v3, v3
  v_add_f32 v5, 0x00000000, v3
  v_mul_f32 v20, 0x3acccccd, v5
  v_add_f32 v5, 0x40800000, v3
  v_mul_f32 v21, 0x3acccccd, v5
  v_add_f32 v5, 0x41000000, v3
  v_mul_f32 v22, 0x3acccccd, v5
  v_add_f32 v5, 0x41400000, v3
  v_mul_f32 v23, 0x3acccccd, v5
  v_add_f32 v5, 0x41800000, v3
  v_mul_f32 v24, 0x3acccccd, v5
  v_and_b32 v5, 1, v2
  v_lshlrev_b32 v26, 4, v5
  v_mov_b32 v27, 0
  v_mov_b32 v5, 0x80000000
  v_cmp_eq_u32 vcc, 1, v2
  s_nop 1
  v_cndmask_b32 v27, v27, v5, vcc
  v_mov_b32 v5, 0x80008000
  v_cmp_eq_u32 vcc, 2, v2
  s_nop 1
  v_cndmask_b32 v27, v27, v5, vcc
  v_mov_b32 v5, 0x8000
  v_cmp_eq_u32 vcc, 3, v2
  s_nop 1
  v_cndmask_b32 v27, v27, v5, vcc
  v_lshrrev_b32 v3, 4, v0
  v_lshlrev_b32 v5, 2, v3
  v_cvt_f32_u32 v25, v5
  v_mul_u32_u24 v3, 33536, v3
  v_lshl_add_u32 v30, v4, 4, v3
  s_add_u32 s62, s61, 3
  s_cmp_eq_u32 s61, 0
  s_cselect_b32 s62, 0, s62
  s_mul_i32 s62, s62, 20480
  v_lshl_add_u32 v31, v0, 4, s62
  v_and_b32 v2, 31, v0
  v_lshlrev_b32 v28, 7, v2
  s_lshl_b32 s68, s57, 12
  s_add_u32 s68, s68, 131072
  s_and_b32 s62, s58, 1
  s_lshl2_add_u32 s56, s62, s61
  s_xor_b32 s72, s56, 4
  s_and_b32 s62, s61, 1
  s_lshr_b32 s69, s61, 1
  s_mul_i32 s69, s69, 10
  s_add_u32 s69, s69, s62
  s_add_u32 s69, s69, 8
  v_lshrrev_b32 v2, 3, v0
  v_mov_b32 v3, 20
  s_add_u32 s62, s56, 0
  v_mov_b32 v5, s62
  v_cmp_eq_u32 vcc, 0, v2
  s_nop 1
  v_cndmask_b32 v3, v3, v5, vcc
  s_add_u32 s62, s56, 10
  v_mov_b32 v5, s62
  v_cmp_eq_u32 vcc, 1, v2
  s_nop 1
  v_cndmask_b32 v3, v3, v5, vcc
  s_add_u32 s62, s72, 0
  v_mov_b32 v5, s62
  v_cmp_eq_u32 vcc, 2, v2
  s_nop 1
  v_cndmask_b32 v3, v3, v5, vcc
  s_add_u32 s62, s72, 10
  v_mov_b32 v5, s62
  v_cmp_eq_u32 vcc, 3, v2
  s_nop 1
  v_cndmask_b32 v3, v3, v5, vcc
  s_add_u32 s62, s69, 0
  v_mov_b32 v5, s62
  v_cmp_eq_u32 vcc, 4, v2
  s_nop 1
  v_cndmask_b32 v3, v3, v5, vcc
  v_and_b32 v2, 7, v0
  v_lshl_add_u32 v2, v3, 3, v2
  v_min_u32 v2, 160, v2
  v_lshlrev_b32 v29, 7, v2
  v_lshlrev_b32 v19, 5, v0
  s_lshl_b32 s77, s61, 11
  s_add_u32 s77, s77, 40960
  s_cmp_eq_u32 s100, 0
  s_cbranch_scc1 L_nofft
  v_and_b32 v2, 15, v0
  v_lshrrev_b32 v3, 4, v0
  v_lshrrev_b32 v4, 2, v2
  v_lshlrev_b32 v5, 4, v4
  v_lshl_add_u32 v5, v2, 6, v5
  v_lshl_add_u32 v5, v3, 11, v5
  v_add_u32 v6, 123072, v5
  v_xor_b32 v7, 16, v6
  v_xor_b32 v8, 32, v6
  v_xor_b32 v9, 48, v6
  v_and_b32 v5, 1, v3
  v_xor_b32 v5, v5, v4
  v_lshlrev_b32 v5, 4, v5
  v_lshl_add_u32 v5, v2, 6, v5
  v_lshrrev_b32 v13, 1, v3
  v_lshl_add_u32 v5, v13, 10, v5
  s_lshl_b32 s75, s61, 12
  s_add_u32 s75, s75, 139456
  v_add_u32 v15, s75, v5
  v_xor_b32 v16, 32, v15
  v_xor_b32 v5, v3, v4
  v_lshlrev_b32 v5, 4, v5
  v_lshl_add_u32 v5, v2, 6, v5
  v_add_u32 v10, 123072, v5
  v_bfe_u32 v4, v2, 1, 2
  v_lshrrev_b32 v5, 3, v2
  v_lshlrev_b32 v5, 1, v5
  v_and_b32 v13, 1, v2
  v_add_u32 v5, v5, v13
  v_lshl_add_u32 v5, v4, 2, v5
  v_xor_b32 v4, v4, v3
  v_lshlrev_b32 v4, 4, v4
  v_lshl_add_u32 v5, v5, 6, v4
  s_lshr_b32 s76, s61, 1
  s_lshl_b32 s75, s76, 11
  s_and_b32 s76, s61, 1
  s_lshl3_add_u32 s75, s76, s75
  s_add_u32 s75, s75, 123072
  v_add_u32 v11, s75, v5
  s_lshl_b32 s75, s61, 12
  v_lshlrev_b32 v5, 4, v3
  v_lshl_add_u32 v5, v2, 8, v5
  v_add_u32 v12, s75, v5
  s_barrier
  s_waitcnt vmcnt(0)
  v_mov_b32 v2, 163584
  v_mov_b32 v3, 1
  s_mov_b64 exec, 1
  ds_add_u32 v2, v3
  s_mov_b64 exec, -1
  v_mov_b32 v2, 163584
  s_mov_b32 s73, 200000
L_ls47:
  ds_read_b32 v3, v2
  s_waitcnt lgkmcnt(0)
  v_readfirstlane_b32 s74, v3
  s_nop 0
  s_cmp_ge_u32 s74, 4
  s_cbranch_scc1 L_lsd48
  s_sub_u32 s73, s73, 1
  s_cmp_lg_u32 s73, 0
  s_cbranch_scc1 L_ls47
L_lsd48:
  ds_read_b128 v[52:55], v6 offset:0
  ds_read_b128 v[56:59], v7 offset:0
  ds_read_b128 v[60:63], v6 offset:8192
  ds_read_b128 v[64:67], v7 offset:8192
  ds_read_b128 v[68:71], v6 offset:1024
  ds_read_b128 v[72:75], v7 offset:1024
  ds_read_b128 v[76:79], v6 offset:9216
  ds_read_b128 v[80:83], v7 offset:9216
  ds_read_b128 v[84:87], v8 offset:0
  ds_read_b128 v[88:91], v9 offset:0
  ds_read_b128 v[92:95], v8 offset:8192
  ds_read_b128 v[96:99], v9 offset:8192
  ds_read_b128 v[100:103], v8 offset:1024
  ds_read_b128 v[104:107], v9 offset:1024
  ds_read_b128 v[108:111], v8 offset:9216
  ds_read_b128 v[112:115], v9 offset:9216
  s_waitcnt lgkmcnt(12)
  v_mfma_f32_16x16x32_bf16 v[116:119], v[52:55], v[208:211], 0
  v_mfma_f32_16x16x32_bf16 v[120:123], v[56:59], v[208:211], 0
  v_mfma_f32_16x16x32_bf16 v[116:119], v[56:59], v[216:219], v[116:119]
  v_mfma_f32_16x16x32_bf16 v[120:123], v[52:55], v[192:195], v[120:123]
  v_mfma_f32_16x16x32_bf16 v[116:119], v[60:63], v[212:215], v[116:119]
  v_mfma_f32_16x16x32_bf16 v[120:123], v[64:67], v[212:215], v[120:123]
  v_mfma_f32_16x16x32_bf16 v[116:119], v[64:67], v[220:223], v[116:119]
  v_mfma_f32_16x16x32_bf16 v[120:123], v[60:63], v[196:199], v[120:123]
  s_waitcnt lgkmcnt(8)
  v_mfma_f32_16x16x32_bf16 v[124:127], v[68:71], v[208:211], 0
  v_mfma_f32_16x16x32_bf16 v[128:131], v[72:75], v[208:211], 0
  v_mfma_f32_16x16x32_bf16 v[124:127], v[72:75], v[216:219], v[124:127]
  v_mfma_f32_16x16x32_bf16 v[128:131], v[68:71], v[192:195], v[128:131]
  v_mfma_f32_16x16x32_bf16 v[124:127], v[76:79], v[212:215], v[124:127]
  v_mfma_f32_16x16x32_bf16 v[128:131], v[80:83], v[212:215], v[128:131]
  v_mfma_f32_16x16x32_bf16 v[124:127], v[80:83], v[220:223], v[124:127]
  v_mfma_f32_16x16x32_bf16 v[128:131], v[76:79], v[196:199], v[128:131]
  s_waitcnt lgkmcnt(4)
  v_mfma_f32_16x16x32_bf16 v[132:135], v[84:87], v[208:211], 0
  v_mfma_f32_16x16x32_bf16 v[136:139], v[88:91], v[208:211], 0
  v_mfma_f32_16x16x32_bf16 v[132:135], v[88:91], v[216:219], v[132:135]
  v_mfma_f32_16x16x32_bf16 v[136:139], v[84:87], v[192:195], v[136:139]
  v_mfma_f32_16x16x32_bf16 v[132:135], v[92:95], v[212:215], v[132:135]
  v_mfma_f32_16x16x32_bf16 v[136:139], v[96:99], v[212:215], v[136:139]
  v_mfma_f32_16x16x32_bf16 v[132:135], v[96:99], v[220:223], v[132:135]
  v_mfma_f32_16x16x32_bf16 v[136:139], v[92:95], v[196:199], v[136:139]
  s_waitcnt lgkmcnt(0)
  v_mfma_f32_16x16x32_bf16 v[140:143], v[100:103], v[208:211], 0
  v_mfma_f32_16x16x32_bf16 v[144:147], v[104:107], v[208:211], 0
  v_mfma_f32_16x16x32_bf16 v[140:143], v[104:107], v[216:219], v[140:143]
  v_mfma_f32_16x16x32_bf16 v[144:147], v[100:103], v[192:195], v[144:147]
  v_mfma_f32_16x16x32_bf16 v[140:143], v[108:111], v[212:215], v[140:143]
  v_mfma_f32_16x16x32_bf16 v[144:147], v[112:115], v[212:215], v[144:147]
  v_mfma_f32_16x16x32_bf16 v[140:143], v[112:115], v[220:223], v[140:143]
  v_mfma_f32_16x16x32_bf16 v[144:147], v[108:111], v[196:199], v[144:147]
  v_mov_b32 v2, 163608
  v_mov_b32 v3, 1
  s_mov_b64 exec, 1
  ds_add_u32 v2, v3
  s_mov_b64 exec, -1
  s_add_u32 s62, s71, 0
  s_and_b32 s62, s62, 3
  s_mul_i32 s62, s62, 10240
  s_add_u32 s62, s62, s66
  s_add_u32 m0, s67, 81920
  s_nop 0
  buffer_load_dwordx4 v18, s[28:31], s62 offen offset:0 sc1 lds
  buffer_load_dwordx4 v18, s[28:31], s62 offen offset:1024 sc1 lds
  buffer_load_dwordx4 v18, s[28:31], s62 offen offset:2048 sc1 lds
  buffer_load_dwordx4 v18, s[28:31], s62 offen offset:3072 sc1 lds
  s_add_u32 m0, s67, 86016
  s_add_u32 s62, s62, 4096
  buffer_load_dwordx4 v18, s[28:31], s62 offen offset:0 sc1 lds
  s_add_u32 s62, s71, 1
  s_and_b32 s62, s62, 3
  s_mul_i32 s62, s62, 10240
  s_add_u32 s62, s62, s66
  s_add_u32 m0, s67, 102400
  s_nop 0
  buffer_load_dwordx4 v18, s[28:31], s62 offen offset:0 sc1 lds
  buffer_load_dwordx4 v18, s[28:31], s62 offen offset:1024 sc1 lds
  buffer_load_dwordx4 v18, s[28:31], s62 offen offset:2048 sc1 lds
  buffer_load_dwordx4 v18, s[28:31], s62 offen offset:3072 sc1 lds
  s_add_u32 m0, s67, 106496
  s_add_u32 s62, s62, 4096
  buffer_load_dwordx4 v18, s[28:31], s62 offen offset:0 sc1 lds
  s_add_u32 s62, s71, 2
  s_and_b32 s62, s62, 3
  s_mul_i32 s62, s62, 10240
  s_add_u32 s62, s62, s66
  s_add_u32 m0, s67, 0
  s_nop 0
  buffer_load_dwordx4 v18, s[28:31], s62 offen offset:0 sc1 lds
  buffer_load_dwordx4 v18, s[28:31], s62 offen offset:1024 sc1 lds
  buffer_load_dwordx4 v18, s[28:31], s62 offen offset:2048 sc1 lds
  buffer_load_dwordx4 v18, s[28:31], s62 offen offset:3072 sc1 lds
  s_add_u32 m0, s67, 4096
  s_add_u32 s62, s62, 4096
  buffer_load_dwordx4 v18, s[28:31], s62 offen offset:0 sc1 lds
  v_fma_mix_f32 v148, v116, v240, 0 op_sel_hi:[0,1,0]
  v_fma_mix_f32 v156, v120, v240, 0 op_sel_hi:[0,1,0]
  v_fma_mix_f32 v148, v120, v240, v148 op_sel:[0,1,0] op_sel_hi:[0,1,0]
  v_fma_mix_f32 v156, -v116, v240, v156 op_sel:[0,1,0] op_sel_hi:[0,1,0]
  v_fma_mix_f32 v149, v117, v241, 0 op_sel_hi:[0,1,0]
  v_fma_mix_f32 v157, v121, v241, 0 op_sel_hi:[0,1,0]
  v_fma_mix_f32 v149, v121, v241, v149 op_sel:[0,1,0] op_sel_hi:[0,1,0]
  v_fma_mix_f32 v157, -v117, v241, v157 op_sel:[0,1,0] op_sel_hi:[0,1,0]
  v_fma_mix_f32 v150, v118, v242, 0 op_sel_hi:[0,1,0]
  v_fma_mix_f32 v158, v122, v242, 0 op_sel_hi:[0,1,0]
  v_fma_mix_f32 v150, v122, v242, v150 op_sel:[0,1,0] op_sel_hi:[0,1,0]
  v_fma_mix_f32 v158, -v118, v242, v158 op_sel:[0,1,0] op_sel_hi:[0,1,0]
  v_fma_mix_f32 v151, v119, v243, 0 op_sel_hi:[0,1,0]
  v_fma_mix_f32 v159, v123, v243, 0 op_sel_hi:[0,1,0]
  v_fma_mix_f32 v151, v123, v243, v151 op_sel:[0,1,0] op_sel_hi:[0,1,0]
  v_fma_mix_f32 v159, -v119, v243, v159 op_sel:[0,1,0] op_sel_hi:[0,1,0]
  v_fma_mix_f32 v152, v124, v244, 0 op_sel_hi:[0,1,0]
  v_fma_mix_f32 v160, v128, v244, 0 op_sel_hi:[0,1,0]
  v_fma_mix_f32 v152, v128, v244, v152 op_sel:[0,1,0] op_sel_hi:[0,1,0]
  v_fma_mix_f32 v160, -v124, v244, v160 op_sel:[0,1,0] op_sel_hi:[0,1,0]
  v_fma_mix_f32 v153, v125, v245, 0 op_sel_hi:[0,1,0]
  v_fma_mix_f32 v161, v129, v245, 0 op_sel_hi:[0,1,0]
  v_fma_mix_f32 v153, v129, v245, v153 op_sel:[0,1,0] op_sel_hi:[0,1,0]
  v_fma_mix_f32 v161, -v125, v245, v161 op_sel:[0,1,0] op_sel_hi:[0,1,0]
  v_fma_mix_f32 v154, v126, v246, 0 op_sel_hi:[0,1,0]
  v_fma_mix_f32 v162, v130, v246, 0 op_sel_hi:[0,1,0]
  v_fma_mix_f32 v154, v130, v246, v154 op_sel:[0,1,0] op_sel_hi:[0,1,0]
  v_fma_mix_f32 v162, -v126, v246, v162 op_sel:[0,1,0] op_sel_hi:[0,1,0]
  v_fma_mix_f32 v155, v127, v247, 0 op_sel_hi:[0,1,0]
  v_fma_mix_f32 v163, v131, v247, 0 op_sel_hi:[0,1,0]
  v_fma_mix_f32 v155, v131, v247, v155 op_sel:[0,1,0] op_sel_hi:[0,1,0]
  v_fma_mix_f32 v163, -v127, v247, v163 op_sel:[0,1,0] op_sel_hi:[0,1,0]
  v_cvt_pk_bf16_f32 v164, v148, v149
  v_cvt_pk_bf16_f32 v165, v150, v151
  v_cvt_pk_bf16_f32 v166, v152, v153
  v_cvt_pk_bf16_f32 v167, v154, v155
  v_cvt_pk_bf16_f32 v168, v156, v157
  v_cvt_pk_bf16_f32 v169, v158, v159
  v_cvt_pk_bf16_f32 v170, v160, v161
  v_cvt_pk_bf16_f32 v171, v162, v163
  v_mfma_f32_16x16x32_bf16 v[52:55], v[224:227], v[164:167], 0
  s_nop 0
  v_mfma_f32_16x16x32_bf16 v[56:59], v[224:227], v[168:171], 0
  v_mfma_f32_16x16x32_bf16 v[52:55], v[232:235], v[168:171], v[52:55]
  v_mfma_f32_16x16x32_bf16 v[56:59], v[200:203], v[164:167], v[56:59]
  v_mfma_f32_16x16x32_bf16 v[60:63], v[228:231], v[164:167], 0
  v_mfma_f32_16x16x32_bf16 v[64:67], v[228:231], v[168:171], 0
  v_mfma_f32_16x16x32_bf16 v[60:63], v[236:239], v[168:171], v[60:63]
  v_mfma_f32_16x16x32_bf16 v[64:67], v[204:207], v[164:167], v[64:67]
  v_fma_mix_f32 v148, v132, v240, 0 op_sel_hi:[0,1,0]
  v_fma_mix_f32 v156, v136, v240, 0 op_sel_hi:[0,1,0]
  v_fma_mix_f32 v148, v136, v240, v148 op_sel:[0,1,0] op_sel_hi:[0,1,0]
  v_fma_mix_f32 v156, -v132, v240, v156 op_sel:[0,1,0] op_sel_hi:[0,1,0]
  v_fma_mix_f32 v149, v133, v241, 0 op_sel_hi:[0,1,0]
  v_fma_mix_f32 v157, v137, v241, 0 op_sel_hi:[0,1,0]
  v_fma_mix_f32 v149, v137, v241, v149 op_sel:[0,1,0] op_sel_hi:[0,1,0]
  v_fma_mix_f32 v157, -v133, v241, v157 op_sel:[0,1,0] op_sel_hi:[0,1,0]
  v_fma_mix_f32 v150, v134, v242, 0 op_sel_hi:[0,1,0]
  v_fma_mix_f32 v158, v138, v242, 0 op_sel_hi:[0,1,0]
  v_fma_mix_f32 v150, v138, v242, v150 op_sel:[0,1,0] op_sel_hi:[0,1,0]
  v_fma_mix_f32 v158, -v134, v242, v158 op_sel:[0,1,0] op_sel_hi:[0,1,0]
  v_fma_mix_f32 v151, v135, v243, 0 op_sel_hi:[0,1,0]
  v_fma_mix_f32 v159, v139, v243, 0 op_sel_hi:[0,1,0]
  v_fma_mix_f32 v151, v139, v243, v151 op_sel:[0,1,0] op_sel_hi:[0,1,0]
  v_fma_mix_f32 v159, -v135, v243, v159 op_sel:[0,1,0] op_sel_hi:[0,1,0]
  v_fma_mix_f32 v152, v140, v244, 0 op_sel_hi:[0,1,0]
  v_fma_mix_f32 v160, v144, v244, 0 op_sel_hi:[0,1,0]
  v_fma_mix_f32 v152, v144, v244, v152 op_sel:[0,1,0] op_sel_hi:[0,1,0]
  v_fma_mix_f32 v160, -v140, v244, v160 op_sel:[0,1,0] op_sel_hi:[0,1,0]
  v_fma_mix_f32 v153, v141, v245, 0 op_sel_hi:[0,1,0]
  v_fma_mix_f32 v161, v145, v245, 0 op_sel_hi:[0,1,0]
  v_fma_mix_f32 v153, v145, v245, v153 op_sel:[0,1,0] op_sel_hi:[0,1,0]
  v_fma_mix_f32 v161, -v141, v245, v161 op_sel:[0,1,0] op_sel_hi:[0,1,0]
  v_fma_mix_f32 v154, v142, v246, 0 op_sel_hi:[0,1,0]
  v_fma_mix_f32 v162, v146, v246, 0 op_sel_hi:[0,1,0]
  v_fma_mix_f32 v154, v146, v246, v154 op_sel:[0,1,0] op_sel_hi:[0,1,0]
  v_fma_mix_f32 v162, -v142, v246, v162 op_sel:[0,1,0] op_sel_hi:[0,1,0]
  v_fma_mix_f32 v155, v143, v247, 0 op_sel_hi:[0,1,0]
  v_fma_mix_f32 v163, v147, v247, 0 op_sel_hi:[0,1,0]
  v_fma_mix_f32 v155, v147, v247, v155 op_sel:[0,1,0] op_sel_hi:[0,1,0]
  v_fma_mix_f32 v163, -v143, v247, v163 op_sel:[0,1,0] op_sel_hi:[0,1,0]
  v_cvt_pk_bf16_f32 v172, v148, v149
  v_cvt_pk_bf16_f32 v173, v150, v151
  v_cvt_pk_bf16_f32 v174, v152, v153
  v_cvt_pk_bf16_f32 v175, v154, v155
  v_cvt_pk_bf16_f32 v176, v156, v157
  v_cvt_pk_bf16_f32 v177, v158, v159
  v_cvt_pk_bf16_f32 v178, v160, v161
  v_cvt_pk_bf16_f32 v179, v162, v163
  v_mfma_f32_16x16x32_bf16 v[84:87], v[224:227], v[172:175], 0
  s_nop 0
  v_mfma_f32_16x16x32_bf16 v[88:91], v[224:227], v[176:179], 0
  v_mfma_f32_16x16x32_bf16 v[84:87], v[232:235], v[176:179], v[84:87]
  v_mfma_f32_16x16x32_bf16 v[88:91], v[200:203], v[172:175], v[88:91]
  v_mfma_f32_16x16x32_bf16 v[92:95], v[228:231], v[172:175], 0
  v_mfma_f32_16x16x32_bf16 v[96:99], v[228:231], v[176:179], 0
  v_mfma_f32_16x16x32_bf16 v[92:95], v[236:239], v[176:179], v[92:95]
  v_mfma_f32_16x16x32_bf16 v[96:99], v[204:207], v[172:175], v[96:99]
  ds_read_b128 v[36:39], v15 offset:0
  ds_read_b128 v[40:43], v15 offset:2048
  ds_read_b128 v[44:47], v16 offset:0
  ds_read_b128 v[48:51], v16 offset:2048
  s_waitcnt lgkmcnt(0)
  v_lshlrev_b32 v2, 16, v36
  v_lshlrev_b32 v3, 16, v38
  v_mul_f32 v148, v52, v2
  v_mul_f32 v156, v56, v2
  v_fma_f32 v148, -v56, v3, v148
  v_fmac_f32 v156, v52, v3
  v_and_b32 v2, 0xffff0000, v36
  v_and_b32 v3, 0xffff0000, v38
  v_mul_f32 v149, v53, v2
  v_mul_f32 v157, v57, v2
  v_fma_f32 v149, -v57, v3, v149
  v_fmac_f32 v157, v53, v3
  v_lshlrev_b32 v2, 16, v37
  v_lshlrev_b32 v3, 16, v39
  v_mul_f32 v150, v54, v2
  v_mul_f32 v158, v58, v2
  v_fma_f32 v150, -v58, v3, v150
  v_fmac_f32 v158, v54, v3
  v_and_b32 v2, 0xffff0000, v37
  v_and_b32 v3, 0xffff0000, v39
  v_mul_f32 v151, v55, v2
  v_mul_f32 v159, v59, v2
  v_fma_f32 v151, -v59, v3, v151
  v_fmac_f32 v159, v55, v3
  v_lshlrev_b32 v2, 16, v40
  v_lshlrev_b32 v3, 16, v42
  v_mul_f32 v152, v60, v2
  v_mul_f32 v160, v64, v2
  v_fma_f32 v152, -v64, v3, v152
  v_fmac_f32 v160, v60, v3
  v_and_b32 v2, 0xffff0000, v40
  v_and_b32 v3, 0xffff0000, v42
  v_mul_f32 v153, v61, v2
  v_mul_f32 v161, v65, v2
  v_fma_f32 v153, -v65, v3, v153
  v_fmac_f32 v161, v61, v3
  v_lshlrev_b32 v2, 16, v41
  v_lshlrev_b32 v3, 16, v43
  v_mul_f32 v154, v62, v2
  v_mul_f32 v162, v66, v2
  v_fma_f32 v154, -v66, v3, v154
  v_fmac_f32 v162, v62, v3
  v_and_b32 v2, 0xffff0000, v41
  v_and_b32 v3, 0xffff0000, v43
  v_mul_f32 v155, v63, v2
  v_mul_f32 v163, v67, v2
  v_fma_f32 v155, -v67, v3, v155
  v_fmac_f32 v163, v63, v3
  v_cvt_pk_bf16_f32 v164, v148, v149
  v_cvt_pk_bf16_f32 v165, v150, v151
  v_cvt_pk_bf16_f32 v166, v152, v153
  v_cvt_pk_bf16_f32 v167, v154, v155
  v_cvt_pk_bf16_f32 v168, v156, v157
  v_cvt_pk_bf16_f32 v169, v158, v159
  v_cvt_pk_bf16_f32 v170, v160, v161
  v_cvt_pk_bf16_f32 v171, v162, v163
  v_mfma_f32_16x16x32_bf16 v[116:119], v[164:167], v[224:227], 0
  s_nop 0
  v_mfma_f32_16x16x32_bf16 v[120:123], v[168:171], v[224:227], 0
  v_mfma_f32_16x16x32_bf16 v[116:119], v[168:171], v[200:203], v[116:119]
  v_mfma_f32_16x16x32_bf16 v[120:123], v[164:167], v[232:235], v[120:123]
  v_mfma_f32_16x16x32_bf16 v[124:127], v[164:167], v[228:231], 0
  v_mfma_f32_16x16x32_bf16 v[128:131], v[168:171], v[228:231], 0
  v_mfma_f32_16x16x32_bf16 v[124:127], v[168:171], v[204:207], v[124:127]
  v_mfma_f32_16x16x32_bf16 v[128:131], v[164:167], v[236:239], v[128:131]
  v_lshlrev_b32 v2, 16, v44
  v_lshlrev_b32 v3, 16, v46
  v_mul_f32 v148, v84, v2
  v_mul_f32 v156, v88, v2
  v_fma_f32 v148, -v88, v3, v148
  v_fmac_f32 v156, v84, v3
  v_and_b32 v2, 0xffff0000, v44
  v_and_b32 v3, 0xffff0000, v46
  v_mul_f32 v149, v85, v2
  v_mul_f32 v157, v89, v2
  v_fma_f32 v149, -v89, v3, v149
  v_fmac_f32 v157, v85, v3
  v_lshlrev_b32 v2, 16, v45
  v_lshlrev_b32 v3, 16, v47
  v_mul_f32 v150, v86, v2
  v_mul_f32 v158, v90, v2
  v_fma_f32 v150, -v90, v3, v150
  v_fmac_f32 v158, v86, v3
  v_and_b32 v2, 0xffff0000, v45
  v_and_b32 v3, 0xffff0000, v47
  v_mul_f32 v151, v87, v2
  v_mul_f32 v159, v91, v2
  v_fma_f32 v151, -v91, v3, v151
  v_fmac_f32 v159, v87, v3
  v_lshlrev_b32 v2, 16, v48
  v_lshlrev_b32 v3, 16, v50
  v_mul_f32 v152, v92, v2
  v_mul_f32 v160, v96, v2
  v_fma_f32 v152, -v96, v3, v152
  v_fmac_f32 v160, v92, v3
  v_and_b32 v2, 0xffff0000, v48
  v_and_b32 v3, 0xffff0000, v50
  v_mul_f32 v153, v93, v2
  v_mul_f32 v161, v97, v2
  v_fma_f32 v153, -v97, v3, v153
  v_fmac_f32 v161, v93, v3
  v_lshlrev_b32 v2, 16, v49
  v_lshlrev_b32 v3, 16, v51
  v_mul_f32 v154, v94, v2
  v_mul_f32 v162, v98, v2
  v_fma_f32 v154, -v98, v3, v154
  v_fmac_f32 v162, v94, v3
  v_and_b32 v2, 0xffff0000, v49
  v_and_b32 v3, 0xffff0000, v51
  v_mul_f32 v155, v95, v2
  v_mul_f32 v163, v99, v2
  v_fma_f32 v155, -v99, v3, v155
  v_fmac_f32 v163, v95, v3
  v_cvt_pk_bf16_f32 v172, v148, v149
  v_cvt_pk_bf16_f32 v173, v150, v151
  v_cvt_pk_bf16_f32 v174, v152, v153
  v_cvt_pk_bf16_f32 v175, v154, v155
  v_cvt_pk_bf16_f32 v176, v156, v157
  v_cvt_pk_bf16_f32 v177, v158, v159
  v_cvt_pk_bf16_f32 v178, v160, v161
  v_cvt_pk_bf16_f32 v179, v162, v163
  v_mfma_f32_16x16x32_bf16 v[132:135], v[172:175], v[224:227], 0
  s_nop 0
  v_mfma_f32_16x16x32_bf16 v[136:139], v[176:179], v[224:227], 0
  v_mfma_f32_16x16x32_bf16 v[132:135], v[176:179], v[200:203], v[132:135]
  v_mfma_f32_16x16x32_bf16 v[136:139], v[172:175], v[232:235], v[136:139]
  v_mfma_f32_16x16x32_bf16 v[140:143], v[172:175], v[228:231], 0
  v_mfma_f32_16x16x32_bf16 v[144:147], v[176:179], v[228:231], 0
  v_mfma_f32_16x16x32_bf16 v[140:143], v[176:179], v[204:207], v[140:143]
  v_mfma_f32_16x16x32_bf16 v[144:147], v[172:175], v[236:239], v[144:147]
  v_mov_b32 v2, 163608
  s_mov_b32 s73, 200000
L_ls49:
  ds_read_b32 v3, v2
  s_waitcnt lgkmcnt(0)
  v_readfirstlane_b32 s74, v3
  s_nop 0
  s_cmp_ge_u32 s74, 4
  s_cbranch_scc1 L_lsd50
  s_sub_u32 s73, s73, 1
  s_cmp_lg_u32 s73, 0
  s_cbranch_scc1 L_ls49
L_lsd50:
  v_fma_mix_f32 v148, v116, v248, 0 op_sel_hi:[0,1,0]
  v_fma_mix_f32 v152, v120, v248, 0 op_sel_hi:[0,1,0]
  v_fma_mix_f32 v148, -v120, v248, v148 op_sel:[0,1,0] op_sel_hi:[0,1,0]
  v_fma_mix_f32 v152, v116, v248, v152 op_sel:[0,1,0] op_sel_hi:[0,1,0]
  v_fma_mix_f32 v149, v117, v249, 0 op_sel_hi:[0,1,0]
  v_fma_mix_f32 v153, v121, v249, 0 op_sel_hi:[0,1,0]
  v_fma_mix_f32 v149, -v121, v249, v149 op_sel:[0,1,0] op_sel_hi:[0,1,0]
  v_fma_mix_f32 v153, v117, v249, v153 op_sel:[0,1,0] op_sel_hi:[0,1,0]
  v_fma_mix_f32 v150, v118, v250, 0 op_sel_hi:[0,1,0]
  v_fma_mix_f32 v154, v122, v250, 0 op_sel_hi:[0,1,0]
  v_fma_mix_f32 v150, -v122, v250, v150 op_sel:[0,1,0] op_sel_hi:[0,1,0]
  v_fma_mix_f32 v154, v118, v250, v154 op_sel:[0,1,0] op_sel_hi:[0,1,0]
  v_fma_mix_f32 v151, v119, v251, 0 op_sel_hi:[0,1,0]
  v_fma_mix_f32 v155, v123, v251, 0 op_sel_hi:[0,1,0]
  v_fma_mix_f32 v151, -v123, v251, v151 op_sel:[0,1,0] op_sel_hi:[0,1,0]
  v_fma_mix_f32 v155, v119, v251, v155 op_sel:[0,1,0] op_sel_hi:[0,1,0]
  v_fma_mix_f32 v156, v124, v252, 0 op_sel_hi:[0,1,0]
  v_fma_mix_f32 v160, v128, v252, 0 op_sel_hi:[0,1,0]
  v_fma_mix_f32 v156, -v128, v252, v156 op_sel:[0,1,0] op_sel_hi:[0,1,0]
  v_fma_mix_f32 v160, v124, v252, v160 op_sel:[0,1,0] op_sel_hi:[0,1,0]
  v_fma_mix_f32 v157, v125, v253, 0 op_sel_hi:[0,1,0]
  v_fma_mix_f32 v161, v129, v253, 0 op_sel_hi:[0,1,0]
  v_fma_mix_f32 v157, -v129, v253, v157 op_sel:[0,1,0] op_sel_hi:[0,1,0]
  v_fma_mix_f32 v161, v125, v253, v161 op_sel:[0,1,0] op_sel_hi:[0,1,0]
  v_fma_mix_f32 v158, v126, v254, 0 op_sel_hi:[0,1,0]
  v_fma_mix_f32 v162, v130, v254, 0 op_sel_hi:[0,1,0]
  v_fma_mix_f32 v158, -v130, v254, v158 op_sel:[0,1,0] op_sel_hi:[0,1,0]
  v_fma_mix_f32 v162, v126, v254, v162 op_sel:[0,1,0] op_sel_hi:[0,1,0]
  v_fma_mix_f32 v159, v127, v255, 0 op_sel_hi:[0,1,0]
  v_fma_mix_f32 v163, v131, v255, 0 op_sel_hi:[0,1,0]
  v_fma_mix_f32 v159, -v131, v255, v159 op_sel:[0,1,0] op_sel_hi:[0,1,0]
  v_fma_mix_f32 v163, v127, v255, v163 op_sel:[0,1,0] op_sel_hi:[0,1,0]
  v_cvt_pk_bf16_f32 v164, v148, v149
  v_cvt_pk_bf16_f32 v165, v150, v151
  v_cvt_pk_bf16_f32 v166, v152, v153
  v_cvt_pk_bf16_f32 v167, v154, v155
  v_cvt_pk_bf16_f32 v168, v156, v157
  v_cvt_pk_bf16_f32 v169, v158, v159
  v_cvt_pk_bf16_f32 v170, v160, v161
  v_cvt_pk_bf16_f32 v171, v162, v163
  ds_write_b64 v11, v[164:165] offset:0
  ds_write_b64 v11, v[166:167] offset:4096
  ds_write_b64 v11, v[168:169] offset:1024
  ds_write_b64 v11, v[170:171] offset:5120
  v_fma_mix_f32 v148, v132, v248, 0 op_sel_hi:[0,1,0]
  v_fma_mix_f32 v152, v136, v248, 0 op_sel_hi:[0,1,0]
  v_fma_mix_f32 v148, -v136, v248, v148 op_sel:[0,1,0] op_sel_hi:[0,1,0]
  v_fma_mix_f32 v152, v132, v248, v152 op_sel:[0,1,0] op_sel_hi:[0,1,0]
  v_fma_mix_f32 v149, v133, v249, 0 op_sel_hi:[0,1,0]
  v_fma_mix_f32 v153, v137, v249, 0 op_sel_hi:[0,1,0]
  v_fma_mix_f32 v149, -v137, v249, v149 op_sel:[0,1,0] op_sel_hi:[0,1,0]
  v_fma_mix_f32 v153, v133, v249, v153 op_sel:[0,1,0] op_sel_hi:[0,1,0]
  v_fma_mix_f32 v150, v134, v250, 0 op_sel_hi:[0,1,0]
  v_fma_mix_f32 v154, v138, v250, 0 op_sel_hi:[0,1,0]
  v_fma_mix_f32 v150, -v138, v250, v150 op_sel:[0,1,0] op_sel_hi:[0,1,0]
  v_fma_mix_f32 v154, v134, v250, v154 op_sel:[0,1,0] op_sel_hi:[0,1,0]
  v_fma_mix_f32 v151, v135, v251, 0 op_sel_hi:[0,1,0]
  v_fma_mix_f32 v155, v139, v251, 0 op_sel_hi:[0,1,0]
  v_fma_mix_f32 v151, -v139, v251, v151 op_sel:[0,1,0] op_sel_hi:[0,1,0]
  v_fma_mix_f32 v155, v135, v251, v155 op_sel:[0,1,0] op_sel_hi:[0,1,0]
  v_fma_mix_f32 v156, v140, v252, 0 op_sel_hi:[0,1,0]
  v_fma_mix_f32 v160, v144, v252, 0 op_sel_hi:[0,1,0]
  v_fma_mix_f32 v156, -v144, v252, v156 op_sel:[0,1,0] op_sel_hi:[0,1,0]
  v_fma_mix_f32 v160, v140, v252, v160 op_sel:[0,1,0] op_sel_hi:[0,1,0]
  v_fma_mix_f32 v157, v141, v253, 0 op_sel_hi:[0,1,0]
  v_fma_mix_f32 v161, v145, v253, 0 op_sel_hi:[0,1,0]
  v_fma_mix_f32 v157, -v145, v253, v157 op_sel:[0,1,0] op_sel_hi:[0,1,0]
  v_fma_mix_f32 v161, v141, v253, v161 op_sel:[0,1,0] op_sel_hi:[0,1,0]
  v_fma_mix_f32 v158, v142, v254, 0 op_sel_hi:[0,1,0]
  v_fma_mix_f32 v162, v146, v254, 0 op_sel_hi:[0,1,0]
  v_fma_mix_f32 v158, -v146, v254, v158 op_sel:[0,1,0] op_sel_hi:[0,1,0]
  v_fma_mix_f32 v162, v142, v254, v162 op_sel:[0,1,0] op_sel_hi:[0,1,0]
  v_fma_mix_f32 v159, v143, v255, 0 op_sel_hi:[0,1,0]
  v_fma_mix_f32 v163, v147, v255, 0 op_sel_hi:[0,1,0]
  v_fma_mix_f32 v159, -v147, v255, v159 op_sel:[0,1,0] op_sel_hi:[0,1,0]
  v_fma_mix_f32 v163, v143, v255, v163 op_sel:[0,1,0] op_sel_hi:[0,1,0]
  v_cvt_pk_bf16_f32 v172, v148, v149
  v_cvt_pk_bf16_f32 v173, v150, v151
  v_cvt_pk_bf16_f32 v174, v152, v153
  v_cvt_pk_bf16_f32 v175, v154, v155
  v_cvt_pk_bf16_f32 v176, v156, v157
  v_cvt_pk_bf16_f32 v177, v158, v159
  v_cvt_pk_bf16_f32 v178, v160, v161
  v_cvt_pk_bf16_f32 v179, v162, v163
  ds_write_b64 v11, v[172:173] offset:8192
  ds_write_b64 v11, v[174:175] offset:12288
  ds_write_b64 v11, v[176:177] offset:9216
  ds_write_b64 v11, v[178:179] offset:13312
  s_waitcnt vmcnt(0)
  v_mov_b32 v2, 163604
  v_mov_b32 v3, 1
  s_mov_b64 exec, 1
  ds_add_u32 v2, v3
  s_mov_b64 exec, -1
  v_mov_b32 v2, 163588
  v_mov_b32 v3, 1
  s_mov_b64 exec, 1
  ds_add_u32 v2, v3
  s_mov_b64 exec, -1
  v_mov_b32 v2, 163588
  s_mov_b32 s73, 200000
L_ls51:
  ds_read_b32 v3, v2
  s_waitcnt lgkmcnt(0)
  v_readfirstlane_b32 s74, v3
  s_nop 0
  s_cmp_ge_u32 s74, 4
  s_cbranch_scc1 L_lsd52
  s_sub_u32 s73, s73, 1
  s_cmp_lg_u32 s73, 0
  s_cbranch_scc1 L_ls51
L_lsd52:
  s_setprio 2
  ds_read_b128 v[52:55], v10 offset:0
  ds_read_b128 v[56:59], v10 offset:2048
  ds_read_b128 v[60:63], v10 offset:4096
  ds_read_b128 v[64:67], v10 offset:6144
  ds_read_b128 v[68:71], v10 offset:8192
  ds_read_b128 v[72:75], v10 offset:10240
  ds_read_b128 v[76:79], v10 offset:12288
  ds_read_b128 v[80:83], v10 offset:14336
  ds_read_b128 v[84:87], v10 offset:1024
  ds_read_b128 v[88:91], v10 offset:3072
  ds_read_b128 v[92:95], v10 offset:5120
  ds_read_b128 v[96:99], v10 offset:7168
  ds_read_b128 v[100:103], v10 offset:9216
  ds_read_b128 v[104:107], v10 offset:11264
  ds_read_b128 v[108:111], v10 offset:13312
  ds_read_b128 v[112:115], v10 offset:15360
  s_mul_i32 s75, s59, 16768
  s_add_u32 s75, s75, 6094848
  s_or_b32 s75, s75, s70
  s_waitcnt lgkmcnt(12)
  v_mfma_f32_16x16x32_bf16 v[116:119], v[52:55], v[208:211], 0
  v_mfma_f32_16x16x32_bf16 v[120:123], v[60:63], v[208:211], 0
  v_mfma_f32_16x16x32_bf16 v[116:119], v[60:63], v[192:195], v[116:119]
  v_mfma_f32_16x16x32_bf16 v[120:123], v[52:55], v[216:219], v[120:123]
  v_mfma_f32_16x16x32_bf16 v[116:119], v[56:59], v[212:215], v[116:119]
  v_mfma_f32_16x16x32_bf16 v[120:123], v[64:67], v[212:215], v[120:123]
  v_mfma_f32_16x16x32_bf16 v[116:119], v[64:67], v[196:199], v[116:119]
  v_mfma_f32_16x16x32_bf16 v[120:123], v[56:59], v[220:223], v[120:123]
  s_waitcnt lgkmcnt(8)
  v_mfma_f32_16x16x32_bf16 v[124:127], v[68:71], v[208:211], 0
  v_mfma_f32_16x16x32_bf16 v[128:131], v[76:79], v[208:211], 0
  v_mfma_f32_16x16x32_bf16 v[124:127], v[76:79], v[192:195], v[124:127]
  v_mfma_f32_16x16x32_bf16 v[128:131], v[68:71], v[216:219], v[128:131]
  v_mfma_f32_16x16x32_bf16 v[124:127], v[72:75], v[212:215], v[124:127]
  v_mfma_f32_16x16x32_bf16 v[128:131], v[80:83], v[212:215], v[128:131]
  v_mfma_f32_16x16x32_bf16 v[124:127], v[80:83], v[196:199], v[124:127]
  v_mfma_f32_16x16x32_bf16 v[128:131], v[72:75], v[220:223], v[128:131]
  s_waitcnt lgkmcnt(4)
  v_mfma_f32_16x16x32_bf16 v[132:135], v[84:87], v[208:211], 0
  v_mfma_f32_16x16x32_bf16 v[136:139], v[92:95], v[208:211], 0
  v_mfma_f32_16x16x32_bf16 v[132:135], v[92:95], v[192:195], v[132:135]
  v_mfma_f32_16x16x32_bf16 v[136:139], v[84:87], v[216:219], v[136:139]
  v_mfma_f32_16x16x32_bf16 v[132:135], v[88:91], v[212:215], v[132:135]
  v_mfma_f32_16x16x32_bf16 v[136:139], v[96:99], v[212:215], v[136:139]
  v_mfma_f32_16x16x32_bf16 v[132:135], v[96:99], v[196:199], v[132:135]
  v_mfma_f32_16x16x32_bf16 v[136:139], v[88:91], v[220:223], v[136:139]
  s_waitcnt lgkmcnt(0)
  v_mfma_f32_16x16x32_bf16 v[140:143], v[100:103], v[208:211], 0
  v_mfma_f32_16x16x32_bf16 v[144:147], v[108:111], v[208:211], 0
  v_mfma_f32_16x16x32_bf16 v[140:143], v[108:111], v[192:195], v[140:143]
  v_mfma_f32_16x16x32_bf16 v[144:147], v[100:103], v[216:219], v[144:147]
  v_mfma_f32_16x16x32_bf16 v[140:143], v[104:107], v[212:215], v[140:143]
  v_mfma_f32_16x16x32_bf16 v[144:147], v[112:115], v[212:215], v[144:147]
  v_mfma_f32_16x16x32_bf16 v[140:143], v[112:115], v[196:199], v[140:143]
  v_mfma_f32_16x16x32_bf16 v[144:147], v[104:107], v[220:223], v[144:147]
  v_cvt_pk_bf16_f32 v148, v116, v120
  v_cvt_pk_bf16_f32 v149, v124, v128
  v_cvt_pk_bf16_f32 v150, v117, v121
  v_cvt_pk_bf16_f32 v151, v125, v129
  buffer_store_dwordx4 v[148:151], v12, s[28:31], s75 offen offset:0 sc1
  v_cvt_pk_bf16_f32 v152, v118, v122
  v_cvt_pk_bf16_f32 v153, v126, v130
  v_cvt_pk_bf16_f32 v154, v119, v123
  v_cvt_pk_bf16_f32 v155, v127, v131
  buffer_store_dwordx4 v[152:155], v12, s[28:31], s75 offen offset:64 sc1
  v_cvt_pk_bf16_f32 v156, v132, v136
  v_cvt_pk_bf16_f32 v157, v140, v144
  v_cvt_pk_bf16_f32 v158, v133, v137
  v_cvt_pk_bf16_f32 v159, v141, v145
  buffer_store_dwordx4 v[156:159], v12, s[28:31], s75 offen offset:128 sc1
  v_cvt_pk_bf16_f32 v160, v134, v138
  v_cvt_pk_bf16_f32 v161, v142, v146
  v_cvt_pk_bf16_f32 v162, v135, v139
  v_cvt_pk_bf16_f32 v163, v143, v147
  buffer_store_dwordx4 v[160:163], v12, s[28:31], s75 offen offset:192 sc1
  s_lshl_b32 s74, s56, 4
  v_cvt_f32_u32 v17, s74
  v_add_f32 v17, v17, v25
  v_mul_f32 v19, v17, v20
  v_fract_f32 v19, v19
  v_fmamk_f32 v77, v20, 0x3f800000, v19
  v_fmamk_f32 v78, v20, 0x40000000, v19
  v_fmamk_f32 v79, v20, 0x40400000, v19
  v_cos_f32 v80, v19
  v_cos_f32 v81, v77
  v_cos_f32 v82, v78
  v_cos_f32 v83, v79
  v_sin_f32 v84, v19
  v_sin_f32 v85, v77
  v_sin_f32 v86, v78
  v_sin_f32 v87, v79
  v_cvt_pk_bf16_f32 v156, v80, -v84
  v_cvt_pk_bf16_f32 v157, v81, -v85
  v_cvt_pk_bf16_f32 v158, v82, -v86
  v_cvt_pk_bf16_f32 v159, v83, -v87
  v_alignbit_b32 v176, v156, v156, v26
  v_alignbit_b32 v177, v157, v157, v26
  v_alignbit_b32 v178, v158, v158, v26
  v_alignbit_b32 v179, v159, v159, v26
  v_xor_b32 v176, v27, v176
  v_xor_b32 v177, v27, v177
  v_xor_b32 v178, v27, v178
  v_xor_b32 v179, v27, v179
  v_mul_f32 v19, v17, v21
  v_fract_f32 v19, v19
  v_fmamk_f32 v77, v21, 0x3f800000, v19
  v_fmamk_f32 v78, v21, 0x40000000, v19
  v_fmamk_f32 v79, v21, 0x40400000, v19
  v_cos_f32 v80, v19
  v_cos_f32 v81, v77
  v_cos_f32 v82, v78
  v_cos_f32 v83, v79
  v_sin_f32 v84, v19
  v_sin_f32 v85, v77
  v_sin_f32 v86, v78
  v_sin_f32 v87, v79
  v_cvt_pk_bf16_f32 v160, v80, -v84
  v_cvt_pk_bf16_f32 v161, v81, -v85
  v_cvt_pk_bf16_f32 v162, v82, -v86
  v_cvt_pk_bf16_f32 v163, v83, -v87
  v_alignbit_b32 v180, v160, v160, v26
  v_alignbit_b32 v181, v161, v161, v26
  v_alignbit_b32 v182, v162, v162, v26
  v_alignbit_b32 v183, v163, v163, v26
  v_xor_b32 v180, v27, v180
  v_xor_b32 v181, v27, v181
  v_xor_b32 v182, v27, v182
  v_xor_b32 v183, v27, v183
  s_waitcnt vmcnt(0)
  v_mov_b32 v2, 163592
  v_mov_b32 v3, 1
  s_mov_b64 exec, 1
  ds_add_rtn_u32 v4, v2, v3
  s_mov_b64 exec, -1
  s_waitcnt lgkmcnt(0)
  v_readfirstlane_b32 s74, v4
  s_lshl_b32 s75, s59, 7
  s_add_u32 s75, s75, 16384
  s_or_b32 s75, s75, s70
  s_cmp_eq_u32 s74, 3
  s_cselect_b32 s75, s75, 2147418112
  v_mov_b32 v4, s60
  v_mov_b32 v5, s60
  v_mov_b32 v6, s60
  v_mov_b32 v7, s60
  v_lshlrev_b32 v2, 4, v0
  s_mov_b64 exec, 0xff
  buffer_store_dwordx4 v[4:7], v2, s[28:31], s75 offen sc1
  s_mov_b64 exec, -1
  s_setprio 0
  s_branch L_g2l
L_nofft:
  s_barrier
  s_add_u32 s62, s71, 0
  s_and_b32 s62, s62, 3
  s_mul_i32 s62, s62, 10240
  s_add_u32 s62, s62, s66
  s_add_u32 m0, s67, 81920
  s_nop 0
  buffer_load_dwordx4 v18, s[28:31], s62 offen offset:0 sc1 lds
  buffer_load_dwordx4 v18, s[28:31], s62 offen offset:1024 sc1 lds
  buffer_load_dwordx4 v18, s[28:31], s62 offen offset:2048 sc1 lds
  buffer_load_dwordx4 v18, s[28:31], s62 offen offset:3072 sc1 lds
  s_add_u32 m0, s67, 86016
  s_add_u32 s62, s62, 4096
  buffer_load_dwordx4 v18, s[28:31], s62 offen offset:0 sc1 lds
  s_add_u32 s62, s71, 1
  s_and_b32 s62, s62, 3
  s_mul_i32 s62, s62, 10240
  s_add_u32 s62, s62, s66
  s_add_u32 m0, s67, 102400
  s_nop 0
  buffer_load_dwordx4 v18, s[28:31], s62 offen offset:0 sc1 lds
  buffer_load_dwordx4 v18, s[28:31], s62 offen offset:1024 sc1 lds
  buffer_load_dwordx4 v18, s[28:31], s62 offen offset:2048 sc1 lds
  buffer_load_dwordx4 v18, s[28:31], s62 offen offset:3072 sc1 lds
  s_add_u32 m0, s67, 106496
  s_add_u32 s62, s62, 4096
  buffer_load_dwordx4 v18, s[28:31], s62 offen offset:0 sc1 lds
  s_add_u32 s62, s71, 2
  s_and_b32 s62, s62, 3
  s_mul_i32 s62, s62, 10240
  s_add_u32 s62, s62, s66
  s_add_u32 m0, s67, 0
  s_nop 0
  buffer_load_dwordx4 v18, s[28:31], s62 offen offset:0 sc1 lds
  buffer_load_dwordx4 v18, s[28:31], s62 offen offset:1024 sc1 lds
  buffer_load_dwordx4 v18, s[28:31], s62 offen offset:2048 sc1 lds
  buffer_load_dwordx4 v18, s[28:31], s62 offen offset:3072 sc1 lds
  s_add_u32 m0, s67, 4096
  s_add_u32 s62, s62, 4096
  buffer_load_dwordx4 v18, s[28:31], s62 offen offset:0 sc1 lds
  s_waitcnt vmcnt(0)
  v_mov_b32 v2, 163604
  v_mov_b32 v3, 1
  s_mov_b64 exec, 1
  ds_add_u32 v2, v3
  s_mov_b64 exec, -1
  s_lshl_b32 s74, s56, 4
  v_cvt_f32_u32 v17, s74
  v_add_f32 v17, v17, v25
  v_mul_f32 v19, v17, v20
  v_fract_f32 v19, v19
  v_fmamk_f32 v77, v20, 0x3f800000, v19
  v_fmamk_f32 v78, v20, 0x40000000, v19
  v_fmamk_f32 v79, v20, 0x40400000, v19
  v_cos_f32 v80, v19
  v_cos_f32 v81, v77
  v_cos_f32 v82, v78
  v_cos_f32 v83, v79
  v_sin_f32 v84, v19
  v_sin_f32 v85, v77
  v_sin_f32 v86, v78
  v_sin_f32 v87, v79
  v_cvt_pk_bf16_f32 v156, v80, -v84
  v_cvt_pk_bf16_f32 v157, v81, -v85
  v_cvt_pk_bf16_f32 v158, v82, -v86
  v_cvt_pk_bf16_f32 v159, v83, -v87
  v_alignbit_b32 v176, v156, v156, v26
  v_alignbit_b32 v177, v157, v157, v26
  v_alignbit_b32 v178, v158, v158, v26
  v_alignbit_b32 v179, v159, v159, v26
  v_xor_b32 v176, v27, v176
  v_xor_b32 v177, v27, v177
  v_xor_b32 v178, v27, v178
  v_xor_b32 v179, v27, v179
  v_mul_f32 v19, v17, v21
  v_fract_f32 v19, v19
  v_fmamk_f32 v77, v21, 0x3f800000, v19
  v_fmamk_f32 v78, v21, 0x40000000, v19
  v_fmamk_f32 v79, v21, 0x40400000, v19
  v_cos_f32 v80, v19
  v_cos_f32 v81, v77
  v_cos_f32 v82, v78
  v_cos_f32 v83, v79
  v_sin_f32 v84, v19
  v_sin_f32 v85, v77
  v_sin_f32 v86, v78
  v_sin_f32 v87, v79
  v_cvt_pk_bf16_f32 v160, v80, -v84
  v_cvt_pk_bf16_f32 v161, v81, -v85
  v_cvt_pk_bf16_f32 v162, v82, -v86
  v_cvt_pk_bf16_f32 v163, v83, -v87
  v_alignbit_b32 v180, v160, v160, v26
  v_alignbit_b32 v181, v161, v161, v26
  v_alignbit_b32 v182, v162, v162, v26
  v_alignbit_b32 v183, v163, v163, v26
  v_xor_b32 v180, v27, v180
  v_xor_b32 v181, v27, v181
  v_xor_b32 v182, v27, v182
  v_xor_b32 v183, v27, v183
L_g2l:
  s_mov_b32 s76, 16384
  s_lshl_b32 s79, s57, 9
  s_add_u32 s79, s79, 6094848
  v_mov_b32 v28, 163632
  v_mul_f32 v19, v17, v22
  v_fract_f32 v19, v19
  v_fmamk_f32 v77, v22, 0x3f800000, v19
  v_fmamk_f32 v78, v22, 0x40000000, v19
  v_fmamk_f32 v79, v22, 0x40400000, v19
  v_cos_f32 v80, v19
  v_cos_f32 v81, v77
  v_cos_f32 v82, v78
  v_cos_f32 v83, v79
  v_sin_f32 v84, v19
  v_sin_f32 v85, v77
  v_sin_f32 v86, v78
  v_sin_f32 v87, v79
  v_cvt_pk_bf16_f32 v164, v80, -v84
  v_cvt_pk_bf16_f32 v165, v81, -v85
  v_cvt_pk_bf16_f32 v166, v82, -v86
  v_cvt_pk_bf16_f32 v167, v83, -v87
  v_alignbit_b32 v184, v164, v164, v26
  v_alignbit_b32 v185, v165, v165, v26
  v_alignbit_b32 v186, v166, v166, v26
  v_alignbit_b32 v187, v167, v167, v26
  v_xor_b32 v184, v27, v184
  v_xor_b32 v185, v27, v185
  v_xor_b32 v186, v27, v186
  v_xor_b32 v187, v27, v187
  v_mul_f32 v19, v17, v23
  v_fract_f32 v19, v19
  v_fmamk_f32 v77, v23, 0x3f800000, v19
  v_fmamk_f32 v78, v23, 0x40000000, v19
  v_fmamk_f32 v79, v23, 0x40400000, v19
  v_cos_f32 v80, v19
  v_cos_f32 v81, v77
  v_cos_f32 v82, v78
  v_cos_f32 v83, v79
  v_sin_f32 v84, v19
  v_sin_f32 v85, v77
  v_sin_f32 v86, v78
  v_sin_f32 v87, v79
  v_cvt_pk_bf16_f32 v168, v80, -v84
  v_cvt_pk_bf16_f32 v169, v81, -v85
  v_cvt_pk_bf16_f32 v170, v82, -v86
  v_cvt_pk_bf16_f32 v171, v83, -v87
  v_alignbit_b32 v188, v168, v168, v26
  v_alignbit_b32 v189, v169, v169, v26
  v_alignbit_b32 v190, v170, v170, v26
  v_alignbit_b32 v191, v171, v171, v26
  v_xor_b32 v188, v27, v188
  v_xor_b32 v189, v27, v189
  v_xor_b32 v190, v27, v190
  v_xor_b32 v191, v27, v191
  v_mul_f32 v19, v17, v24
  v_fract_f32 v19, v19
  v_fmamk_f32 v77, v24, 0x3f800000, v19
  v_fmamk_f32 v78, v24, 0x40000000, v19
  v_fmamk_f32 v79, v24, 0x40400000, v19
  v_cos_f32 v80, v19
  v_cos_f32 v81, v77
  v_cos_f32 v82, v78
  v_cos_f32 v83, v79
  v_sin_f32 v84, v19
  v_sin_f32 v85, v77
  v_sin_f32 v86, v78
  v_sin_f32 v87, v79
  v_cvt_pk_bf16_f32 v172, v80, -v84
  v_cvt_pk_bf16_f32 v173, v81, -v85
  v_cvt_pk_bf16_f32 v174, v82, -v86
  v_cvt_pk_bf16_f32 v175, v83, -v87
  v_alignbit_b32 v192, v172, v172, v26
  v_alignbit_b32 v193, v173, v173, v26
  v_alignbit_b32 v194, v174, v174, v26
  v_alignbit_b32 v195, v175, v175, v26
  v_xor_b32 v192, v27, v192
  v_xor_b32 v193, v27, v193
  v_xor_b32 v194, v27, v194
  v_xor_b32 v195, v27, v195
  s_lshl_b32 s74, s72, 4
  v_cvt_f32_u32 v17, s74
  v_add_f32 v17, v17, v25
  v_mul_f32 v19, v17, v20
  v_fract_f32 v19, v19
  v_fmamk_f32 v77, v20, 0x3f800000, v19
  v_fmamk_f32 v78, v20, 0x40000000, v19
  v_fmamk_f32 v79, v20, 0x40400000, v19
  v_cos_f32 v80, v19
  v_cos_f32 v81, v77
  v_cos_f32 v82, v78
  v_cos_f32 v83, v79
  v_sin_f32 v84, v19
  v_sin_f32 v85, v77
  v_sin_f32 v86, v78
  v_sin_f32 v87, v79
  v_cvt_pk_bf16_f32 v196, v80, -v84
  v_cvt_pk_bf16_f32 v197, v81, -v85
  v_cvt_pk_bf16_f32 v198, v82, -v86
  v_cvt_pk_bf16_f32 v199, v83, -v87
  v_alignbit_b32 v216, v196, v196, v26
  v_alignbit_b32 v217, v197, v197, v26
  v_alignbit_b32 v218, v198, v198, v26
  v_alignbit_b32 v219, v199, v199, v26
  v_xor_b32 v216, v27, v216
  v_xor_b32 v217, v27, v217
  v_xor_b32 v218, v27, v218
  v_xor_b32 v219, v27, v219
  v_mul_f32 v19, v17, v21
  v_fract_f32 v19, v19
  v_fmamk_f32 v77, v21, 0x3f800000, v19
  v_fmamk_f32 v78, v21, 0x40000000, v19
  v_fmamk_f32 v79, v21, 0x40400000, v19
  v_cos_f32 v80, v19
  v_cos_f32 v81, v77
  v_cos_f32 v82, v78
  v_cos_f32 v83, v79
  v_sin_f32 v84, v19
  v_sin_f32 v85, v77
  v_sin_f32 v86, v78
  v_sin_f32 v87, v79
  v_cvt_pk_bf16_f32 v200, v80, -v84
  v_cvt_pk_bf16_f32 v201, v81, -v85
  v_cvt_pk_bf16_f32 v202, v82, -v86
  v_cvt_pk_bf16_f32 v203, v83, -v87
  v_alignbit_b32 v220, v200, v200, v26
  v_alignbit_b32 v221, v201, v201, v26
  v_alignbit_b32 v222, v202, v202, v26
  v_alignbit_b32 v223, v203, v203, v26
  v_xor_b32 v220, v27, v220
  v_xor_b32 v221, v27, v221
  v_xor_b32 v222, v27, v222
  v_xor_b32 v223, v27, v223
  v_mul_f32 v19, v17, v22
  v_fract_f32 v19, v19
  v_fmamk_f32 v77, v22, 0x3f800000, v19
  v_fmamk_f32 v78, v22, 0x40000000, v19
  v_fmamk_f32 v79, v22, 0x40400000, v19
  v_cos_f32 v80, v19
  v_cos_f32 v81, v77
  v_cos_f32 v82, v78
  v_cos_f32 v83, v79
  v_sin_f32 v84, v19
  v_sin_f32 v85, v77
  v_sin_f32 v86, v78
  v_sin_f32 v87, v79
  v_cvt_pk_bf16_f32 v204, v80, -v84
  v_cvt_pk_bf16_f32 v205, v81, -v85
  v_cvt_pk_bf16_f32 v206, v82, -v86
  v_cvt_pk_bf16_f32 v207, v83, -v87
  v_alignbit_b32 v224, v204, v204, v26
  v_alignbit_b32 v225, v205, v205, v26
  v_alignbit_b32 v226, v206, v206, v26
  v_alignbit_b32 v227, v207, v207, v26
  v_xor_b32 v224, v27, v224
  v_xor_b32 v225, v27, v225
  v_xor_b32 v226, v27, v226
  v_xor_b32 v227, v27, v227
  v_mul_f32 v19, v17, v23
  v_fract_f32 v19, v19
  v_fmamk_f32 v77, v23, 0x3f800000, v19
  v_fmamk_f32 v78, v23, 0x40000000, v19
  v_fmamk_f32 v79, v23, 0x40400000, v19
  v_cos_f32 v80, v19
  v_cos_f32 v81, v77
  v_cos_f32 v82, v78
  v_cos_f32 v83, v79
  v_sin_f32 v84, v19
  v_sin_f32 v85, v77
  v_sin_f32 v86, v78
  v_sin_f32 v87, v79
  v_cvt_pk_bf16_f32 v208, v80, -v84
  v_cvt_pk_bf16_f32 v209, v81, -v85
  v_cvt_pk_bf16_f32 v210, v82, -v86
  v_cvt_pk_bf16_f32 v211, v83, -v87
  v_alignbit_b32 v228, v208, v208, v26
  v_alignbit_b32 v229, v209, v209, v26
  v_alignbit_b32 v230, v210, v210, v26
  v_alignbit_b32 v231, v211, v211, v26
  v_xor_b32 v228, v27, v228
  v_xor_b32 v229, v27, v229
  v_xor_b32 v230, v27, v230
  v_xor_b32 v231, v27, v231
  v_mul_f32 v19, v17, v24
  v_fract_f32 v19, v19
  v_fmamk_f32 v77, v24, 0x3f800000, v19
  v_fmamk_f32 v78, v24, 0x40000000, v19
  v_fmamk_f32 v79, v24, 0x40400000, v19
  v_cos_f32 v80, v19
  v_cos_f32 v81, v77
  v_cos_f32 v82, v78
  v_cos_f32 v83, v79
  v_sin_f32 v84, v19
  v_sin_f32 v85, v77
  v_sin_f32 v86, v78
  v_sin_f32 v87, v79
  v_cvt_pk_bf16_f32 v212, v80, -v84
  v_cvt_pk_bf16_f32 v213, v81, -v85
  v_cvt_pk_bf16_f32 v214, v82, -v86
  v_cvt_pk_bf16_f32 v215, v83, -v87
  v_alignbit_b32 v232, v212, v212, v26
  v_alignbit_b32 v233, v213, v213, v26
  v_alignbit_b32 v234, v214, v214, v26
  v_alignbit_b32 v235, v215, v215, v26
  v_xor_b32 v232, v27, v232
  v_xor_b32 v233, v27, v233
  v_xor_b32 v234, v27, v234
  v_xor_b32 v235, v27, v235
  s_lshl_b32 s74, s69, 4
  v_cvt_f32_u32 v17, s74
  v_add_f32 v17, v17, v25
  v_mul_f32 v19, v17, v20
  v_fract_f32 v19, v19
  v_fmamk_f32 v77, v20, 0x3f800000, v19
  v_fmamk_f32 v78, v20, 0x40000000, v19
  v_fmamk_f32 v79, v20, 0x40400000, v19
  v_cos_f32 v80, v19
  v_cos_f32 v81, v77
  v_cos_f32 v82, v78
  v_cos_f32 v83, v79
  v_sin_f32 v84, v19
  v_sin_f32 v85, v77
  v_sin_f32 v86, v78
  v_sin_f32 v87, v79
  v_cvt_pk_bf16_f32 v236, v80, -v84
  v_cvt_pk_bf16_f32 v237, v81, -v85
  v_cvt_pk_bf16_f32 v238, v82, -v86
  v_cvt_pk_bf16_f32 v239, v83, -v87
  v_mul_f32 v19, v17, v21
  v_fract_f32 v19, v19
  v_fmamk_f32 v77, v21, 0x3f800000, v19
  v_fmamk_f32 v78, v21, 0x40000000, v19
  v_fmamk_f32 v79, v21, 0x40400000, v19
  v_cos_f32 v80, v19
  v_cos_f32 v81, v77
  v_cos_f32 v82, v78
  v_cos_f32 v83, v79
  v_sin_f32 v84, v19
  v_sin_f32 v85, v77
  v_sin_f32 v86, v78
  v_sin_f32 v87, v79
  v_cvt_pk_bf16_f32 v240, v80, -v84
  v_cvt_pk_bf16_f32 v241, v81, -v85
  v_cvt_pk_bf16_f32 v242, v82, -v86
  v_cvt_pk_bf16_f32 v243, v83, -v87
  v_mul_f32 v19, v17, v22
  v_fract_f32 v19, v19
  v_fmamk_f32 v77, v22, 0x3f800000, v19
  v_fmamk_f32 v78, v22, 0x40000000, v19
  v_fmamk_f32 v79, v22, 0x40400000, v19
  v_cos_f32 v80, v19
  v_cos_f32 v81, v77
  v_cos_f32 v82, v78
  v_cos_f32 v83, v79
  v_sin_f32 v84, v19
  v_sin_f32 v85, v77
  v_sin_f32 v86, v78
  v_sin_f32 v87, v79
  v_cvt_pk_bf16_f32 v244, v80, -v84
  v_cvt_pk_bf16_f32 v245, v81, -v85
  v_cvt_pk_bf16_f32 v246, v82, -v86
  v_cvt_pk_bf16_f32 v247, v83, -v87
  v_mul_f32 v19, v17, v23
  v_fract_f32 v19, v19
  v_fmamk_f32 v77, v23, 0x3f800000, v19
  v_fmamk_f32 v78, v23, 0x40000000, v19
  v_fmamk_f32 v79, v23, 0x40400000, v19
  v_cos_f32 v80, v19
  v_cos_f32 v81, v77
  v_cos_f32 v82, v78
  v_cos_f32 v83, v79
  v_sin_f32 v84, v19
  v_sin_f32 v85, v77
  v_sin_f32 v86, v78
  v_sin_f32 v87, v79
  v_cvt_pk_bf16_f32 v248, v80, -v84
  v_cvt_pk_bf16_f32 v249, v81, -v85
  v_cvt_pk_bf16_f32 v250, v82, -v86
  v_cvt_pk_bf16_f32 v251, v83, -v87
  v_mul_f32 v19, v17, v24
  v_fract_f32 v19, v19
  v_fmamk_f32 v77, v24, 0x3f800000, v19
  v_fmamk_f32 v78, v24, 0x40000000, v19
  v_fmamk_f32 v79, v24, 0x40400000, v19
  v_cos_f32 v80, v19
  v_cos_f32 v81, v77
  v_cos_f32 v82, v78
  v_cos_f32 v83, v79
  v_sin_f32 v84, v19
  v_sin_f32 v85, v77
  v_sin_f32 v86, v78
  v_sin_f32 v87, v79
  v_cvt_pk_bf16_f32 v252, v80, -v84
  v_cvt_pk_bf16_f32 v253, v81, -v85
  v_cvt_pk_bf16_f32 v254, v82, -v86
  v_cvt_pk_bf16_f32 v255, v83, -v87
  s_mov_b32 s73, 200000
L_pw53:
  ds_read_b128 v[4:7], v28
  s_waitcnt lgkmcnt(0)
  v_min3_u32 v4, v4, v5, v6
  v_min_u32 v4, v4, v7
  s_nop 0
  v_readfirstlane_b32 s74, v4
  s_nop 0
  s_cmp_ge_u32 s74, 7
  s_cbranch_scc1 L_pwd54
  s_sleep 4
  s_sub_u32 s73, s73, 1
  s_cmp_lg_u32 s73, 0
  s_cbranch_scc1 L_pw53
L_pwd54:
  buffer_load_dword v15, v29, s[28:31], s76 offen sc1
  s_mov_b32 s73, 200000
L_pw55:
  ds_read_b128 v[4:7], v28
  s_waitcnt lgkmcnt(0)
  v_min3_u32 v4, v4, v5, v6
  v_min_u32 v4, v4, v7
  s_nop 0
  v_readfirstlane_b32 s74, v4
  s_nop 0
  s_cmp_ge_u32 s74, 8
  s_cbranch_scc1 L_pwd56
  s_sleep 4
  s_sub_u32 s73, s73, 1
  s_cmp_lg_u32 s73, 0
  s_cbranch_scc1 L_pw55
L_pwd56:
  s_mov_b32 s73, 20000
  s_waitcnt vmcnt(0)
  s_branch L_pchk59
L_poll57:
  buffer_load_dword v15, v29, s[28:31], s76 offen sc1
  s_waitcnt vmcnt(0)
L_pchk59:
  v_cmp_eq_u32 vcc, s60, v15
  s_nop 0
  s_cmp_eq_u64 vcc, exec
  s_cbranch_scc1 L_pdone58
  s_sub_u32 s73, s73, 1
  s_cmp_eq_u32 s73, 0
  s_cbranch_scc1 L_pdone58
  s_sleep 8
  s_branch L_poll57
L_pdone58:
  s_lshl_b32 s62, s57, 9
  s_add_u32 s62, s62, 8777728
  s_cmp_eq_u32 s61, 0
  s_cselect_b32 s62, s62, 2147418112
  v_and_b32 v2, 15, v0
  v_lshlrev_b32 v2, 4, v2
  buffer_load_dwordx4 v[136:139], v2, s[28:31], s62 offen offset:0 sc1
  buffer_load_dwordx4 v[140:143], v2, s[28:31], s62 offen offset:256 sc1
  s_setprio 2
  s_mul_i32 s62, s56, 134144
  s_add_u32 s62, s62, s79
  s_add_u32 s63, s62, 16768
  buffer_load_dwordx4 v[32:35], v30, s[28:31], s62 offen offset:0 sc1
  buffer_load_dwordx4 v[36:39], v30, s[28:31], s63 offen offset:0 sc1
  buffer_load_dwordx4 v[40:43], v30, s[28:31], s62 offen offset:256 sc1
  buffer_load_dwordx4 v[44:47], v30, s[28:31], s63 offen offset:256 sc1
  s_mul_i32 s62, s56, 134144
  s_add_u32 s62, s62, s79
  s_add_u32 s62, s62, 1341440
  s_add_u32 s63, s62, 16768
  buffer_load_dwordx4 v[48:51], v30, s[28:31], s62 offen offset:0 sc1
  buffer_load_dwordx4 v[52:55], v30, s[28:31], s63 offen offset:0 sc1
  buffer_load_dwordx4 v[56:59], v30, s[28:31], s62 offen offset:256 sc1
  buffer_load_dwordx4 v[60:63], v30, s[28:31], s63 offen offset:256 sc1
  s_mul_i32 s62, s72, 134144
  s_add_u32 s62, s62, s79
  s_add_u32 s63, s62, 16768
  buffer_load_dwordx4 v[64:67], v30, s[28:31], s62 offen offset:0 sc1
  buffer_load_dwordx4 v[68:71], v30, s[28:31], s63 offen offset:0 sc1
  buffer_load_dwordx4 v[72:75], v30, s[28:31], s62 offen offset:256 sc1
  buffer_load_dwordx4 v[8:11], v30, s[28:31], s63 offen offset:256 sc1
  s_mul_i32 s62, s72, 134144
  s_add_u32 s62, s62, s79
  s_add_u32 s62, s62, 1341440
  s_add_u32 s63, s62, 16768
  buffer_load_dwordx4 v[12:15], v30, s[28:31], s62 offen offset:0 sc1
  buffer_load_dwordx4 v[16:19], v30, s[28:31], s63 offen offset:0 sc1
  buffer_load_dwordx4 v[20:23], v30, s[28:31], s62 offen offset:256 sc1
  buffer_load_dwordx4 v[24:27], v30, s[28:31], s63 offen offset:256 sc1
  s_waitcnt vmcnt(14)
  v_swap_b32 v34, v36
  v_swap_b32 v35, v37
  v_lshlrev_b32 v4, 16, v136
  v_xor_b32 v5, 0x80000000, v4
  v_mov_b32 v6, v4
  v_mov_b32 v7, v5
  s_nop 1
  v_mfma_f32_16x16x32_bf16 v[76:79], v[156:159], v[32:35], v[4:7]
  v_mfma_f32_16x16x32_bf16 v[80:83], v[160:163], v[32:35], v[4:7]
  v_mfma_f32_16x16x32_bf16 v[84:87], v[164:167], v[32:35], v[4:7]
  v_mfma_f32_16x16x32_bf16 v[88:91], v[168:171], v[32:35], v[4:7]
  v_mfma_f32_16x16x32_bf16 v[92:95], v[172:175], v[32:35], v[4:7]
  s_nop 2
  v_lshlrev_b32 v4, 16, v138
  v_xor_b32 v5, 0x80000000, v4
  v_mov_b32 v6, v4
  v_mov_b32 v7, v5
  s_nop 1
  v_mfma_f32_16x16x32_bf16 v[96:99], v[156:159], v[36:39], v[4:7]
  v_mfma_f32_16x16x32_bf16 v[100:103], v[160:163], v[36:39], v[4:7]
  v_mfma_f32_16x16x32_bf16 v[104:107], v[164:167], v[36:39], v[4:7]
  v_mfma_f32_16x16x32_bf16 v[108:111], v[168:171], v[36:39], v[4:7]
  v_mfma_f32_16x16x32_bf16 v[112:115], v[172:175], v[36:39], v[4:7]
  s_waitcnt vmcnt(12)
  v_swap_b32 v42, v44
  v_swap_b32 v43, v45
  v_lshlrev_b32 v4, 16, v140
  v_xor_b32 v5, 0x80000000, v4
  v_mov_b32 v6, v4
  v_mov_b32 v7, v5
  s_nop 1
  v_mfma_f32_16x16x32_bf16 v[116:119], v[156:159], v[40:43], v[4:7]
  v_mfma_f32_16x16x32_bf16 v[120:123], v[160:163], v[40:43], v[4:7]
  v_mfma_f32_16x16x32_bf16 v[124:127], v[164:167], v[40:43], v[4:7]
  v_mfma_f32_16x16x32_bf16 v[128:131], v[168:171], v[40:43], v[4:7]
  v_mfma_f32_16x16x32_bf16 v[132:135], v[172:175], v[40:43], v[4:7]
  s_nop 2
  v_lshlrev_b32 v4, 16, v142
  v_xor_b32 v5, 0x80000000, v4
  v_mov_b32 v6, v4
  v_mov_b32 v7, v5
  s_nop 1
  v_mfma_f32_16x16x32_bf16 v[136:139], v[156:159], v[44:47], v[4:7]
  v_mfma_f32_16x16x32_bf16 v[140:143], v[160:163], v[44:47], v[4:7]
  v_mfma_f32_16x16x32_bf16 v[144:147], v[164:167], v[44:47], v[4:7]
  v_mfma_f32_16x16x32_bf16 v[148:151], v[168:171], v[44:47], v[4:7]
  v_mfma_f32_16x16x32_bf16 v[152:155], v[172:175], v[44:47], v[4:7]
  s_mul_i32 s62, s69, 134144
  s_add_u32 s62, s62, s79
  s_add_u32 s63, s62, 16768
  buffer_load_dwordx4 v[32:35], v30, s[28:31], s62 offen offset:0 sc1
  buffer_load_dwordx4 v[36:39], v30, s[28:31], s63 offen offset:0 sc1
  buffer_load_dwordx4 v[40:43], v30, s[28:31], s62 offen offset:256 sc1
  buffer_load_dwordx4 v[44:47], v30, s[28:31], s63 offen offset:256 sc1
  s_waitcnt vmcnt(14)
  v_swap_b32 v50, v52
  v_swap_b32 v51, v53
  s_nop 1
  v_mfma_f32_16x16x32_bf16 v[76:79], v[176:179], v[48:51], v[76:79]
  v_mfma_f32_16x16x32_bf16 v[80:83], v[180:183], v[48:51], v[80:83]
  v_mfma_f32_16x16x32_bf16 v[84:87], v[184:187], v[48:51], v[84:87]
  v_mfma_f32_16x16x32_bf16 v[88:91], v[188:191], v[48:51], v[88:91]
  v_mfma_f32_16x16x32_bf16 v[92:95], v[192:195], v[48:51], v[92:95]
  v_mfma_f32_16x16x32_bf16 v[96:99], v[176:179], v[52:55], v[96:99]
  v_mfma_f32_16x16x32_bf16 v[100:103], v[180:183], v[52:55], v[100:103]
  v_mfma_f32_16x16x32_bf16 v[104:107], v[184:187], v[52:55], v[104:107]
  v_mfma_f32_16x16x32_bf16 v[108:111], v[188:191], v[52:55], v[108:111]
  v_mfma_f32_16x16x32_bf16 v[112:115], v[192:195], v[52:55], v[112:115]
  s_waitcnt vmcnt(12)
  v_swap_b32 v58, v60
  v_swap_b32 v59, v61
  s_nop 1
  v_mfma_f32_16x16x32_bf16 v[116:119], v[176:179], v[56:59], v[116:119]
  v_mfma_f32_16x16x32_bf16 v[120:123], v[180:183], v[56:59], v[120:123]
  v_mfma_f32_16x16x32_bf16 v[124:127], v[184:187], v[56:59], v[124:127]
  v_mfma_f32_16x16x32_bf16 v[128:131], v[188:191], v[56:59], v[128:131]
  v_mfma_f32_16x16x32_bf16 v[132:135], v[192:195], v[56:59], v[132:135]
  v_mfma_f32_16x16x32_bf16 v[136:139], v[176:179], v[60:63], v[136:139]
  v_mfma_f32_16x16x32_bf16 v[140:143], v[180:183], v[60:63], v[140:143]
  v_mfma_f32_16x16x32_bf16 v[144:147], v[184:187], v[60:63], v[144:147]
  v_mfma_f32_16x16x32_bf16 v[148:151], v[188:191], v[60:63], v[148:151]
  v_mfma_f32_16x16x32_bf16 v[152:155], v[192:195], v[60:63], v[152:155]
  s_waitcnt vmcnt(10)
  v_swap_b32 v66, v68
  v_swap_b32 v67, v69
  s_nop 1
  v_mfma_f32_16x16x32_bf16 v[76:79], v[196:199], v[64:67], v[76:79]
  v_mfma_f32_16x16x32_bf16 v[80:83], v[200:203], v[64:67], v[80:83]
  v_mfma_f32_16x16x32_bf16 v[84:87], v[204:207], v[64:67], v[84:87]
  v_mfma_f32_16x16x32_bf16 v[88:91], v[208:211], v[64:67], v[88:91]
  v_mfma_f32_16x16x32_bf16 v[92:95], v[212:215], v[64:67], v[92:95]
  v_mfma_f32_16x16x32_bf16 v[96:99], v[196:199], v[68:71], v[96:99]
  v_mfma_f32_16x16x32_bf16 v[100:103], v[200:203], v[68:71], v[100:103]
  v_mfma_f32_16x16x32_bf16 v[104:107], v[204:207], v[68:71], v[104:107]
  v_mfma_f32_16x16x32_bf16 v[108:111], v[208:211], v[68:71], v[108:111]
  v_mfma_f32_16x16x32_bf16 v[112:115], v[212:215], v[68:71], v[112:115]
  s_waitcnt vmcnt(8)
  v_swap_b32 v74, v8
  v_swap_b32 v75, v9
  s_nop 1
  v_mfma_f32_16x16x32_bf16 v[116:119], v[196:199], v[72:75], v[116:119]
  v_mfma_f32_16x16x32_bf16 v[120:123], v[200:203], v[72:75], v[120:123]
  v_mfma_f32_16x16x32_bf16 v[124:127], v[204:207], v[72:75], v[124:127]
  v_mfma_f32_16x16x32_bf16 v[128:131], v[208:211], v[72:75], v[128:131]
  v_mfma_f32_16x16x32_bf16 v[132:135], v[212:215], v[72:75], v[132:135]
  v_mfma_f32_16x16x32_bf16 v[136:139], v[196:199], v[8:11], v[136:139]
  v_mfma_f32_16x16x32_bf16 v[140:143], v[200:203], v[8:11], v[140:143]
  v_mfma_f32_16x16x32_bf16 v[144:147], v[204:207], v[8:11], v[144:147]
  v_mfma_f32_16x16x32_bf16 v[148:151], v[208:211], v[8:11], v[148:151]
  v_mfma_f32_16x16x32_bf16 v[152:155], v[212:215], v[8:11], v[152:155]
  s_cmp_eq_u32 s100, 0
  s_cbranch_scc1 L_nw60
  v_mov_b32 v2, 163592
  s_mov_b32 s73, 200000
L_ls61:
  ds_read_b32 v3, v2
  s_waitcnt lgkmcnt(0)
  v_readfirstlane_b32 s74, v3
  s_nop 0
  s_cmp_ge_u32 s74, 4
  s_cbranch_scc1 L_lsd62
  s_sub_u32 s73, s73, 1
  s_cmp_lg_u32 s73, 0
  s_cbranch_scc1 L_ls61
L_lsd62:
L_nw60:
  s_mov_b32 s73, 200000
L_pw63:
  ds_read_b128 v[4:7], v28
  s_waitcnt lgkmcnt(0)
  v_min3_u32 v4, v4, v5, v6
  v_min_u32 v4, v4, v7
  s_nop 0
  v_readfirstlane_b32 s74, v4
  s_nop 0
  s_cmp_ge_u32 s74, 9
  s_cbranch_scc1 L_pwd64
  s_sleep 4
  s_sub_u32 s73, s73, 1
  s_cmp_lg_u32 s73, 0
  s_cbranch_scc1 L_pw63
L_pwd64:
  v_xor_b32 v3, 128, v31
  s_waitcnt vmcnt(6)
  v_swap_b32 v14, v16
  v_swap_b32 v15, v17
  s_nop 1
  v_mfma_f32_16x16x32_bf16 v[76:79], v[216:219], v[12:15], v[76:79]
  v_mfma_f32_16x16x32_bf16 v[80:83], v[220:223], v[12:15], v[80:83]
  v_mfma_f32_16x16x32_bf16 v[84:87], v[224:227], v[12:15], v[84:87]
  v_mfma_f32_16x16x32_bf16 v[88:91], v[228:231], v[12:15], v[88:91]
  v_mfma_f32_16x16x32_bf16 v[92:95], v[232:235], v[12:15], v[92:95]
  s_waitcnt vmcnt(2)
  v_swap_b32 v34, v36
  v_swap_b32 v35, v37
  s_nop 1
  v_mfma_f32_16x16x32_bf16 v[76:79], v[236:239], v[32:35], v[76:79]
  v_mfma_f32_16x16x32_bf16 v[80:83], v[240:243], v[32:35], v[80:83]
  v_mfma_f32_16x16x32_bf16 v[84:87], v[244:247], v[32:35], v[84:87]
  v_mfma_f32_16x16x32_bf16 v[88:91], v[248:251], v[32:35], v[88:91]
  v_mfma_f32_16x16x32_bf16 v[92:95], v[252:255], v[32:35], v[92:95]
  v_mfma_f32_16x16x32_bf16 v[96:99], v[216:219], v[16:19], v[96:99]
  v_mfma_f32_16x16x32_bf16 v[100:103], v[220:223], v[16:19], v[100:103]
  v_mfma_f32_16x16x32_bf16 v[104:107], v[224:227], v[16:19], v[104:107]
  v_mfma_f32_16x16x32_bf16 v[108:111], v[228:231], v[16:19], v[108:111]
  v_mfma_f32_16x16x32_bf16 v[112:115], v[232:235], v[16:19], v[112:115]
  v_mfma_f32_16x16x32_bf16 v[96:99], v[236:239], v[36:39], v[96:99]
  v_mfma_f32_16x16x32_bf16 v[100:103], v[240:243], v[36:39], v[100:103]
  v_mfma_f32_16x16x32_bf16 v[104:107], v[244:247], v[36:39], v[104:107]
  v_mfma_f32_16x16x32_bf16 v[108:111], v[248:251], v[36:39], v[108:111]
  v_mfma_f32_16x16x32_bf16 v[112:115], v[252:255], v[36:39], v[112:115]
  ds_write_b128 v31, v[76:79] offset:0
  ds_write_b128 v31, v[80:83] offset:1024
  ds_write_b128 v31, v[84:87] offset:2048
  ds_write_b128 v31, v[88:91] offset:3072
  ds_write_b128 v31, v[92:95] offset:4096
  v_swap_b32 v22, v24
  v_swap_b32 v23, v25
  s_nop 1
  v_mfma_f32_16x16x32_bf16 v[116:119], v[216:219], v[20:23], v[116:119]
  v_mfma_f32_16x16x32_bf16 v[120:123], v[220:223], v[20:23], v[120:123]
  v_mfma_f32_16x16x32_bf16 v[124:127], v[224:227], v[20:23], v[124:127]
  v_mfma_f32_16x16x32_bf16 v[128:131], v[228:231], v[20:23], v[128:131]
  v_mfma_f32_16x16x32_bf16 v[132:135], v[232:235], v[20:23], v[132:135]
  s_waitcnt vmcnt(0)
  v_swap_b32 v42, v44
  v_swap_b32 v43, v45
  s_nop 1
  v_mfma_f32_16x16x32_bf16 v[116:119], v[236:239], v[40:43], v[116:119]
  v_mfma_f32_16x16x32_bf16 v[120:123], v[240:243], v[40:43], v[120:123]
  v_mfma_f32_16x16x32_bf16 v[124:127], v[244:247], v[40:43], v[124:127]
  v_mfma_f32_16x16x32_bf16 v[128:131], v[248:251], v[40:43], v[128:131]
  v_mfma_f32_16x16x32_bf16 v[132:135], v[252:255], v[40:43], v[132:135]
  ds_write_b128 v3, v[96:99] offset:5120
  ds_write_b128 v3, v[100:103] offset:6144
  ds_write_b128 v3, v[104:107] offset:7168
  ds_write_b128 v3, v[108:111] offset:8192
  ds_write_b128 v3, v[112:115] offset:9216
  v_mfma_f32_16x16x32_bf16 v[136:139], v[216:219], v[24:27], v[136:139]
  v_mfma_f32_16x16x32_bf16 v[140:143], v[220:223], v[24:27], v[140:143]
  v_mfma_f32_16x16x32_bf16 v[144:147], v[224:227], v[24:27], v[144:147]
  v_mfma_f32_16x16x32_bf16 v[148:151], v[228:231], v[24:27], v[148:151]
  v_mfma_f32_16x16x32_bf16 v[152:155], v[232:235], v[24:27], v[152:155]
  v_mfma_f32_16x16x32_bf16 v[136:139], v[236:239], v[44:47], v[136:139]
  v_mfma_f32_16x16x32_bf16 v[140:143], v[240:243], v[44:47], v[140:143]
  v_mfma_f32_16x16x32_bf16 v[144:147], v[244:247], v[44:47], v[144:147]
  v_mfma_f32_16x16x32_bf16 v[148:151], v[248:251], v[44:47], v[148:151]
  v_mfma_f32_16x16x32_bf16 v[152:155], v[252:255], v[44:47], v[152:155]
  ds_write_b128 v31, v[116:119] offset:10240
  ds_write_b128 v31, v[120:123] offset:11264
  ds_write_b128 v31, v[124:127] offset:12288
  ds_write_b128 v31, v[128:131] offset:13312
  ds_write_b128 v31, v[132:135] offset:14336
  ds_write_b128 v3, v[136:139] offset:15360
  ds_write_b128 v3, v[140:143] offset:16384
  ds_write_b128 v3, v[144:147] offset:17408
  ds_write_b128 v3, v[148:151] offset:18432
  ds_write_b128 v3, v[152:155] offset:19456
  s_waitcnt lgkmcnt(0)
  s_barrier
L_end:
  s_endpgm
L_codeend:
.set PFMAX, ((L_codeend - recurrent_scan__spectral_gfnet__glu_gated_geglu__prompt_kernel) & ~127) - 128
.section .rodata,"a"
.p2align 6
.amdhsa_kernel recurrent_scan__spectral_gfnet__glu_gated_geglu__prompt_kernel
  .amdhsa_next_free_vgpr 256
  .amdhsa_next_free_sgpr 102
  .amdhsa_accum_offset 256
  .amdhsa_group_segment_fixed_size 0
  .amdhsa_kernarg_size 80
  .amdhsa_user_sgpr_count 2
  .amdhsa_user_sgpr_kernarg_segment_ptr 1
  .amdhsa_system_sgpr_workgroup_id_x 1
.end_amdhsa_kernel
```
